```python
import torch

def _softmax(x, axis=-1):
    return torch.softmax(x, dim=axis)
def _gelu(x):
    return torch.nn.functional.gelu(x, approximate="tanh")
def _silu(x):
    return torch.nn.functional.silu(x)
def _sigmoid(x):
    return torch.sigmoid(x)
def _layernorm(x, axis=-1, eps=1e-5):
    m = x.mean(dim=axis, keepdim=True)
    v = x.var(dim=axis, keepdim=True, unbiased=False)
    return (x - m) / torch.sqrt(v + eps)
def _scatter_add(tgt, idx, src, axis=0):
    return tgt.clone().index_add_(axis, idx, src)
def _segment_sum(src, seg, n):
    out = torch.zeros((n,) + src.shape[1:], dtype=src.dtype)
    return out.index_add_(0, seg, src)
def _pad(x, pw):
    flat = tuple(v for pair in reversed(pw) for v in pair)
    return torch.nn.functional.pad(x, flat)

kernel_name = 'interleave_layers__sliding_block__glu_gated_geglu__prompt'

def setup_inputs():

    _w = (lambda a: (lambda t: t.to(torch.bfloat16) if t.is_floating_point() else t)(torch.as_tensor(a)))
    def _A_setup():
        B, S, D = 1, 2048, 640
        return {
            "x": _w((lambda *s: torch.randn(*s, dtype=torch.bfloat16) * 0.05)(B, S, D)),
            "wqkv": _w((lambda *s: torch.randn(*s, dtype=torch.bfloat16) * 0.05)(D, 3 * D)),
            "wo": _w((lambda *s: torch.randn(*s, dtype=torch.bfloat16) * 0.05)(D, D)),
        }
    _A_in = _A_setup()

    def _B_setup():
        B, S, Dm, Df = 1, 2048, 640, 1728
        return {
            "x": _w((lambda *s: torch.randn(*s, dtype=torch.bfloat16) * 0.05)(B, S, Dm)),
            "w_gate": _w((lambda *s: torch.randn(*s, dtype=torch.bfloat16) * 0.8)(Dm, Df) * (Dm ** -0.5)),
            "w_up": _w((lambda *s: torch.randn(*s, dtype=torch.bfloat16) * 0.8)(Dm, Df) * (Dm ** -0.5)),
            "w_down": _w((lambda *s: torch.randn(*s, dtype=torch.bfloat16) * 0.8)(Df, Dm) * (Df ** -0.5)),
        }
    _B_in = _B_setup()

    return {
        "A_x": _A_in["x"],
        "A_wqkv": _A_in["wqkv"],
        "A_wo": _A_in["wo"],
        "B_x": _B_in["x"],
        "B_w_gate": _B_in["w_gate"],
        "B_w_up": _B_in["w_up"],
        "B_w_down": _B_in["w_down"],
    }

def reference(A_x, A_wqkv, A_wo, B_x, B_w_gate, B_w_up, B_w_down):
    def _A_ref(x, wqkv, wo):
        B, S, D = x.shape
        H = 32; Dh = D // H; W = 256
        qkv = (lambda x, *d: x.permute(*d))((x @ wqkv).reshape(B, S, 3, H, Dh), 2, 0, 3, 1, 4)
        q, k, v = qkv[0], qkv[1], qkv[2]
        scores = torch.einsum("bhqd,bhkd->bhqk", q, k) * (Dh ** -0.5)
        idx = torch.arange(S)
        mask = (idx[:, None] - idx[None, :] >= 0) & (idx[:, None] - idx[None, :] < W)
        scores = torch.where(mask[None, None], scores, -1e9)
        p = _softmax(scores, axis=-1)
        o = torch.einsum("bhqk,bhkd->bhqd", p, v)
        return (lambda x, *d: x.permute(*d))(o, 0, 2, 1, 3).reshape(B, S, D) @ wo

    def _B_ref(x, w_gate, w_up, w_down):
        g = torch.einsum("bsd,df->bsf", x, w_gate)
        u = torch.einsum("bsd,df->bsf", x, w_up)
        h = _gelu(g) * u
        return torch.einsum("bsf,fd->bsd", h, w_down)

    x = A_x
    x = x + _A_ref(_layernorm(x, axis=-1), A_wqkv, A_wo)
    x = x + _B_ref(_layernorm(x, axis=-1), B_w_gate, B_w_up, B_w_down)
    x = x + _A_ref(_layernorm(x, axis=-1), A_wqkv, A_wo)
    x = x + _B_ref(_layernorm(x, axis=-1), B_w_gate, B_w_up, B_w_down)
    return x
```

```asm
; @launch kernel=prep_kernel grid=(256,1,1) block=(256,1,1) lds=163840
; @launch kernel=main_kernel grid=(256,1,1) block=(256,1,1) lds=163840
.amdgcn_target "amdgcn-amd-amdhsa--gfx950"
.text
.globl prep_kernel
.p2align 8
.type prep_kernel,@function
prep_kernel:
  s_cmp_ge_u32 s2, 256
  s_cbranch_scc1 K1_END
  s_load_dwordx16 s[4:19], s[0:1], 0
  s_load_dwordx2 s[24:25], s[0:1], 72
  v_lshrrev_b32 v1, 6, v0
  v_and_b32 v0, 63, v0
  v_readfirstlane_b32 s3, v1
  v_and_b32 v2, 7, v0
  v_lshrrev_b32 v3, 3, v0
  s_sub_u32 s52, 255, s2
  s_lshl_b32 s52, s52, 2
  s_add_u32 s52, s52, s3
  s_and_b32 s53, s2, 7
  s_lshr_b32 s54, s2, 3
  s_cmp_ge_u32 s54, 15
  s_cselect_b32 s55, 1, 0
  s_cselect_b32 s56, 15, 0
  s_sub_u32 s56, s54, s56
  s_waitcnt lgkmcnt(0)
  s_mov_b32 s28, s24
  s_mov_b32 s29, s25
  s_mov_b32 s30, 62312448
  s_mov_b32 s31, 0x20000
  s_mov_b32 s23, 0x20000
  s_mov_b32 s20, s12
  s_mov_b32 s21, s13
  s_mov_b32 s22, 2211840
  s_mov_b32 s60, s4
  s_mov_b32 s61, s5
  s_mov_b32 s62, 2621440
  s_mov_b32 s63, 0x20000
  s_mov_b32 s64, s6
  s_mov_b32 s65, s7
  s_mov_b32 s66, 2457600
  s_mov_b32 s67, 0x20000
  v_lshlrev_b32 v1, 4, v0
  v_and_b32 v8, 31, v0
  v_lshrrev_b32 v9, 5, v0
  v_and_b32 v10, 15, v0
  v_lshrrev_b32 v11, 4, v0
  s_lshl_b32 s45, s3, 12
  s_lshl_b32 s36, s2, 2
  s_add_u32 s36, s36, s3
  v_lshlrev_b32 v4, 7, v0
  s_cmp_lt_u32 s36, 480
  s_cselect_b32 s96, s64, s60
  s_cselect_b32 s97, s65, s61
  s_cselect_b32 s98, s66, s62
  s_mov_b32 s99, 0x20000
  s_cselect_b32 s37, 0, 480
  s_sub_u32 s36, s36, s37
  s_mul_i32 s36, s36, 5120
  v_add_u32 v4, s36, v4
  s_mov_b32 exec_hi, 0xff
  buffer_load_dword v62, v4, s[96:99], 0 offen
  s_mov_b32 exec_hi, -1
  s_cmp_ge_u32 s54, 4
  s_cbranch_scc1 K1C_8
  s_getpc_b64 s[68:69]
K1_PC:
  s_sub_u32 s68, s68, K1_PC-prep_kernel
  s_subb_u32 s69, s69, 0
  s_and_b32 s36, s54, 1
  s_lshl_b32 s36, s36, 2
  s_add_u32 s36, s36, s3
  s_lshl_b32 s36, s36, 13
  v_lshl_add_u32 v16, v0, 7, s36
  v_min_u32 v16, MAIN_END-prep_kernel, v16
  global_load_dword v63, v16, s[68:69]
K1C_8:
  v_lshlrev_b32 v12, 2, v11
  v_xor_b32 v12, v12, v10
  v_lshlrev_b32 v12, 4, v12
  v_mul_u32_u24 v13, 3840, v11
  v_add_u32 v12, v12, v13
  s_lshl_b32 s44, s56, 8
  s_mul_i32 s46, s3, 61440
  s_add_u32 s44, s44, s46
  v_xor_b32 v13, v2, v11
  v_lshlrev_b32 v13, 4, v13
  v_mul_u32_u24 v14, 1280, v3
  v_add_u32 v13, v13, v14
  v_xor_b32 v14, 64, v13
  s_lshl_b32 s46, s53, 3
  s_lshl_b32 s47, s55, 2
  s_add_u32 s46, s46, s47
  s_add_u32 s46, s46, s3
  s_mul_i32 s47, s46, 40960
  s_mov_b32 s99, 0
  v_add_u32 v104, 0, v13
  v_add_u32 v108, 0, v12
  v_add_u32 v105, 9216, v14
  v_add_u32 v109, 14336, v12
  v_add_u32 v106, 18432, v13
  v_add_u32 v110, 28672, v12
  v_add_u32 v107, 27648, v14
  v_add_u32 v111, 43008, v12
  s_nop 2
  s_cmp_ge_u32 s54, 30
  s_cbranch_scc1 K1J_1
  s_add_u32 m0, s45, 0
  s_add_u32 s48, s44, 0
  buffer_load_dwordx4 v108, s[64:67], s48 offen lds
  buffer_load_dwordx4 v109, s[64:67], s48 offen offset:1024 lds
  buffer_load_dwordx4 v110, s[64:67], s48 offen offset:2048 lds
  buffer_load_dwordx4 v111, s[64:67], s48 offen offset:3072 lds
K1J_1:
  s_mov_b32 s35, 2
  v_mov_b32 v37, 0x40000000
  s_mov_b32 s90, 0
  s_mov_b32 s91, 0
  s_add_u32 s43, s45, 131072
  s_cmp_ge_u32 s52, 910
  s_cbranch_scc1 K1_6
  s_cmp_ge_u32 s52, 640
  s_cbranch_scc1 K1_4
  s_cmp_ge_u32 s52, 540
  s_cbranch_scc1 K1_3
  s_cmp_ge_u32 s52, 270
  s_cselect_b32 s20, s14, s12
  s_cselect_b32 s21, s15, s13
  s_cselect_b32 s39, 16, 0
  s_cselect_b32 s36, 270, 0
  s_sub_u32 s38, s52, s36
  s_mul_i32 s33, s38, 19
  s_lshr_b32 s33, s33, 9
  s_mul_i32 s36, s33, 27
  s_sub_u32 s34, s38, s36
  s_mov_b32 s32, 3456
  s_mov_b32 s35, 0
  s_branch K1_5
K1_3:
  s_sub_u32 s38, s52, 540
  s_mov_b32 s20, s8
  s_mov_b32 s21, s9
  s_mov_b32 s22, 819200
  s_mov_b32 s39, 102400
  s_mov_b32 s40, 7245824
  s_branch K1_7
K1_4:
  s_sub_u32 s38, s52, 640
  s_mov_b32 s20, s16
  s_mov_b32 s21, s17
  s_mov_b32 s39, 276480
  s_mov_b32 s40, 8065024
K1_7:
  s_mul_i32 s33, s38, 205
  s_lshr_b32 s33, s33, 11
  s_mul_i32 s36, s33, 10
  s_sub_u32 s34, s38, s36
  s_mov_b32 s32, 1280
  s_mov_b32 s35, 1
K1_5:
  v_bfe_u32 v4, v0, 4, 1
  v_lshlrev_b32 v4, 2, v4
  v_xor_b32 v4, v4, v2
  v_lshlrev_b32 v4, 4, v4
  v_mad_u32_u24 v37, v3, s32, v4
  s_lshl_b32 s91, s32, 3
  s_mul_i32 s90, s33, s91
  s_lshl_b32 s90, s90, 3
  s_lshl_b32 s36, s34, 7
  s_add_u32 s90, s90, s36
K1_6:
  v_mov_b32 v216, 0x3f803f80
  v_mov_b32 v217, 0x3f803f80
  v_and_b32 v17, 3, v0
  v_bfe_u32 v16, v0, 2, 2
  v_and_b32 v18, 1, v17
  v_lshlrev_b32 v18, 1, v18
  v_lshrrev_b32 v19, 1, v17
  v_or_b32 v18, v18, v19
  v_lshl_add_u32 v18, v11, 2, v18
  v_lshlrev_b32 v18, 3, v18
  v_lshrrev_b32 v19, 1, v16
  v_lshlrev_b32 v19, 6, v19
  v_xor_b32 v18, v18, v19
  v_lshl_add_u32 v18, v16, 7, v18
  v_add_u32 v15, s43, v18
  v_mov_b32 v6, 0x40000000
  v_mov_b32 v7, 0x40000000
  s_mov_b32 s42, 0
  s_cmp_eq_u32 s35, 2
  s_cbranch_scc1 K1Z_11
  s_cmp_eq_u32 s35, 1
  s_cbranch_scc1 K1D_10
  s_lshl_b32 s36, s34, 2
  s_add_u32 s36, s36, 60
  s_mul_i32 s40, s36, 40960
  s_lshl_b32 s37, s33, 12
  s_add_u32 s40, s40, s37
  s_lshl_b32 s37, s39, 4
  s_add_u32 s40, s40, s37
  s_add_u32 s40, s40, 147456
  v_mul_u32_u24 v6, 40960, v11
  v_lshl_add_u32 v6, v10, 4, v6
  s_movk_i32 s38, 512
  s_movk_i32 s41, 2048
  s_lshl_b32 s36, s36, 5
  s_add_u32 s36, s36, s39
  s_lshl_b32 s36, s36, 2
  s_mul_i32 s42, s33, 21504
  s_add_u32 s42, s42, s36
  s_add_u32 s42, s42, 7028736
  v_lshlrev_b32 v7, 7, v11
  v_lshl_add_u32 v7, v10, 2, v7
  s_nop 2
  s_branch K1Q_9
K1D_10:
  v_and_b32 v18, 1, v16
  v_lshlrev_b32 v18, 1, v18
  v_lshrrev_b32 v19, 1, v16
  v_or_b32 v18, v18, v19
  v_lshl_add_u32 v18, v11, 2, v18
  s_lshl_b32 s36, s34, 4
  v_add_u32 v18, s36, v18
  v_mul_u32_u24 v19, 103, v18
  v_lshrrev_b32 v19, 11, v19
  v_mul_u32_u24 v20, 20, v19
  v_sub_u32 v20, v18, v20
  v_lshrrev_b32 v21, 3, v20
  v_lshlrev_b32 v21, 11, v21
  v_and_b32 v22, 1, v20
  v_lshl_add_u32 v21, v22, 10, v21
  v_bfe_u32 v22, v20, 1, 2
  v_lshl_add_u32 v21, v22, 6, v21
  v_lshlrev_b32 v22, 6, v20
  v_add_u32 v22, 3072, v22
  v_cmp_gt_u32 vcc, 16, v20
  s_nop 1
  v_cndmask_b32 v21, v22, v21, vcc
  v_mul_lo_u32 v19, v19, s39
  v_lshl_add_u32 v21, v17, 4, v21
  v_add_u32 v6, v19, v21
  s_mul_i32 s36, s33, 10240
  s_add_u32 s40, s40, s36
  s_movk_i32 s38, 256
  s_movk_i32 s41, 5120
  v_mov_b32 v7, 0x40000000
  s_mov_b32 s42, 0
  s_nop 1
  s_branch K1Q_9
K1Z_11:
  s_sub_u32 s38, s52, 910
  v_mov_b32 v136, 0
  v_mov_b32 v137, 0
  v_mov_b32 v138, 0
  v_mov_b32 v139, 0
  s_cmp_ge_u32 s38, 49
  s_cbranch_scc1 K1Z_14
  s_cmp_eq_u32 s38, 48
  s_cbranch_scc1 K1Z_13
  s_lshl_b32 s39, s38, 12
  s_add_u32 s40, s39, 16384
  s_add_u32 s39, s39, 15454208
  s_cmp_lt_u32 s38, 16
  s_cselect_b32 s39, s40, s39
  buffer_store_dwordx4 v[136:139], v1, s[28:31], s39 offen offset:0
  buffer_store_dwordx4 v[136:139], v1, s[28:31], s39 offen offset:1024
  buffer_store_dwordx4 v[136:139], v1, s[28:31], s39 offen offset:2048
  buffer_store_dwordx4 v[136:139], v1, s[28:31], s39 offen offset:3072
  s_branch K1Z_14
K1Z_13:
  s_mov_b32 s36, 0
  buffer_store_dwordx4 v[136:139], v1, s[28:31], s36 offen
  s_mov_b32 s36, 1024
  buffer_store_dwordx4 v[136:139], v1, s[28:31], s36 offen
  s_mov_b32 s36, 2048
  buffer_store_dwordx4 v[136:139], v1, s[28:31], s36 offen
  s_mov_b32 s36, 3072
  buffer_store_dwordx4 v[136:139], v1, s[28:31], s36 offen
  s_mov_b32 s36, 4096
  buffer_store_dwordx4 v[136:139], v1, s[28:31], s36 offen
  s_mov_b32 s36, 5120
  buffer_store_dwordx4 v[136:139], v1, s[28:31], s36 offen
  s_mov_b32 s36, 6144
  buffer_store_dwordx4 v[136:139], v1, s[28:31], s36 offen
  s_mov_b32 s36, 7168
  buffer_store_dwordx4 v[136:139], v1, s[28:31], s36 offen
  s_mov_b32 s36, 8192
  buffer_store_dwordx4 v[136:139], v1, s[28:31], s36 offen
  s_mov_b32 s36, 9216
  buffer_store_dwordx4 v[136:139], v1, s[28:31], s36 offen
  s_mov_b32 s36, 10240
  buffer_store_dwordx4 v[136:139], v1, s[28:31], s36 offen
  s_mov_b32 s36, 11264
  buffer_store_dwordx4 v[136:139], v1, s[28:31], s36 offen
  s_mov_b32 s36, 12288
  buffer_store_dwordx4 v[136:139], v1, s[28:31], s36 offen
K1Z_14:
  s_mov_b32 s38, 0
  s_mov_b32 s40, 0
  s_mov_b32 s41, 0
K1Q_9:
  s_mov_b32 s86, s40
  s_cmp_ge_u32 s54, 30
  s_cbranch_scc1 K1I_2
  v_bfe_u32 v16, v0, 2, 2
  v_and_b32 v17, 3, v0
  v_and_b32 v18, 1, v17
  v_lshlrev_b32 v18, 1, v18
  v_lshrrev_b32 v19, 1, v17
  v_or_b32 v18, v18, v19
  s_cmp_ge_u32 s56, 10
  s_cselect_b64 vcc, -1, 0
  v_cndmask_b32 v18, v18, v17, vcc
  v_bfe_u32 v19, v0, 4, 1
  v_lshl_add_u32 v18, v19, 2, v18
  v_lshlrev_b32 v18, 3, v18
  v_lshl_add_u32 v19, v9, 3, v16
  v_lshl_add_u32 v18, v19, 8, v18
  s_add_u32 s36, s3, 0
  s_and_b32 s36, s36, 3
  s_mov_b32 s76, s36
  v_xor_b32 v19, s36, v16
  v_lshl_add_u32 v224, v19, 6, v18
  v_add_u32 v228, 0x10000, v224
  s_add_u32 s36, s3, 1
  s_and_b32 s36, s36, 3
  s_mov_b32 s77, s36
  v_xor_b32 v19, s36, v16
  v_lshl_add_u32 v225, v19, 6, v18
  v_add_u32 v229, 0x10000, v225
  s_add_u32 s36, s3, 2
  s_and_b32 s36, s36, 3
  s_mov_b32 s78, s36
  v_xor_b32 v19, s36, v16
  v_lshl_add_u32 v226, v19, 6, v18
  v_add_u32 v230, 0x10000, v226
  s_add_u32 s36, s3, 3
  s_and_b32 s36, s36, 3
  s_mov_b32 s79, s36
  v_xor_b32 v19, s36, v16
  v_lshl_add_u32 v227, v19, 6, v18
  v_add_u32 v231, 0x10000, v227
  v_bfe_u32 v19, v8, 1, 3
  v_xor_b32 v19, v19, v9
  v_lshlrev_b32 v19, 4, v19
  v_lshl_add_u32 v19, v8, 7, v19
  s_add_u32 s36, s45, 16384
  v_add_u32 v232, s36, v19
  v_xor_b32 v233, 32, v232
  v_xor_b32 v234, 64, v232
  v_xor_b32 v235, 96, v232
  v_add_u32 v236, 0x10000, v232
  v_add_u32 v237, 0x10000, v233
  v_add_u32 v238, 0x10000, v234
  v_add_u32 v239, 0x10000, v235
  v_mov_b32 v216, 0x3f803f80
  v_mov_b32 v217, 0x3f803f80
  s_lshl_b32 s57, s53, 1
  s_add_u32 s57, s57, s55
  s_lshl_b32 s58, s56, 2
  s_add_u32 s58, s58, s3
  s_mul_i32 s59, s58, 40960
  s_add_u32 s59, s59, 147456
  s_add_u32 s70, s47, 10276864
  s_cmp_ge_u32 s56, 10
  s_cbranch_scc1 K1V_16
  s_cmp_ge_u32 s56, 5
  s_cselect_b32 s36, 2580480, 0
  s_cselect_b32 s84, 0x3f800000, 0x3ea52b5c
  s_lshl_b32 s37, s56, 13
  s_add_u32 s36, s36, s37
  s_add_u32 s36, s36, s47
  s_add_u32 s36, s36, 15650816
  s_lshl_b32 s37, s76, 11
  s_add_u32 s80, s36, s37
  s_lshl_b32 s37, s77, 11
  s_add_u32 s81, s36, s37
  s_lshl_b32 s37, s78, 11
  s_add_u32 s82, s36, s37
  s_lshl_b32 s37, s79, 11
  s_add_u32 s83, s36, s37
  s_mov_b32 s89, s36
  v_lshlrev_b32 v220, 7, v0
  s_add_u32 m0, s45, 16384
  s_add_u32 s48, s47, 0
  buffer_load_dwordx4 v104, s[60:63], s48 offen lds
  buffer_load_dwordx4 v105, s[60:63], s48 offen offset:1024 lds
  buffer_load_dwordx4 v106, s[60:63], s48 offen offset:2048 lds
  buffer_load_dwordx4 v107, s[60:63], s48 offen offset:3072 lds
  s_add_u32 m0, s45, 32768
  s_add_u32 s48, s44, 245760
  buffer_load_dwordx4 v108, s[64:67], s48 offen lds
  buffer_load_dwordx4 v109, s[64:67], s48 offen offset:1024 lds
  buffer_load_dwordx4 v110, s[64:67], s48 offen offset:2048 lds
  buffer_load_dwordx4 v111, s[64:67], s48 offen offset:3072 lds
  s_add_u32 m0, s45, 49152
  s_add_u32 s48, s47, 128
  buffer_load_dwordx4 v104, s[60:63], s48 offen lds
  buffer_load_dwordx4 v105, s[60:63], s48 offen offset:1024 lds
  buffer_load_dwordx4 v106, s[60:63], s48 offen offset:2048 lds
  buffer_load_dwordx4 v107, s[60:63], s48 offen offset:3072 lds
  s_waitcnt vmcnt(8)
  s_barrier
  ds_read_b128 a[48:51], v232
  ds_read_b64_tr_b16 a[0:1], v224
  ds_read_b64_tr_b16 a[2:3], v224 offset:1024
  ds_read_b64_tr_b16 a[4:5], v225
  ds_read_b64_tr_b16 a[6:7], v225 offset:1024
  ds_read_b64_tr_b16 a[8:9], v226
  ds_read_b64_tr_b16 a[10:11], v226 offset:1024
  ds_read_b64_tr_b16 a[12:13], v227
  ds_read_b64_tr_b16 a[14:15], v227 offset:1024
  ds_read_b128 a[52:55], v233
  ds_read_b64_tr_b16 a[16:17], v224 offset:4096
  ds_read_b64_tr_b16 a[18:19], v224 offset:5120
  ds_read_b64_tr_b16 a[20:21], v225 offset:4096
  ds_read_b64_tr_b16 a[22:23], v225 offset:5120
  ds_read_b64_tr_b16 a[24:25], v226 offset:4096
  ds_read_b64_tr_b16 a[26:27], v226 offset:5120
  ds_read_b64_tr_b16 a[28:29], v227 offset:4096
  ds_read_b64_tr_b16 a[30:31], v227 offset:5120
  s_waitcnt lgkmcnt(9)
  v_mfma_f32_32x32x16_bf16 v[128:143], a[0:3], a[48:51], 0
  ds_read_b128 a[56:59], v234
  ds_read_b64_tr_b16 a[32:33], v224 offset:8192
  ds_read_b64_tr_b16 a[34:35], v224 offset:9216
  s_add_u32 m0, s45, 65536
  s_add_u32 s48, s44, 491520
  buffer_load_dwordx4 v108, s[64:67], s48 offen lds
  buffer_load_dwordx4 v109, s[64:67], s48 offen offset:1024 lds
  v_mfma_f32_32x32x16_bf16 v[144:159], a[4:7], a[48:51], 0
  ds_read_b64_tr_b16 a[36:37], v225 offset:8192
  ds_read_b64_tr_b16 a[38:39], v225 offset:9216
  buffer_load_dwordx4 v110, s[64:67], s48 offen offset:2048 lds
  buffer_load_dwordx4 v111, s[64:67], s48 offen offset:3072 lds
  v_mfma_f32_32x32x16_bf16 v[160:175], a[8:11], a[48:51], 0
  ds_read_b64_tr_b16 a[40:41], v226 offset:8192
  ds_read_b64_tr_b16 a[42:43], v226 offset:9216
  s_add_u32 m0, s45, 81920
  s_add_u32 s48, s47, 256
  buffer_load_dwordx4 v104, s[60:63], s48 offen lds
  buffer_load_dwordx4 v105, s[60:63], s48 offen offset:1024 lds
  v_mfma_f32_32x32x16_bf16 v[176:191], a[12:15], a[48:51], 0
  ds_read_b64_tr_b16 a[44:45], v227 offset:8192
  ds_read_b64_tr_b16 a[46:47], v227 offset:9216
  buffer_load_dwordx4 v106, s[60:63], s48 offen offset:2048 lds
  buffer_load_dwordx4 v107, s[60:63], s48 offen offset:3072 lds
  s_lshl_b32 s88, s99, 2
  s_sub_u32 s71, s57, s88
  s_and_b32 s71, s71, 15
  s_cmp_ge_u32 s71, 4
  s_cbranch_scc1 CW_17
  s_lshl_b32 s85, s71, 12
  s_add_u32 s85, s85, 0
  v_add_u32 v36, s85, v224
  s_add_u32 s71, s71, s88
  s_lshl_b32 s71, s71, 10
  s_add_u32 s71, s71, s59
  ds_read_b64_tr_b16 a[64:65], v36
  ds_read_b64_tr_b16 a[66:67], v36 offset:1024
  s_waitcnt lgkmcnt(0)
  buffer_store_dwordx4 a[64:67], v1, s[28:31], s71 offen sc1
CW_17:
  s_cmp_lg_u32 s99, s56
  s_cbranch_scc1 CX_18
  s_lshl_b32 s71, s99, 12
  s_add_u32 s71, s71, s70
  ds_read_b128 a[68:71], v232
  ds_read_b128 a[72:75], v233
  ds_read_b128 a[76:79], v234
  ds_read_b128 a[80:83], v235
  s_waitcnt lgkmcnt(0)
  buffer_store_dwordx4 a[68:71], v1, s[28:31], s71 offen sc1
  buffer_store_dwordx4 a[72:75], v1, s[28:31], s71 offen offset:1024 sc1
  buffer_store_dwordx4 a[76:79], v1, s[28:31], s71 offen offset:2048 sc1
  buffer_store_dwordx4 a[80:83], v1, s[28:31], s71 offen offset:3072 sc1
CX_18:
  v_mfma_f32_4x4x4_16b_bf16 v[208:211], v[216:217], a[0:1], 0
  v_mfma_f32_4x4x4_16b_bf16 v[212:215], v[216:217], a[2:3], 0
  v_mfma_f32_4x4x4_16b_bf16 v[192:195], a[48:49], a[48:49], 0
  v_mfma_f32_4x4x4_16b_bf16 v[196:199], a[50:51], a[50:51], 0
  v_mfma_f32_4x4x4_16b_bf16 v[200:203], v[216:217], a[48:49], 0
  v_mfma_f32_4x4x4_16b_bf16 v[204:207], v[216:217], a[50:51], 0
  s_waitcnt lgkmcnt(9)
  v_mfma_f32_32x32x16_bf16 v[128:143], a[16:19], a[52:55], v[128:143]
  ds_read_b128 a[48:51], v235
  ds_read_b64_tr_b16 a[0:1], v224 offset:12288
  ds_read_b64_tr_b16 a[2:3], v224 offset:13312
  s_add_u32 m0, s45, 98304
  s_add_u32 s48, s44, 737280
  buffer_load_dwordx4 v108, s[64:67], s48 offen lds
  buffer_load_dwordx4 v109, s[64:67], s48 offen offset:1024 lds
  v_mfma_f32_32x32x16_bf16 v[144:159], a[20:23], a[52:55], v[144:159]
  ds_read_b64_tr_b16 a[4:5], v225 offset:12288
  ds_read_b64_tr_b16 a[6:7], v225 offset:13312
  buffer_load_dwordx4 v110, s[64:67], s48 offen offset:2048 lds
  buffer_load_dwordx4 v111, s[64:67], s48 offen offset:3072 lds
  v_mfma_f32_32x32x16_bf16 v[160:175], a[24:27], a[52:55], v[160:175]
  ds_read_b64_tr_b16 a[8:9], v226 offset:12288
  ds_read_b64_tr_b16 a[10:11], v226 offset:13312
  s_add_u32 m0, s45, 114688
  s_add_u32 s48, s47, 384
  buffer_load_dwordx4 v104, s[60:63], s48 offen lds
  buffer_load_dwordx4 v105, s[60:63], s48 offen offset:1024 lds
  v_mfma_f32_32x32x16_bf16 v[176:191], a[28:31], a[52:55], v[176:191]
  ds_read_b64_tr_b16 a[12:13], v227 offset:12288
  ds_read_b64_tr_b16 a[14:15], v227 offset:13312
  buffer_load_dwordx4 v106, s[60:63], s48 offen offset:2048 lds
  buffer_load_dwordx4 v107, s[60:63], s48 offen offset:3072 lds
  v_mfma_f32_4x4x4_16b_bf16 v[208:211], v[216:217], a[16:17], v[208:211]
  v_mfma_f32_4x4x4_16b_bf16 v[212:215], v[216:217], a[18:19], v[212:215]
  v_mfma_f32_4x4x4_16b_bf16 v[192:195], a[52:53], a[52:53], v[192:195]
  v_mfma_f32_4x4x4_16b_bf16 v[196:199], a[54:55], a[54:55], v[196:199]
  v_mfma_f32_4x4x4_16b_bf16 v[200:203], v[216:217], a[52:53], v[200:203]
  v_mfma_f32_4x4x4_16b_bf16 v[204:207], v[216:217], a[54:55], v[204:207]
  s_waitcnt lgkmcnt(9)
  v_mfma_f32_32x32x16_bf16 v[128:143], a[32:35], a[56:59], v[128:143]
  s_waitcnt vmcnt(16)
  s_waitcnt lgkmcnt(0)
  s_barrier
  ds_read_b128 a[52:55], v232 offset:32768
  ds_read_b64_tr_b16 a[16:17], v224 offset:32768
  ds_read_b64_tr_b16 a[18:19], v224 offset:33792
  s_add_u32 m0, s45, 0
  s_add_u32 s48, s44, 983040
  buffer_load_dwordx4 v108, s[64:67], s48 offen lds
  v_mfma_f32_32x32x16_bf16 v[144:159], a[36:39], a[56:59], v[144:159]
  ds_read_b64_tr_b16 a[20:21], v225 offset:32768
  ds_read_b64_tr_b16 a[22:23], v225 offset:33792
  buffer_load_dwordx4 v109, s[64:67], s48 offen offset:1024 lds
  v_mfma_f32_32x32x16_bf16 v[160:175], a[40:43], a[56:59], v[160:175]
  ds_read_b64_tr_b16 a[24:25], v226 offset:32768
  ds_read_b64_tr_b16 a[26:27], v226 offset:33792
  buffer_load_dwordx4 v110, s[64:67], s48 offen offset:2048 lds
  v_mfma_f32_32x32x16_bf16 v[176:191], a[44:47], a[56:59], v[176:191]
  ds_read_b64_tr_b16 a[28:29], v227 offset:32768
  ds_read_b64_tr_b16 a[30:31], v227 offset:33792
  buffer_load_dwordx4 v111, s[64:67], s48 offen offset:3072 lds
  v_mfma_f32_4x4x4_16b_bf16 v[208:211], v[216:217], a[32:33], v[208:211]
  v_mfma_f32_4x4x4_16b_bf16 v[212:215], v[216:217], a[34:35], v[212:215]
  v_mfma_f32_4x4x4_16b_bf16 v[192:195], a[56:57], a[56:57], v[192:195]
  v_mfma_f32_4x4x4_16b_bf16 v[196:199], a[58:59], a[58:59], v[196:199]
  v_mfma_f32_4x4x4_16b_bf16 v[200:203], v[216:217], a[56:57], v[200:203]
  v_mfma_f32_4x4x4_16b_bf16 v[204:207], v[216:217], a[58:59], v[204:207]
  v_mfma_f32_32x32x16_bf16 v[128:143], a[0:3], a[48:51], v[128:143]
  ds_read_b128 a[56:59], v233 offset:32768
  ds_read_b64_tr_b16 a[32:33], v224 offset:36864
  ds_read_b64_tr_b16 a[34:35], v224 offset:37888
  s_add_u32 m0, s45, 16384
  s_add_u32 s48, s47, 512
  buffer_load_dwordx4 v104, s[60:63], s48 offen lds
  v_mfma_f32_32x32x16_bf16 v[144:159], a[4:7], a[48:51], v[144:159]
  ds_read_b64_tr_b16 a[36:37], v225 offset:36864
  ds_read_b64_tr_b16 a[38:39], v225 offset:37888
  buffer_load_dwordx4 v105, s[60:63], s48 offen offset:1024 lds
  v_mfma_f32_32x32x16_bf16 v[160:175], a[8:11], a[48:51], v[160:175]
  ds_read_b64_tr_b16 a[40:41], v226 offset:36864
  ds_read_b64_tr_b16 a[42:43], v226 offset:37888
  buffer_load_dwordx4 v106, s[60:63], s48 offen offset:2048 lds
  v_mfma_f32_32x32x16_bf16 v[176:191], a[12:15], a[48:51], v[176:191]
  ds_read_b64_tr_b16 a[44:45], v227 offset:36864
  ds_read_b64_tr_b16 a[46:47], v227 offset:37888
  buffer_load_dwordx4 v107, s[60:63], s48 offen offset:3072 lds
  v_mfma_f32_4x4x4_16b_bf16 v[208:211], v[216:217], a[0:1], v[208:211]
  v_mfma_f32_4x4x4_16b_bf16 v[212:215], v[216:217], a[2:3], v[212:215]
  v_mfma_f32_4x4x4_16b_bf16 v[192:195], a[48:49], a[48:49], v[192:195]
  v_mfma_f32_4x4x4_16b_bf16 v[196:199], a[50:51], a[50:51], v[196:199]
  v_mfma_f32_4x4x4_16b_bf16 v[200:203], v[216:217], a[48:49], v[200:203]
  v_mfma_f32_4x4x4_16b_bf16 v[204:207], v[216:217], a[50:51], v[204:207]
  s_waitcnt lgkmcnt(9)
  v_mfma_f32_32x32x16_bf16 v[128:143], a[16:19], a[52:55], v[128:143]
  ds_read_b128 a[48:51], v234 offset:32768
  ds_read_b64_tr_b16 a[0:1], v224 offset:40960
  ds_read_b64_tr_b16 a[2:3], v224 offset:41984
  s_add_u32 m0, s43, 0
  s_mul_i32 s87, s91, 0
  s_add_u32 s87, s87, s90
  buffer_load_dwordx4 v37, s[20:23], s87 offen nt lds
  v_mfma_f32_32x32x16_bf16 v[144:159], a[20:23], a[52:55], v[144:159]
  ds_read_b64_tr_b16 a[4:5], v225 offset:40960
  ds_read_b64_tr_b16 a[6:7], v225 offset:41984
  v_mfma_f32_32x32x16_bf16 v[160:175], a[24:27], a[52:55], v[160:175]
  ds_read_b64_tr_b16 a[8:9], v226 offset:40960
  ds_read_b64_tr_b16 a[10:11], v226 offset:41984
  v_mfma_f32_32x32x16_bf16 v[176:191], a[28:31], a[52:55], v[176:191]
  ds_read_b64_tr_b16 a[12:13], v227 offset:40960
  ds_read_b64_tr_b16 a[14:15], v227 offset:41984
  s_add_u32 s99, s99, 1
  s_cmp_eq_u32 s99, 10
  s_cselect_b32 s99, 0, s99
  s_lshl_b32 s88, s99, 2
  s_sub_u32 s71, s57, s88
  s_and_b32 s71, s71, 15
  s_cmp_ge_u32 s71, 4
  s_cbranch_scc1 CW_19
  s_lshl_b32 s85, s71, 12
  s_add_u32 s85, s85, 32768
  v_add_u32 v36, s85, v224
  s_add_u32 s71, s71, s88
  s_lshl_b32 s71, s71, 10
  s_add_u32 s71, s71, s59
  ds_read_b64_tr_b16 a[64:65], v36
  ds_read_b64_tr_b16 a[66:67], v36 offset:1024
  s_waitcnt lgkmcnt(0)
  buffer_store_dwordx4 a[64:67], v1, s[28:31], s71 offen sc1
CW_19:
  s_cmp_lg_u32 s99, s56
  s_cbranch_scc1 CX_20
  s_lshl_b32 s71, s99, 12
  s_add_u32 s71, s71, s70
  ds_read_b128 a[68:71], v232 offset:32768
  ds_read_b128 a[72:75], v233 offset:32768
  ds_read_b128 a[76:79], v234 offset:32768
  ds_read_b128 a[80:83], v235 offset:32768
  s_waitcnt lgkmcnt(0)
  buffer_store_dwordx4 a[68:71], v1, s[28:31], s71 offen sc1
  buffer_store_dwordx4 a[72:75], v1, s[28:31], s71 offen offset:1024 sc1
  buffer_store_dwordx4 a[76:79], v1, s[28:31], s71 offen offset:2048 sc1
  buffer_store_dwordx4 a[80:83], v1, s[28:31], s71 offen offset:3072 sc1
CX_20:
  v_mfma_f32_4x4x4_16b_bf16 v[208:211], v[216:217], a[16:17], v[208:211]
  v_mfma_f32_4x4x4_16b_bf16 v[212:215], v[216:217], a[18:19], v[212:215]
  v_mfma_f32_4x4x4_16b_bf16 v[192:195], a[52:53], a[52:53], v[192:195]
  v_mfma_f32_4x4x4_16b_bf16 v[196:199], a[54:55], a[54:55], v[196:199]
  v_mfma_f32_4x4x4_16b_bf16 v[200:203], v[216:217], a[52:53], v[200:203]
  v_mfma_f32_4x4x4_16b_bf16 v[204:207], v[216:217], a[54:55], v[204:207]
  s_waitcnt lgkmcnt(9)
  v_mfma_f32_32x32x16_bf16 v[128:143], a[32:35], a[56:59], v[128:143]
  ds_read_b128 a[52:55], v235 offset:32768
  ds_read_b64_tr_b16 a[16:17], v224 offset:45056
  ds_read_b64_tr_b16 a[18:19], v224 offset:46080
  s_add_u32 m0, s43, 1024
  s_mul_i32 s87, s91, 1
  s_add_u32 s87, s87, s90
  buffer_load_dwordx4 v37, s[20:23], s87 offen nt lds
  v_mfma_f32_32x32x16_bf16 v[144:159], a[36:39], a[56:59], v[144:159]
  ds_read_b64_tr_b16 a[20:21], v225 offset:45056
  ds_read_b64_tr_b16 a[22:23], v225 offset:46080
  v_mfma_f32_32x32x16_bf16 v[160:175], a[40:43], a[56:59], v[160:175]
  ds_read_b64_tr_b16 a[24:25], v226 offset:45056
  ds_read_b64_tr_b16 a[26:27], v226 offset:46080
  v_mfma_f32_32x32x16_bf16 v[176:191], a[44:47], a[56:59], v[176:191]
  ds_read_b64_tr_b16 a[28:29], v227 offset:45056
  ds_read_b64_tr_b16 a[30:31], v227 offset:46080
  v_mfma_f32_4x4x4_16b_bf16 v[208:211], v[216:217], a[32:33], v[208:211]
  v_mfma_f32_4x4x4_16b_bf16 v[212:215], v[216:217], a[34:35], v[212:215]
  v_mfma_f32_4x4x4_16b_bf16 v[192:195], a[56:57], a[56:57], v[192:195]
  v_mfma_f32_4x4x4_16b_bf16 v[196:199], a[58:59], a[58:59], v[196:199]
  v_mfma_f32_4x4x4_16b_bf16 v[200:203], v[216:217], a[56:57], v[200:203]
  v_mfma_f32_4x4x4_16b_bf16 v[204:207], v[216:217], a[58:59], v[204:207]
  s_waitcnt lgkmcnt(9)
  v_mfma_f32_32x32x16_bf16 v[128:143], a[0:3], a[48:51], v[128:143]
  s_waitcnt vmcnt(18)
  s_waitcnt lgkmcnt(0)
  s_barrier
  ds_read_b128 a[56:59], v236
  ds_read_b64_tr_b16 a[32:33], v228
  ds_read_b64_tr_b16 a[34:35], v228 offset:1024
  s_add_u32 m0, s45, 32768
  s_add_u32 s48, s44, 1228800
  buffer_load_dwordx4 v108, s[64:67], s48 offen lds
  v_mfma_f32_32x32x16_bf16 v[144:159], a[4:7], a[48:51], v[144:159]
  ds_read_b64_tr_b16 a[36:37], v229
  ds_read_b64_tr_b16 a[38:39], v229 offset:1024
  buffer_load_dwordx4 v109, s[64:67], s48 offen offset:1024 lds
  v_mfma_f32_32x32x16_bf16 v[160:175], a[8:11], a[48:51], v[160:175]
  ds_read_b64_tr_b16 a[40:41], v230
  ds_read_b64_tr_b16 a[42:43], v230 offset:1024
  buffer_load_dwordx4 v110, s[64:67], s48 offen offset:2048 lds
  v_mfma_f32_32x32x16_bf16 v[176:191], a[12:15], a[48:51], v[176:191]
  ds_read_b64_tr_b16 a[44:45], v231
  ds_read_b64_tr_b16 a[46:47], v231 offset:1024
  buffer_load_dwordx4 v111, s[64:67], s48 offen offset:3072 lds
  v_mfma_f32_4x4x4_16b_bf16 v[208:211], v[216:217], a[0:1], v[208:211]
  v_mfma_f32_4x4x4_16b_bf16 v[212:215], v[216:217], a[2:3], v[212:215]
  v_mfma_f32_4x4x4_16b_bf16 v[192:195], a[48:49], a[48:49], v[192:195]
  v_mfma_f32_4x4x4_16b_bf16 v[196:199], a[50:51], a[50:51], v[196:199]
  v_mfma_f32_4x4x4_16b_bf16 v[200:203], v[216:217], a[48:49], v[200:203]
  v_mfma_f32_4x4x4_16b_bf16 v[204:207], v[216:217], a[50:51], v[204:207]
  v_mfma_f32_32x32x16_bf16 v[128:143], a[16:19], a[52:55], v[128:143]
  ds_read_b128 a[48:51], v237
  ds_read_b64_tr_b16 a[0:1], v228 offset:4096
  ds_read_b64_tr_b16 a[2:3], v228 offset:5120
  s_add_u32 m0, s45, 49152
  s_add_u32 s48, s47, 640
  buffer_load_dwordx4 v104, s[60:63], s48 offen lds
  v_mfma_f32_32x32x16_bf16 v[144:159], a[20:23], a[52:55], v[144:159]
  ds_read_b64_tr_b16 a[4:5], v229 offset:4096
  ds_read_b64_tr_b16 a[6:7], v229 offset:5120
  buffer_load_dwordx4 v105, s[60:63], s48 offen offset:1024 lds
  v_mfma_f32_32x32x16_bf16 v[160:175], a[24:27], a[52:55], v[160:175]
  ds_read_b64_tr_b16 a[8:9], v230 offset:4096
  ds_read_b64_tr_b16 a[10:11], v230 offset:5120
  buffer_load_dwordx4 v106, s[60:63], s48 offen offset:2048 lds
  v_mfma_f32_32x32x16_bf16 v[176:191], a[28:31], a[52:55], v[176:191]
  ds_read_b64_tr_b16 a[12:13], v231 offset:4096
  ds_read_b64_tr_b16 a[14:15], v231 offset:5120
  buffer_load_dwordx4 v107, s[60:63], s48 offen offset:3072 lds
  v_mfma_f32_4x4x4_16b_bf16 v[208:211], v[216:217], a[16:17], v[208:211]
  v_mfma_f32_4x4x4_16b_bf16 v[212:215], v[216:217], a[18:19], v[212:215]
  v_mfma_f32_4x4x4_16b_bf16 v[192:195], a[52:53], a[52:53], v[192:195]
  v_mfma_f32_4x4x4_16b_bf16 v[196:199], a[54:55], a[54:55], v[196:199]
  v_mfma_f32_4x4x4_16b_bf16 v[200:203], v[216:217], a[52:53], v[200:203]
  v_mfma_f32_4x4x4_16b_bf16 v[204:207], v[216:217], a[54:55], v[204:207]
  s_waitcnt lgkmcnt(9)
  v_mfma_f32_32x32x16_bf16 v[128:143], a[32:35], a[56:59], v[128:143]
  ds_read_b128 a[52:55], v238
  ds_read_b64_tr_b16 a[16:17], v228 offset:8192
  ds_read_b64_tr_b16 a[18:19], v228 offset:9216
  s_add_u32 m0, s43, 2048
  s_mul_i32 s87, s91, 2
  s_add_u32 s87, s87, s90
  buffer_load_dwordx4 v37, s[20:23], s87 offen nt lds
  v_mfma_f32_32x32x16_bf16 v[144:159], a[36:39], a[56:59], v[144:159]
  ds_read_b64_tr_b16 a[20:21], v229 offset:8192
  ds_read_b64_tr_b16 a[22:23], v229 offset:9216
  v_mfma_f32_32x32x16_bf16 v[160:175], a[40:43], a[56:59], v[160:175]
  ds_read_b64_tr_b16 a[24:25], v230 offset:8192
  ds_read_b64_tr_b16 a[26:27], v230 offset:9216
  v_mfma_f32_32x32x16_bf16 v[176:191], a[44:47], a[56:59], v[176:191]
  ds_read_b64_tr_b16 a[28:29], v231 offset:8192
  ds_read_b64_tr_b16 a[30:31], v231 offset:9216
  s_add_u32 s99, s99, 1
  s_cmp_eq_u32 s99, 10
  s_cselect_b32 s99, 0, s99
  s_lshl_b32 s88, s99, 2
  s_sub_u32 s71, s57, s88
  s_and_b32 s71, s71, 15
  s_cmp_ge_u32 s71, 4
  s_cbranch_scc1 CW_21
  s_lshl_b32 s85, s71, 12
  s_add_u32 s85, s85, 65536
  v_add_u32 v36, s85, v224
  s_add_u32 s71, s71, s88
  s_lshl_b32 s71, s71, 10
  s_add_u32 s71, s71, s59
  ds_read_b64_tr_b16 a[64:65], v36
  ds_read_b64_tr_b16 a[66:67], v36 offset:1024
  s_waitcnt lgkmcnt(0)
  buffer_store_dwordx4 a[64:67], v1, s[28:31], s71 offen sc1
CW_21:
  s_cmp_lg_u32 s99, s56
  s_cbranch_scc1 CX_22
  s_lshl_b32 s71, s99, 12
  s_add_u32 s71, s71, s70
  ds_read_b128 a[68:71], v236
  ds_read_b128 a[72:75], v237
  ds_read_b128 a[76:79], v238
  ds_read_b128 a[80:83], v239
  s_waitcnt lgkmcnt(0)
  buffer_store_dwordx4 a[68:71], v1, s[28:31], s71 offen sc1
  buffer_store_dwordx4 a[72:75], v1, s[28:31], s71 offen offset:1024 sc1
  buffer_store_dwordx4 a[76:79], v1, s[28:31], s71 offen offset:2048 sc1
  buffer_store_dwordx4 a[80:83], v1, s[28:31], s71 offen offset:3072 sc1
CX_22:
  v_mfma_f32_4x4x4_16b_bf16 v[208:211], v[216:217], a[32:33], v[208:211]
  v_mfma_f32_4x4x4_16b_bf16 v[212:215], v[216:217], a[34:35], v[212:215]
  v_mfma_f32_4x4x4_16b_bf16 v[192:195], a[56:57], a[56:57], v[192:195]
  v_mfma_f32_4x4x4_16b_bf16 v[196:199], a[58:59], a[58:59], v[196:199]
  v_mfma_f32_4x4x4_16b_bf16 v[200:203], v[216:217], a[56:57], v[200:203]
  v_mfma_f32_4x4x4_16b_bf16 v[204:207], v[216:217], a[58:59], v[204:207]
  s_waitcnt lgkmcnt(9)
  v_mfma_f32_32x32x16_bf16 v[128:143], a[0:3], a[48:51], v[128:143]
  ds_read_b128 a[56:59], v239
  ds_read_b64_tr_b16 a[32:33], v228 offset:12288
  ds_read_b64_tr_b16 a[34:35], v228 offset:13312
  s_add_u32 m0, s43, 3072
  s_mul_i32 s87, s91, 3
  s_add_u32 s87, s87, s90
  buffer_load_dwordx4 v37, s[20:23], s87 offen nt lds
  v_mfma_f32_32x32x16_bf16 v[144:159], a[4:7], a[48:51], v[144:159]
  ds_read_b64_tr_b16 a[36:37], v229 offset:12288
  ds_read_b64_tr_b16 a[38:39], v229 offset:13312
  v_mfma_f32_32x32x16_bf16 v[160:175], a[8:11], a[48:51], v[160:175]
  ds_read_b64_tr_b16 a[40:41], v230 offset:12288
  ds_read_b64_tr_b16 a[42:43], v230 offset:13312
  v_mfma_f32_32x32x16_bf16 v[176:191], a[12:15], a[48:51], v[176:191]
  ds_read_b64_tr_b16 a[44:45], v231 offset:12288
  ds_read_b64_tr_b16 a[46:47], v231 offset:13312
  v_mfma_f32_4x4x4_16b_bf16 v[208:211], v[216:217], a[0:1], v[208:211]
  v_mfma_f32_4x4x4_16b_bf16 v[212:215], v[216:217], a[2:3], v[212:215]
  v_mfma_f32_4x4x4_16b_bf16 v[192:195], a[48:49], a[48:49], v[192:195]
  v_mfma_f32_4x4x4_16b_bf16 v[196:199], a[50:51], a[50:51], v[196:199]
  v_mfma_f32_4x4x4_16b_bf16 v[200:203], v[216:217], a[48:49], v[200:203]
  v_mfma_f32_4x4x4_16b_bf16 v[204:207], v[216:217], a[50:51], v[204:207]
  s_waitcnt lgkmcnt(9)
  v_mfma_f32_32x32x16_bf16 v[128:143], a[16:19], a[52:55], v[128:143]
  s_waitcnt vmcnt(20)
  s_waitcnt lgkmcnt(0)
  s_barrier
  ds_read_b128 a[48:51], v236 offset:32768
  ds_read_b64_tr_b16 a[0:1], v228 offset:32768
  ds_read_b64_tr_b16 a[2:3], v228 offset:33792
  s_add_u32 m0, s45, 65536
  s_add_u32 s48, s44, 1474560
  buffer_load_dwordx4 v108, s[64:67], s48 offen lds
  v_mfma_f32_32x32x16_bf16 v[144:159], a[20:23], a[52:55], v[144:159]
  ds_read_b64_tr_b16 a[4:5], v229 offset:32768
  ds_read_b64_tr_b16 a[6:7], v229 offset:33792
  buffer_load_dwordx4 v109, s[64:67], s48 offen offset:1024 lds
  v_mfma_f32_32x32x16_bf16 v[160:175], a[24:27], a[52:55], v[160:175]
  ds_read_b64_tr_b16 a[8:9], v230 offset:32768
  ds_read_b64_tr_b16 a[10:11], v230 offset:33792
  buffer_load_dwordx4 v110, s[64:67], s48 offen offset:2048 lds
  v_mfma_f32_32x32x16_bf16 v[176:191], a[28:31], a[52:55], v[176:191]
  ds_read_b64_tr_b16 a[12:13], v231 offset:32768
  ds_read_b64_tr_b16 a[14:15], v231 offset:33792
  buffer_load_dwordx4 v111, s[64:67], s48 offen offset:3072 lds
  v_mfma_f32_4x4x4_16b_bf16 v[208:211], v[216:217], a[16:17], v[208:211]
  v_mfma_f32_4x4x4_16b_bf16 v[212:215], v[216:217], a[18:19], v[212:215]
  v_mfma_f32_4x4x4_16b_bf16 v[192:195], a[52:53], a[52:53], v[192:195]
  v_mfma_f32_4x4x4_16b_bf16 v[196:199], a[54:55], a[54:55], v[196:199]
  v_mfma_f32_4x4x4_16b_bf16 v[200:203], v[216:217], a[52:53], v[200:203]
  v_mfma_f32_4x4x4_16b_bf16 v[204:207], v[216:217], a[54:55], v[204:207]
  v_mfma_f32_32x32x16_bf16 v[128:143], a[32:35], a[56:59], v[128:143]
  ds_read_b128 a[52:55], v237 offset:32768
  ds_read_b64_tr_b16 a[16:17], v228 offset:36864
  ds_read_b64_tr_b16 a[18:19], v228 offset:37888
  s_add_u32 m0, s45, 81920
  s_add_u32 s48, s47, 768
  buffer_load_dwordx4 v104, s[60:63], s48 offen lds
  v_mfma_f32_32x32x16_bf16 v[144:159], a[36:39], a[56:59], v[144:159]
  ds_read_b64_tr_b16 a[20:21], v229 offset:36864
  ds_read_b64_tr_b16 a[22:23], v229 offset:37888
  buffer_load_dwordx4 v105, s[60:63], s48 offen offset:1024 lds
  v_mfma_f32_32x32x16_bf16 v[160:175], a[40:43], a[56:59], v[160:175]
  ds_read_b64_tr_b16 a[24:25], v230 offset:36864
  ds_read_b64_tr_b16 a[26:27], v230 offset:37888
  buffer_load_dwordx4 v106, s[60:63], s48 offen offset:2048 lds
  v_mfma_f32_32x32x16_bf16 v[176:191], a[44:47], a[56:59], v[176:191]
  ds_read_b64_tr_b16 a[28:29], v231 offset:36864
  ds_read_b64_tr_b16 a[30:31], v231 offset:37888
  buffer_load_dwordx4 v107, s[60:63], s48 offen offset:3072 lds
  v_mfma_f32_4x4x4_16b_bf16 v[208:211], v[216:217], a[32:33], v[208:211]
  v_mfma_f32_4x4x4_16b_bf16 v[212:215], v[216:217], a[34:35], v[212:215]
  v_mfma_f32_4x4x4_16b_bf16 v[192:195], a[56:57], a[56:57], v[192:195]
  v_mfma_f32_4x4x4_16b_bf16 v[196:199], a[58:59], a[58:59], v[196:199]
  v_mfma_f32_4x4x4_16b_bf16 v[200:203], v[216:217], a[56:57], v[200:203]
  v_mfma_f32_4x4x4_16b_bf16 v[204:207], v[216:217], a[58:59], v[204:207]
  s_waitcnt lgkmcnt(9)
  v_mfma_f32_32x32x16_bf16 v[128:143], a[0:3], a[48:51], v[128:143]
  ds_read_b128 a[56:59], v238 offset:32768
  ds_read_b64_tr_b16 a[32:33], v228 offset:40960
  ds_read_b64_tr_b16 a[34:35], v228 offset:41984
  v_mfma_f32_32x32x16_bf16 v[144:159], a[4:7], a[48:51], v[144:159]
  ds_read_b64_tr_b16 a[36:37], v229 offset:40960
  ds_read_b64_tr_b16 a[38:39], v229 offset:41984
  v_mfma_f32_32x32x16_bf16 v[160:175], a[8:11], a[48:51], v[160:175]
  ds_read_b64_tr_b16 a[40:41], v230 offset:40960
  ds_read_b64_tr_b16 a[42:43], v230 offset:41984
  v_mfma_f32_32x32x16_bf16 v[176:191], a[12:15], a[48:51], v[176:191]
  ds_read_b64_tr_b16 a[44:45], v231 offset:40960
  ds_read_b64_tr_b16 a[46:47], v231 offset:41984
  s_add_u32 s99, s99, 1
  s_cmp_eq_u32 s99, 10
  s_cselect_b32 s99, 0, s99
  s_lshl_b32 s88, s99, 2
  s_sub_u32 s71, s57, s88
  s_and_b32 s71, s71, 15
  s_cmp_ge_u32 s71, 4
  s_cbranch_scc1 CW_23
  s_lshl_b32 s85, s71, 12
  s_add_u32 s85, s85, 98304
  v_add_u32 v36, s85, v224
  s_add_u32 s71, s71, s88
  s_lshl_b32 s71, s71, 10
  s_add_u32 s71, s71, s59
  ds_read_b64_tr_b16 a[64:65], v36
  ds_read_b64_tr_b16 a[66:67], v36 offset:1024
  s_waitcnt lgkmcnt(0)
  buffer_store_dwordx4 a[64:67], v1, s[28:31], s71 offen sc1
CW_23:
  s_cmp_lg_u32 s99, s56
  s_cbranch_scc1 CX_24
  s_lshl_b32 s71, s99, 12
  s_add_u32 s71, s71, s70
  ds_read_b128 a[68:71], v236 offset:32768
  ds_read_b128 a[72:75], v237 offset:32768
  ds_read_b128 a[76:79], v238 offset:32768
  ds_read_b128 a[80:83], v239 offset:32768
  s_waitcnt lgkmcnt(0)
  buffer_store_dwordx4 a[68:71], v1, s[28:31], s71 offen sc1
  buffer_store_dwordx4 a[72:75], v1, s[28:31], s71 offen offset:1024 sc1
  buffer_store_dwordx4 a[76:79], v1, s[28:31], s71 offen offset:2048 sc1
  buffer_store_dwordx4 a[80:83], v1, s[28:31], s71 offen offset:3072 sc1
CX_24:
  v_mfma_f32_4x4x4_16b_bf16 v[208:211], v[216:217], a[0:1], v[208:211]
  v_mfma_f32_4x4x4_16b_bf16 v[212:215], v[216:217], a[2:3], v[212:215]
  v_mfma_f32_4x4x4_16b_bf16 v[192:195], a[48:49], a[48:49], v[192:195]
  v_mfma_f32_4x4x4_16b_bf16 v[196:199], a[50:51], a[50:51], v[196:199]
  v_mfma_f32_4x4x4_16b_bf16 v[200:203], v[216:217], a[48:49], v[200:203]
  v_mfma_f32_4x4x4_16b_bf16 v[204:207], v[216:217], a[50:51], v[204:207]
  s_waitcnt lgkmcnt(9)
  v_mfma_f32_32x32x16_bf16 v[128:143], a[16:19], a[52:55], v[128:143]
  ds_read_b128 a[48:51], v239 offset:32768
  ds_read_b64_tr_b16 a[0:1], v228 offset:45056
  ds_read_b64_tr_b16 a[2:3], v228 offset:46080
  v_mfma_f32_32x32x16_bf16 v[144:159], a[20:23], a[52:55], v[144:159]
  ds_read_b64_tr_b16 a[4:5], v229 offset:45056
  ds_read_b64_tr_b16 a[6:7], v229 offset:46080
  v_mfma_f32_32x32x16_bf16 v[160:175], a[24:27], a[52:55], v[160:175]
  ds_read_b64_tr_b16 a[8:9], v230 offset:45056
  ds_read_b64_tr_b16 a[10:11], v230 offset:46080
  v_mfma_f32_32x32x16_bf16 v[176:191], a[28:31], a[52:55], v[176:191]
  ds_read_b64_tr_b16 a[12:13], v231 offset:45056
  ds_read_b64_tr_b16 a[14:15], v231 offset:46080
  v_mfma_f32_4x4x4_16b_bf16 v[208:211], v[216:217], a[16:17], v[208:211]
  v_mfma_f32_4x4x4_16b_bf16 v[212:215], v[216:217], a[18:19], v[212:215]
  v_mfma_f32_4x4x4_16b_bf16 v[192:195], a[52:53], a[52:53], v[192:195]
  v_mfma_f32_4x4x4_16b_bf16 v[196:199], a[54:55], a[54:55], v[196:199]
  v_mfma_f32_4x4x4_16b_bf16 v[200:203], v[216:217], a[52:53], v[200:203]
  v_mfma_f32_4x4x4_16b_bf16 v[204:207], v[216:217], a[54:55], v[204:207]
  s_waitcnt lgkmcnt(9)
  v_mfma_f32_32x32x16_bf16 v[128:143], a[32:35], a[56:59], v[128:143]
  s_waitcnt vmcnt(20)
  s_waitcnt lgkmcnt(0)
  s_barrier
  ds_read_b128 a[52:55], v232
  ds_read_b64_tr_b16 a[16:17], v224
  ds_read_b64_tr_b16 a[18:19], v224 offset:1024
  s_add_u32 m0, s45, 98304
  s_add_u32 s48, s44, 1720320
  buffer_load_dwordx4 v108, s[64:67], s48 offen lds
  v_mfma_f32_32x32x16_bf16 v[144:159], a[36:39], a[56:59], v[144:159]
  ds_read_b64_tr_b16 a[20:21], v225
  ds_read_b64_tr_b16 a[22:23], v225 offset:1024
  buffer_load_dwordx4 v109, s[64:67], s48 offen offset:1024 lds
  v_mfma_f32_32x32x16_bf16 v[160:175], a[40:43], a[56:59], v[160:175]
  ds_read_b64_tr_b16 a[24:25], v226
  ds_read_b64_tr_b16 a[26:27], v226 offset:1024
  buffer_load_dwordx4 v110, s[64:67], s48 offen offset:2048 lds
  v_mfma_f32_32x32x16_bf16 v[176:191], a[44:47], a[56:59], v[176:191]
  ds_read_b64_tr_b16 a[28:29], v227
  ds_read_b64_tr_b16 a[30:31], v227 offset:1024
  buffer_load_dwordx4 v111, s[64:67], s48 offen offset:3072 lds
  v_mfma_f32_4x4x4_16b_bf16 v[208:211], v[216:217], a[32:33], v[208:211]
  v_mfma_f32_4x4x4_16b_bf16 v[212:215], v[216:217], a[34:35], v[212:215]
  v_mfma_f32_4x4x4_16b_bf16 v[192:195], a[56:57], a[56:57], v[192:195]
  v_mfma_f32_4x4x4_16b_bf16 v[196:199], a[58:59], a[58:59], v[196:199]
  v_mfma_f32_4x4x4_16b_bf16 v[200:203], v[216:217], a[56:57], v[200:203]
  v_mfma_f32_4x4x4_16b_bf16 v[204:207], v[216:217], a[58:59], v[204:207]
  v_mfma_f32_32x32x16_bf16 v[128:143], a[0:3], a[48:51], v[128:143]
  ds_read_b128 a[56:59], v233
  ds_read_b64_tr_b16 a[32:33], v224 offset:4096
  ds_read_b64_tr_b16 a[34:35], v224 offset:5120
  s_add_u32 m0, s45, 114688
  s_add_u32 s48, s47, 896
  buffer_load_dwordx4 v104, s[60:63], s48 offen lds
  v_mfma_f32_32x32x16_bf16 v[144:159], a[4:7], a[48:51], v[144:159]
  ds_read_b64_tr_b16 a[36:37], v225 offset:4096
  ds_read_b64_tr_b16 a[38:39], v225 offset:5120
  buffer_load_dwordx4 v105, s[60:63], s48 offen offset:1024 lds
  v_mfma_f32_32x32x16_bf16 v[160:175], a[8:11], a[48:51], v[160:175]
  ds_read_b64_tr_b16 a[40:41], v226 offset:4096
  ds_read_b64_tr_b16 a[42:43], v226 offset:5120
  buffer_load_dwordx4 v106, s[60:63], s48 offen offset:2048 lds
  v_mfma_f32_32x32x16_bf16 v[176:191], a[12:15], a[48:51], v[176:191]
  ds_read_b64_tr_b16 a[44:45], v227 offset:4096
  ds_read_b64_tr_b16 a[46:47], v227 offset:5120
  buffer_load_dwordx4 v107, s[60:63], s48 offen offset:3072 lds
  v_mfma_f32_4x4x4_16b_bf16 v[208:211], v[216:217], a[0:1], v[208:211]
  v_mfma_f32_4x4x4_16b_bf16 v[212:215], v[216:217], a[2:3], v[212:215]
  v_mfma_f32_4x4x4_16b_bf16 v[192:195], a[48:49], a[48:49], v[192:195]
  v_mfma_f32_4x4x4_16b_bf16 v[196:199], a[50:51], a[50:51], v[196:199]
  v_mfma_f32_4x4x4_16b_bf16 v[200:203], v[216:217], a[48:49], v[200:203]
  v_mfma_f32_4x4x4_16b_bf16 v[204:207], v[216:217], a[50:51], v[204:207]
  s_waitcnt lgkmcnt(9)
  v_mfma_f32_32x32x16_bf16 v[128:143], a[16:19], a[52:55], v[128:143]
  ds_read_b128 a[48:51], v234
  ds_read_b64_tr_b16 a[0:1], v224 offset:8192
  ds_read_b64_tr_b16 a[2:3], v224 offset:9216
  v_mfma_f32_32x32x16_bf16 v[144:159], a[20:23], a[52:55], v[144:159]
  ds_read_b64_tr_b16 a[4:5], v225 offset:8192
  ds_read_b64_tr_b16 a[6:7], v225 offset:9216
  v_mfma_f32_32x32x16_bf16 v[160:175], a[24:27], a[52:55], v[160:175]
  ds_read_b64_tr_b16 a[8:9], v226 offset:8192
  ds_read_b64_tr_b16 a[10:11], v226 offset:9216
  v_mfma_f32_32x32x16_bf16 v[176:191], a[28:31], a[52:55], v[176:191]
  ds_read_b64_tr_b16 a[12:13], v227 offset:8192
  ds_read_b64_tr_b16 a[14:15], v227 offset:9216
  s_add_u32 s99, s99, 1
  s_cmp_eq_u32 s99, 10
  s_cselect_b32 s99, 0, s99
  s_lshl_b32 s88, s99, 2
  s_sub_u32 s71, s57, s88
  s_and_b32 s71, s71, 15
  s_cmp_ge_u32 s71, 4
  s_cbranch_scc1 CW_25
  s_lshl_b32 s85, s71, 12
  s_add_u32 s85, s85, 0
  v_add_u32 v36, s85, v224
  s_add_u32 s71, s71, s88
  s_lshl_b32 s71, s71, 10
  s_add_u32 s71, s71, s59
  ds_read_b64_tr_b16 a[64:65], v36
  ds_read_b64_tr_b16 a[66:67], v36 offset:1024
  s_waitcnt lgkmcnt(0)
  buffer_store_dwordx4 a[64:67], v1, s[28:31], s71 offen sc1
CW_25:
  s_cmp_lg_u32 s99, s56
  s_cbranch_scc1 CX_26
  s_lshl_b32 s71, s99, 12
  s_add_u32 s71, s71, s70
  ds_read_b128 a[68:71], v232
  ds_read_b128 a[72:75], v233
  ds_read_b128 a[76:79], v234
  ds_read_b128 a[80:83], v235
  s_waitcnt lgkmcnt(0)
  buffer_store_dwordx4 a[68:71], v1, s[28:31], s71 offen sc1
  buffer_store_dwordx4 a[72:75], v1, s[28:31], s71 offen offset:1024 sc1
  buffer_store_dwordx4 a[76:79], v1, s[28:31], s71 offen offset:2048 sc1
  buffer_store_dwordx4 a[80:83], v1, s[28:31], s71 offen offset:3072 sc1
CX_26:
  v_mfma_f32_4x4x4_16b_bf16 v[208:211], v[216:217], a[16:17], v[208:211]
  v_mfma_f32_4x4x4_16b_bf16 v[212:215], v[216:217], a[18:19], v[212:215]
  v_mfma_f32_4x4x4_16b_bf16 v[192:195], a[52:53], a[52:53], v[192:195]
  v_mfma_f32_4x4x4_16b_bf16 v[196:199], a[54:55], a[54:55], v[196:199]
  v_mfma_f32_4x4x4_16b_bf16 v[200:203], v[216:217], a[52:53], v[200:203]
  v_mfma_f32_4x4x4_16b_bf16 v[204:207], v[216:217], a[54:55], v[204:207]
  s_waitcnt lgkmcnt(9)
  v_mfma_f32_32x32x16_bf16 v[128:143], a[32:35], a[56:59], v[128:143]
  ds_read_b128 a[52:55], v235
  ds_read_b64_tr_b16 a[16:17], v224 offset:12288
  ds_read_b64_tr_b16 a[18:19], v224 offset:13312
  v_mfma_f32_32x32x16_bf16 v[144:159], a[36:39], a[56:59], v[144:159]
  ds_read_b64_tr_b16 a[20:21], v225 offset:12288
  ds_read_b64_tr_b16 a[22:23], v225 offset:13312
  v_mfma_f32_32x32x16_bf16 v[160:175], a[40:43], a[56:59], v[160:175]
  ds_read_b64_tr_b16 a[24:25], v226 offset:12288
  ds_read_b64_tr_b16 a[26:27], v226 offset:13312
  v_mfma_f32_32x32x16_bf16 v[176:191], a[44:47], a[56:59], v[176:191]
  ds_read_b64_tr_b16 a[28:29], v227 offset:12288
  ds_read_b64_tr_b16 a[30:31], v227 offset:13312
  v_mfma_f32_4x4x4_16b_bf16 v[208:211], v[216:217], a[32:33], v[208:211]
  v_mfma_f32_4x4x4_16b_bf16 v[212:215], v[216:217], a[34:35], v[212:215]
  v_mfma_f32_4x4x4_16b_bf16 v[192:195], a[56:57], a[56:57], v[192:195]
  v_mfma_f32_4x4x4_16b_bf16 v[196:199], a[58:59], a[58:59], v[196:199]
  v_mfma_f32_4x4x4_16b_bf16 v[200:203], v[216:217], a[56:57], v[200:203]
  v_mfma_f32_4x4x4_16b_bf16 v[204:207], v[216:217], a[58:59], v[204:207]
  s_waitcnt lgkmcnt(9)
  v_mfma_f32_32x32x16_bf16 v[128:143], a[0:3], a[48:51], v[128:143]
  s_waitcnt vmcnt(18)
  s_waitcnt lgkmcnt(0)
  s_barrier
  ds_read_b128 a[56:59], v232 offset:32768
  ds_read_b64_tr_b16 a[32:33], v224 offset:32768
  ds_read_b64_tr_b16 a[34:35], v224 offset:33792
  s_add_u32 m0, s45, 0
  s_add_u32 s48, s44, 1966080
  buffer_load_dwordx4 v108, s[64:67], s48 offen lds
  v_mfma_f32_32x32x16_bf16 v[144:159], a[4:7], a[48:51], v[144:159]
  ds_read_b64_tr_b16 a[36:37], v225 offset:32768
  ds_read_b64_tr_b16 a[38:39], v225 offset:33792
  buffer_load_dwordx4 v109, s[64:67], s48 offen offset:1024 lds
  s_waitcnt vmcnt(18)
  ds_read_b64_tr_b16 v[64:65], v15
  ds_read_b64_tr_b16 v[66:67], v15 offset:512
  ds_read_b64_tr_b16 v[68:69], v15 offset:1024
  ds_read_b64_tr_b16 v[70:71], v15 offset:1536
  ds_read_b64_tr_b16 v[72:73], v15 offset:2048
  ds_read_b64_tr_b16 v[74:75], v15 offset:2560
  ds_read_b64_tr_b16 v[76:77], v15 offset:3072
  ds_read_b64_tr_b16 v[78:79], v15 offset:3584
  v_mfma_f32_32x32x16_bf16 v[160:175], a[8:11], a[48:51], v[160:175]
  ds_read_b64_tr_b16 a[40:41], v226 offset:32768
  ds_read_b64_tr_b16 a[42:43], v226 offset:33792
  buffer_load_dwordx4 v110, s[64:67], s48 offen offset:2048 lds
  v_mfma_f32_32x32x16_bf16 v[176:191], a[12:15], a[48:51], v[176:191]
  ds_read_b64_tr_b16 a[44:45], v227 offset:32768
  ds_read_b64_tr_b16 a[46:47], v227 offset:33792
  buffer_load_dwordx4 v111, s[64:67], s48 offen offset:3072 lds
  v_mfma_f32_4x4x4_16b_bf16 v[208:211], v[216:217], a[0:1], v[208:211]
  v_mfma_f32_4x4x4_16b_bf16 v[212:215], v[216:217], a[2:3], v[212:215]
  v_mfma_f32_4x4x4_16b_bf16 v[192:195], a[48:49], a[48:49], v[192:195]
  v_mfma_f32_4x4x4_16b_bf16 v[196:199], a[50:51], a[50:51], v[196:199]
  v_mfma_f32_4x4x4_16b_bf16 v[200:203], v[216:217], a[48:49], v[200:203]
  v_mfma_f32_4x4x4_16b_bf16 v[204:207], v[216:217], a[50:51], v[204:207]
  v_mfma_f32_32x32x16_bf16 v[128:143], a[16:19], a[52:55], v[128:143]
  ds_read_b128 a[48:51], v233 offset:32768
  ds_read_b64_tr_b16 a[0:1], v224 offset:36864
  ds_read_b64_tr_b16 a[2:3], v224 offset:37888
  s_add_u32 m0, s45, 16384
  s_add_u32 s48, s47, 1024
  buffer_load_dwordx4 v104, s[60:63], s48 offen lds
  s_waitcnt lgkmcnt(13)
  buffer_store_dwordx4 v[64:67], v6, s[28:31], s40 offen sc1
  v_mfma_f32_32x32x16_bf16 v[144:159], a[20:23], a[52:55], v[144:159]
  ds_read_b64_tr_b16 a[4:5], v225 offset:36864
  ds_read_b64_tr_b16 a[6:7], v225 offset:37888
  buffer_load_dwordx4 v105, s[60:63], s48 offen offset:1024 lds
  s_add_u32 s40, s40, s38
  s_waitcnt lgkmcnt(13)
  buffer_store_dwordx4 v[68:71], v6, s[28:31], s40 offen sc1
  v_mfma_f32_32x32x16_bf16 v[160:175], a[24:27], a[52:55], v[160:175]
  ds_read_b64_tr_b16 a[8:9], v226 offset:36864
  ds_read_b64_tr_b16 a[10:11], v226 offset:37888
  buffer_load_dwordx4 v106, s[60:63], s48 offen offset:2048 lds
  s_add_u32 s40, s40, s38
  s_waitcnt lgkmcnt(13)
  buffer_store_dwordx4 v[72:75], v6, s[28:31], s40 offen sc1
  v_mfma_f32_32x32x16_bf16 v[176:191], a[28:31], a[52:55], v[176:191]
  ds_read_b64_tr_b16 a[12:13], v227 offset:36864
  ds_read_b64_tr_b16 a[14:15], v227 offset:37888
  buffer_load_dwordx4 v107, s[60:63], s48 offen offset:3072 lds
  s_add_u32 s40, s40, s38
  s_waitcnt lgkmcnt(13)
  buffer_store_dwordx4 v[76:79], v6, s[28:31], s40 offen sc1
  v_mfma_f32_4x4x4_16b_bf16 v[208:211], v[216:217], a[16:17], v[208:211]
  v_mfma_f32_4x4x4_16b_bf16 v[212:215], v[216:217], a[18:19], v[212:215]
  v_mfma_f32_4x4x4_16b_bf16 v[192:195], a[52:53], a[52:53], v[192:195]
  v_mfma_f32_4x4x4_16b_bf16 v[196:199], a[54:55], a[54:55], v[196:199]
  v_mfma_f32_4x4x4_16b_bf16 v[200:203], v[216:217], a[52:53], v[200:203]
  v_mfma_f32_4x4x4_16b_bf16 v[204:207], v[216:217], a[54:55], v[204:207]
  v_mfma_f32_4x4x4_16b_bf16 v[96:99], v[216:217], v[64:65], 0
  v_mfma_f32_4x4x4_16b_bf16 v[100:103], v[216:217], v[66:67], 0
  s_nop 0
  v_mfma_f32_4x4x4_16b_bf16 v[96:99], v[216:217], v[68:69], v[96:99]
  v_mfma_f32_4x4x4_16b_bf16 v[100:103], v[216:217], v[70:71], v[100:103]
  s_nop 0
  v_mfma_f32_4x4x4_16b_bf16 v[96:99], v[216:217], v[72:73], v[96:99]
  v_mfma_f32_4x4x4_16b_bf16 v[100:103], v[216:217], v[74:75], v[100:103]
  s_nop 0
  v_mfma_f32_4x4x4_16b_bf16 v[96:99], v[216:217], v[76:77], v[96:99]
  v_mfma_f32_4x4x4_16b_bf16 v[100:103], v[216:217], v[78:79], v[100:103]
  s_waitcnt lgkmcnt(9)
  v_mfma_f32_32x32x16_bf16 v[128:143], a[32:35], a[56:59], v[128:143]
  ds_read_b128 a[52:55], v234 offset:32768
  ds_read_b64_tr_b16 a[16:17], v224 offset:40960
  ds_read_b64_tr_b16 a[18:19], v224 offset:41984
  v_mfma_f32_32x32x16_bf16 v[144:159], a[36:39], a[56:59], v[144:159]
  ds_read_b64_tr_b16 a[20:21], v225 offset:40960
  ds_read_b64_tr_b16 a[22:23], v225 offset:41984
  v_mfma_f32_32x32x16_bf16 v[160:175], a[40:43], a[56:59], v[160:175]
  ds_read_b64_tr_b16 a[24:25], v226 offset:40960
  ds_read_b64_tr_b16 a[26:27], v226 offset:41984
  v_mfma_f32_32x32x16_bf16 v[176:191], a[44:47], a[56:59], v[176:191]
  ds_read_b64_tr_b16 a[28:29], v227 offset:40960
  ds_read_b64_tr_b16 a[30:31], v227 offset:41984
  s_add_u32 s99, s99, 1
  s_cmp_eq_u32 s99, 10
  s_cselect_b32 s99, 0, s99
  s_lshl_b32 s88, s99, 2
  s_sub_u32 s71, s57, s88
  s_and_b32 s71, s71, 15
  s_cmp_ge_u32 s71, 4
  s_cbranch_scc1 CW_27
  s_lshl_b32 s85, s71, 12
  s_add_u32 s85, s85, 32768
  v_add_u32 v36, s85, v224
  s_add_u32 s71, s71, s88
  s_lshl_b32 s71, s71, 10
  s_add_u32 s71, s71, s59
  ds_read_b64_tr_b16 a[64:65], v36
  ds_read_b64_tr_b16 a[66:67], v36 offset:1024
  s_waitcnt lgkmcnt(0)
  buffer_store_dwordx4 a[64:67], v1, s[28:31], s71 offen sc1
CW_27:
  s_cmp_lg_u32 s99, s56
  s_cbranch_scc1 CX_28
  s_lshl_b32 s71, s99, 12
  s_add_u32 s71, s71, s70
  ds_read_b128 a[68:71], v232 offset:32768
  ds_read_b128 a[72:75], v233 offset:32768
  ds_read_b128 a[76:79], v234 offset:32768
  ds_read_b128 a[80:83], v235 offset:32768
  s_waitcnt lgkmcnt(0)
  buffer_store_dwordx4 a[68:71], v1, s[28:31], s71 offen sc1
  buffer_store_dwordx4 a[72:75], v1, s[28:31], s71 offen offset:1024 sc1
  buffer_store_dwordx4 a[76:79], v1, s[28:31], s71 offen offset:2048 sc1
  buffer_store_dwordx4 a[80:83], v1, s[28:31], s71 offen offset:3072 sc1
CX_28:
  v_mfma_f32_4x4x4_16b_bf16 v[208:211], v[216:217], a[32:33], v[208:211]
  v_mfma_f32_4x4x4_16b_bf16 v[212:215], v[216:217], a[34:35], v[212:215]
  v_mfma_f32_4x4x4_16b_bf16 v[192:195], a[56:57], a[56:57], v[192:195]
  v_mfma_f32_4x4x4_16b_bf16 v[196:199], a[58:59], a[58:59], v[196:199]
  v_mfma_f32_4x4x4_16b_bf16 v[200:203], v[216:217], a[56:57], v[200:203]
  v_mfma_f32_4x4x4_16b_bf16 v[204:207], v[216:217], a[58:59], v[204:207]
  s_waitcnt lgkmcnt(9)
  v_mfma_f32_32x32x16_bf16 v[128:143], a[0:3], a[48:51], v[128:143]
  ds_read_b128 a[56:59], v235 offset:32768
  ds_read_b64_tr_b16 a[32:33], v224 offset:45056
  ds_read_b64_tr_b16 a[34:35], v224 offset:46080
  v_mfma_f32_32x32x16_bf16 v[144:159], a[4:7], a[48:51], v[144:159]
  ds_read_b64_tr_b16 a[36:37], v225 offset:45056
  ds_read_b64_tr_b16 a[38:39], v225 offset:46080
  v_mfma_f32_32x32x16_bf16 v[160:175], a[8:11], a[48:51], v[160:175]
  ds_read_b64_tr_b16 a[40:41], v226 offset:45056
  ds_read_b64_tr_b16 a[42:43], v226 offset:46080
  v_mfma_f32_32x32x16_bf16 v[176:191], a[12:15], a[48:51], v[176:191]
  ds_read_b64_tr_b16 a[44:45], v227 offset:45056
  ds_read_b64_tr_b16 a[46:47], v227 offset:46080
  v_mfma_f32_4x4x4_16b_bf16 v[208:211], v[216:217], a[0:1], v[208:211]
  v_mfma_f32_4x4x4_16b_bf16 v[212:215], v[216:217], a[2:3], v[212:215]
  v_mfma_f32_4x4x4_16b_bf16 v[192:195], a[48:49], a[48:49], v[192:195]
  v_mfma_f32_4x4x4_16b_bf16 v[196:199], a[50:51], a[50:51], v[196:199]
  v_mfma_f32_4x4x4_16b_bf16 v[200:203], v[216:217], a[48:49], v[200:203]
  v_mfma_f32_4x4x4_16b_bf16 v[204:207], v[216:217], a[50:51], v[204:207]
  s_waitcnt lgkmcnt(9)
  v_mfma_f32_32x32x16_bf16 v[128:143], a[16:19], a[52:55], v[128:143]
  s_waitcnt vmcnt(20)
  s_waitcnt lgkmcnt(0)
  s_barrier
  ds_read_b128 a[48:51], v236
  ds_read_b64_tr_b16 a[0:1], v228
  ds_read_b64_tr_b16 a[2:3], v228 offset:1024
  s_add_u32 m0, s45, 32768
  s_add_u32 s48, s44, 2211840
  buffer_load_dwordx4 v108, s[64:67], s48 offen lds
  v_mfma_f32_32x32x16_bf16 v[144:159], a[20:23], a[52:55], v[144:159]
  ds_read_b64_tr_b16 a[4:5], v229
  ds_read_b64_tr_b16 a[6:7], v229 offset:1024
  buffer_load_dwordx4 v109, s[64:67], s48 offen offset:1024 lds
  v_mfma_f32_32x32x16_bf16 v[160:175], a[24:27], a[52:55], v[160:175]
  ds_read_b64_tr_b16 a[8:9], v230
  ds_read_b64_tr_b16 a[10:11], v230 offset:1024
  buffer_load_dwordx4 v110, s[64:67], s48 offen offset:2048 lds
  v_mfma_f32_32x32x16_bf16 v[176:191], a[28:31], a[52:55], v[176:191]
  ds_read_b64_tr_b16 a[12:13], v231
  ds_read_b64_tr_b16 a[14:15], v231 offset:1024
  buffer_load_dwordx4 v111, s[64:67], s48 offen offset:3072 lds
  v_mfma_f32_4x4x4_16b_bf16 v[208:211], v[216:217], a[16:17], v[208:211]
  v_mfma_f32_4x4x4_16b_bf16 v[212:215], v[216:217], a[18:19], v[212:215]
  v_mfma_f32_4x4x4_16b_bf16 v[192:195], a[52:53], a[52:53], v[192:195]
  v_mfma_f32_4x4x4_16b_bf16 v[196:199], a[54:55], a[54:55], v[196:199]
  v_mfma_f32_4x4x4_16b_bf16 v[200:203], v[216:217], a[52:53], v[200:203]
  v_mfma_f32_4x4x4_16b_bf16 v[204:207], v[216:217], a[54:55], v[204:207]
  v_mfma_f32_32x32x16_bf16 v[128:143], a[32:35], a[56:59], v[128:143]
  ds_read_b128 a[52:55], v237
  ds_read_b64_tr_b16 a[16:17], v228 offset:4096
  ds_read_b64_tr_b16 a[18:19], v228 offset:5120
  s_add_u32 m0, s45, 49152
  s_add_u32 s48, s47, 1152
  buffer_load_dwordx4 v104, s[60:63], s48 offen lds
  v_mfma_f32_32x32x16_bf16 v[144:159], a[36:39], a[56:59], v[144:159]
  ds_read_b64_tr_b16 a[20:21], v229 offset:4096
  ds_read_b64_tr_b16 a[22:23], v229 offset:5120
  buffer_load_dwordx4 v105, s[60:63], s48 offen offset:1024 lds
  v_mfma_f32_32x32x16_bf16 v[160:175], a[40:43], a[56:59], v[160:175]
  ds_read_b64_tr_b16 a[24:25], v230 offset:4096
  ds_read_b64_tr_b16 a[26:27], v230 offset:5120
  buffer_load_dwordx4 v106, s[60:63], s48 offen offset:2048 lds
  v_mfma_f32_32x32x16_bf16 v[176:191], a[44:47], a[56:59], v[176:191]
  ds_read_b64_tr_b16 a[28:29], v231 offset:4096
  ds_read_b64_tr_b16 a[30:31], v231 offset:5120
  buffer_load_dwordx4 v107, s[60:63], s48 offen offset:3072 lds
  v_mfma_f32_4x4x4_16b_bf16 v[208:211], v[216:217], a[32:33], v[208:211]
  v_mfma_f32_4x4x4_16b_bf16 v[212:215], v[216:217], a[34:35], v[212:215]
  v_mfma_f32_4x4x4_16b_bf16 v[192:195], a[56:57], a[56:57], v[192:195]
  v_mfma_f32_4x4x4_16b_bf16 v[196:199], a[58:59], a[58:59], v[196:199]
  v_mfma_f32_4x4x4_16b_bf16 v[200:203], v[216:217], a[56:57], v[200:203]
  v_mfma_f32_4x4x4_16b_bf16 v[204:207], v[216:217], a[58:59], v[204:207]
  s_waitcnt lgkmcnt(9)
  v_mfma_f32_32x32x16_bf16 v[128:143], a[0:3], a[48:51], v[128:143]
  ds_read_b128 a[56:59], v238
  ds_read_b64_tr_b16 a[32:33], v228 offset:8192
  ds_read_b64_tr_b16 a[34:35], v228 offset:9216
  s_add_u32 m0, s43, 0
  s_mul_i32 s87, s91, 4
  s_add_u32 s87, s87, s90
  buffer_load_dwordx4 v37, s[20:23], s87 offen nt lds
  v_mfma_f32_32x32x16_bf16 v[144:159], a[4:7], a[48:51], v[144:159]
  ds_read_b64_tr_b16 a[36:37], v229 offset:8192
  ds_read_b64_tr_b16 a[38:39], v229 offset:9216
  v_mfma_f32_32x32x16_bf16 v[160:175], a[8:11], a[48:51], v[160:175]
  ds_read_b64_tr_b16 a[40:41], v230 offset:8192
  ds_read_b64_tr_b16 a[42:43], v230 offset:9216
  v_mfma_f32_32x32x16_bf16 v[176:191], a[12:15], a[48:51], v[176:191]
  ds_read_b64_tr_b16 a[44:45], v231 offset:8192
  ds_read_b64_tr_b16 a[46:47], v231 offset:9216
  s_add_u32 s99, s99, 1
  s_cmp_eq_u32 s99, 10
  s_cselect_b32 s99, 0, s99
  s_lshl_b32 s88, s99, 2
  s_sub_u32 s71, s57, s88
  s_and_b32 s71, s71, 15
  s_cmp_ge_u32 s71, 4
  s_cbranch_scc1 CW_29
  s_lshl_b32 s85, s71, 12
  s_add_u32 s85, s85, 65536
  v_add_u32 v36, s85, v224
  s_add_u32 s71, s71, s88
  s_lshl_b32 s71, s71, 10
  s_add_u32 s71, s71, s59
  ds_read_b64_tr_b16 a[64:65], v36
  ds_read_b64_tr_b16 a[66:67], v36 offset:1024
  s_waitcnt lgkmcnt(0)
  buffer_store_dwordx4 a[64:67], v1, s[28:31], s71 offen sc1
CW_29:
  s_cmp_lg_u32 s99, s56
  s_cbranch_scc1 CX_30
  s_lshl_b32 s71, s99, 12
  s_add_u32 s71, s71, s70
  ds_read_b128 a[68:71], v236
  ds_read_b128 a[72:75], v237
  ds_read_b128 a[76:79], v238
  ds_read_b128 a[80:83], v239
  s_waitcnt lgkmcnt(0)
  buffer_store_dwordx4 a[68:71], v1, s[28:31], s71 offen sc1
  buffer_store_dwordx4 a[72:75], v1, s[28:31], s71 offen offset:1024 sc1
  buffer_store_dwordx4 a[76:79], v1, s[28:31], s71 offen offset:2048 sc1
  buffer_store_dwordx4 a[80:83], v1, s[28:31], s71 offen offset:3072 sc1
CX_30:
  v_mfma_f32_4x4x4_16b_bf16 v[208:211], v[216:217], a[0:1], v[208:211]
  v_mfma_f32_4x4x4_16b_bf16 v[212:215], v[216:217], a[2:3], v[212:215]
  v_mfma_f32_4x4x4_16b_bf16 v[192:195], a[48:49], a[48:49], v[192:195]
  v_mfma_f32_4x4x4_16b_bf16 v[196:199], a[50:51], a[50:51], v[196:199]
  v_mfma_f32_4x4x4_16b_bf16 v[200:203], v[216:217], a[48:49], v[200:203]
  v_mfma_f32_4x4x4_16b_bf16 v[204:207], v[216:217], a[50:51], v[204:207]
  s_waitcnt lgkmcnt(9)
  v_mfma_f32_32x32x16_bf16 v[128:143], a[16:19], a[52:55], v[128:143]
  ds_read_b128 a[48:51], v239
  ds_read_b64_tr_b16 a[0:1], v228 offset:12288
  ds_read_b64_tr_b16 a[2:3], v228 offset:13312
  s_add_u32 m0, s43, 1024
  s_mul_i32 s87, s91, 5
  s_add_u32 s87, s87, s90
  buffer_load_dwordx4 v37, s[20:23], s87 offen nt lds
  v_mfma_f32_32x32x16_bf16 v[144:159], a[20:23], a[52:55], v[144:159]
  ds_read_b64_tr_b16 a[4:5], v229 offset:12288
  ds_read_b64_tr_b16 a[6:7], v229 offset:13312
  v_mfma_f32_32x32x16_bf16 v[160:175], a[24:27], a[52:55], v[160:175]
  ds_read_b64_tr_b16 a[8:9], v230 offset:12288
  ds_read_b64_tr_b16 a[10:11], v230 offset:13312
  v_mfma_f32_32x32x16_bf16 v[176:191], a[28:31], a[52:55], v[176:191]
  ds_read_b64_tr_b16 a[12:13], v231 offset:12288
  ds_read_b64_tr_b16 a[14:15], v231 offset:13312
  v_mfma_f32_4x4x4_16b_bf16 v[208:211], v[216:217], a[16:17], v[208:211]
  v_mfma_f32_4x4x4_16b_bf16 v[212:215], v[216:217], a[18:19], v[212:215]
  v_mfma_f32_4x4x4_16b_bf16 v[192:195], a[52:53], a[52:53], v[192:195]
  v_mfma_f32_4x4x4_16b_bf16 v[196:199], a[54:55], a[54:55], v[196:199]
  v_mfma_f32_4x4x4_16b_bf16 v[200:203], v[216:217], a[52:53], v[200:203]
  v_mfma_f32_4x4x4_16b_bf16 v[204:207], v[216:217], a[54:55], v[204:207]
  s_waitcnt lgkmcnt(9)
  v_mfma_f32_32x32x16_bf16 v[128:143], a[32:35], a[56:59], v[128:143]
  s_waitcnt vmcnt(22)
  s_waitcnt lgkmcnt(0)
  s_barrier
  ds_read_b128 a[52:55], v236 offset:32768
  ds_read_b64_tr_b16 a[16:17], v228 offset:32768
  ds_read_b64_tr_b16 a[18:19], v228 offset:33792
  s_add_u32 m0, s43, 2048
  s_mul_i32 s87, s91, 6
  s_add_u32 s87, s87, s90
  buffer_load_dwordx4 v37, s[20:23], s87 offen nt lds
  v_mfma_f32_32x32x16_bf16 v[144:159], a[36:39], a[56:59], v[144:159]
  ds_read_b64_tr_b16 a[20:21], v229 offset:32768
  ds_read_b64_tr_b16 a[22:23], v229 offset:33792
  v_mfma_f32_32x32x16_bf16 v[160:175], a[40:43], a[56:59], v[160:175]
  ds_read_b64_tr_b16 a[24:25], v230 offset:32768
  ds_read_b64_tr_b16 a[26:27], v230 offset:33792
  v_mfma_f32_32x32x16_bf16 v[176:191], a[44:47], a[56:59], v[176:191]
  ds_read_b64_tr_b16 a[28:29], v231 offset:32768
  ds_read_b64_tr_b16 a[30:31], v231 offset:33792
  v_mfma_f32_4x4x4_16b_bf16 v[208:211], v[216:217], a[32:33], v[208:211]
  v_mfma_f32_4x4x4_16b_bf16 v[212:215], v[216:217], a[34:35], v[212:215]
  v_mfma_f32_4x4x4_16b_bf16 v[192:195], a[56:57], a[56:57], v[192:195]
  v_mfma_f32_4x4x4_16b_bf16 v[196:199], a[58:59], a[58:59], v[196:199]
  v_mfma_f32_4x4x4_16b_bf16 v[200:203], v[216:217], a[56:57], v[200:203]
  v_mfma_f32_4x4x4_16b_bf16 v[204:207], v[216:217], a[58:59], v[204:207]
  v_mfma_f32_32x32x16_bf16 v[128:143], a[0:3], a[48:51], v[128:143]
  ds_read_b128 a[56:59], v237 offset:32768
  ds_read_b64_tr_b16 a[32:33], v228 offset:36864
  ds_read_b64_tr_b16 a[34:35], v228 offset:37888
  s_add_u32 m0, s43, 3072
  s_mul_i32 s87, s91, 7
  s_add_u32 s87, s87, s90
  buffer_load_dwordx4 v37, s[20:23], s87 offen nt lds
  v_mfma_f32_32x32x16_bf16 v[144:159], a[4:7], a[48:51], v[144:159]
  ds_read_b64_tr_b16 a[36:37], v229 offset:36864
  ds_read_b64_tr_b16 a[38:39], v229 offset:37888
  v_mfma_f32_32x32x16_bf16 v[160:175], a[8:11], a[48:51], v[160:175]
  ds_read_b64_tr_b16 a[40:41], v230 offset:36864
  ds_read_b64_tr_b16 a[42:43], v230 offset:37888
  v_mfma_f32_32x32x16_bf16 v[176:191], a[12:15], a[48:51], v[176:191]
  ds_read_b64_tr_b16 a[44:45], v231 offset:36864
  ds_read_b64_tr_b16 a[46:47], v231 offset:37888
  v_mfma_f32_4x4x4_16b_bf16 v[208:211], v[216:217], a[0:1], v[208:211]
  v_mfma_f32_4x4x4_16b_bf16 v[212:215], v[216:217], a[2:3], v[212:215]
  v_mfma_f32_4x4x4_16b_bf16 v[192:195], a[48:49], a[48:49], v[192:195]
  v_mfma_f32_4x4x4_16b_bf16 v[196:199], a[50:51], a[50:51], v[196:199]
  v_mfma_f32_4x4x4_16b_bf16 v[200:203], v[216:217], a[48:49], v[200:203]
  v_mfma_f32_4x4x4_16b_bf16 v[204:207], v[216:217], a[50:51], v[204:207]
  s_waitcnt lgkmcnt(9)
  v_mfma_f32_32x32x16_bf16 v[128:143], a[16:19], a[52:55], v[128:143]
  ds_read_b128 a[48:51], v238 offset:32768
  ds_read_b64_tr_b16 a[0:1], v228 offset:40960
  ds_read_b64_tr_b16 a[2:3], v228 offset:41984
  v_mfma_f32_32x32x16_bf16 v[144:159], a[20:23], a[52:55], v[144:159]
  ds_read_b64_tr_b16 a[4:5], v229 offset:40960
  ds_read_b64_tr_b16 a[6:7], v229 offset:41984
  v_mfma_f32_32x32x16_bf16 v[160:175], a[24:27], a[52:55], v[160:175]
  ds_read_b64_tr_b16 a[8:9], v230 offset:40960
  ds_read_b64_tr_b16 a[10:11], v230 offset:41984
  v_mfma_f32_32x32x16_bf16 v[176:191], a[28:31], a[52:55], v[176:191]
  ds_read_b64_tr_b16 a[12:13], v231 offset:40960
  ds_read_b64_tr_b16 a[14:15], v231 offset:41984
  s_add_u32 s99, s99, 1
  s_cmp_eq_u32 s99, 10
  s_cselect_b32 s99, 0, s99
  s_lshl_b32 s88, s99, 2
  s_sub_u32 s71, s57, s88
  s_and_b32 s71, s71, 15
  s_cmp_ge_u32 s71, 4
  s_cbranch_scc1 CW_31
  s_lshl_b32 s85, s71, 12
  s_add_u32 s85, s85, 98304
  v_add_u32 v36, s85, v224
  s_add_u32 s71, s71, s88
  s_lshl_b32 s71, s71, 10
  s_add_u32 s71, s71, s59
  ds_read_b64_tr_b16 a[64:65], v36
  ds_read_b64_tr_b16 a[66:67], v36 offset:1024
  s_waitcnt lgkmcnt(0)
  buffer_store_dwordx4 a[64:67], v1, s[28:31], s71 offen sc1
CW_31:
  s_cmp_lg_u32 s99, s56
  s_cbranch_scc1 CX_32
  s_lshl_b32 s71, s99, 12
  s_add_u32 s71, s71, s70
  ds_read_b128 a[68:71], v236 offset:32768
  ds_read_b128 a[72:75], v237 offset:32768
  ds_read_b128 a[76:79], v238 offset:32768
  ds_read_b128 a[80:83], v239 offset:32768
  s_waitcnt lgkmcnt(0)
  buffer_store_dwordx4 a[68:71], v1, s[28:31], s71 offen sc1
  buffer_store_dwordx4 a[72:75], v1, s[28:31], s71 offen offset:1024 sc1
  buffer_store_dwordx4 a[76:79], v1, s[28:31], s71 offen offset:2048 sc1
  buffer_store_dwordx4 a[80:83], v1, s[28:31], s71 offen offset:3072 sc1
CX_32:
  v_mfma_f32_4x4x4_16b_bf16 v[208:211], v[216:217], a[16:17], v[208:211]
  v_mfma_f32_4x4x4_16b_bf16 v[212:215], v[216:217], a[18:19], v[212:215]
  v_mfma_f32_4x4x4_16b_bf16 v[192:195], a[52:53], a[52:53], v[192:195]
  v_mfma_f32_4x4x4_16b_bf16 v[196:199], a[54:55], a[54:55], v[196:199]
  v_mfma_f32_4x4x4_16b_bf16 v[200:203], v[216:217], a[52:53], v[200:203]
  v_mfma_f32_4x4x4_16b_bf16 v[204:207], v[216:217], a[54:55], v[204:207]
  s_waitcnt lgkmcnt(9)
  v_mfma_f32_32x32x16_bf16 v[128:143], a[32:35], a[56:59], v[128:143]
  ds_read_b128 a[52:55], v239 offset:32768
  ds_read_b64_tr_b16 a[16:17], v228 offset:45056
  ds_read_b64_tr_b16 a[18:19], v228 offset:46080
  v_mfma_f32_32x32x16_bf16 v[144:159], a[36:39], a[56:59], v[144:159]
  ds_read_b64_tr_b16 a[20:21], v229 offset:45056
  ds_read_b64_tr_b16 a[22:23], v229 offset:46080
  v_mfma_f32_32x32x16_bf16 v[160:175], a[40:43], a[56:59], v[160:175]
  ds_read_b64_tr_b16 a[24:25], v230 offset:45056
  ds_read_b64_tr_b16 a[26:27], v230 offset:46080
  v_mfma_f32_32x32x16_bf16 v[176:191], a[44:47], a[56:59], v[176:191]
  ds_read_b64_tr_b16 a[28:29], v231 offset:45056
  ds_read_b64_tr_b16 a[30:31], v231 offset:46080
  v_mfma_f32_4x4x4_16b_bf16 v[208:211], v[216:217], a[32:33], v[208:211]
  v_mfma_f32_4x4x4_16b_bf16 v[212:215], v[216:217], a[34:35], v[212:215]
  v_mfma_f32_4x4x4_16b_bf16 v[192:195], a[56:57], a[56:57], v[192:195]
  v_mfma_f32_4x4x4_16b_bf16 v[196:199], a[58:59], a[58:59], v[196:199]
  v_mfma_f32_4x4x4_16b_bf16 v[200:203], v[216:217], a[56:57], v[200:203]
  v_mfma_f32_4x4x4_16b_bf16 v[204:207], v[216:217], a[58:59], v[204:207]
  s_waitcnt lgkmcnt(9)
  v_mfma_f32_32x32x16_bf16 v[128:143], a[0:3], a[48:51], v[128:143]
  s_waitcnt vmcnt(13)
  s_waitcnt lgkmcnt(0)
  s_barrier
  ds_read_b128 a[56:59], v232
  ds_read_b64_tr_b16 a[32:33], v224
  ds_read_b64_tr_b16 a[34:35], v224 offset:1024
  v_mfma_f32_32x32x16_bf16 v[144:159], a[4:7], a[48:51], v[144:159]
  ds_read_b64_tr_b16 a[36:37], v225
  ds_read_b64_tr_b16 a[38:39], v225 offset:1024
  v_mfma_f32_32x32x16_bf16 v[160:175], a[8:11], a[48:51], v[160:175]
  ds_read_b64_tr_b16 a[40:41], v226
  ds_read_b64_tr_b16 a[42:43], v226 offset:1024
  v_mfma_f32_32x32x16_bf16 v[176:191], a[12:15], a[48:51], v[176:191]
  ds_read_b64_tr_b16 a[44:45], v227
  ds_read_b64_tr_b16 a[46:47], v227 offset:1024
  v_mfma_f32_4x4x4_16b_bf16 v[208:211], v[216:217], a[0:1], v[208:211]
  v_mfma_f32_4x4x4_16b_bf16 v[212:215], v[216:217], a[2:3], v[212:215]
  v_mfma_f32_4x4x4_16b_bf16 v[192:195], a[48:49], a[48:49], v[192:195]
  v_mfma_f32_4x4x4_16b_bf16 v[196:199], a[50:51], a[50:51], v[196:199]
  v_mfma_f32_4x4x4_16b_bf16 v[200:203], v[216:217], a[48:49], v[200:203]
  v_mfma_f32_4x4x4_16b_bf16 v[204:207], v[216:217], a[50:51], v[204:207]
  v_mfma_f32_32x32x16_bf16 v[128:143], a[16:19], a[52:55], v[128:143]
  ds_read_b128 a[48:51], v233
  ds_read_b64_tr_b16 a[0:1], v224 offset:4096
  ds_read_b64_tr_b16 a[2:3], v224 offset:5120
  v_mfma_f32_32x32x16_bf16 v[144:159], a[20:23], a[52:55], v[144:159]
  ds_read_b64_tr_b16 a[4:5], v225 offset:4096
  ds_read_b64_tr_b16 a[6:7], v225 offset:5120
  v_mfma_f32_32x32x16_bf16 v[160:175], a[24:27], a[52:55], v[160:175]
  ds_read_b64_tr_b16 a[8:9], v226 offset:4096
  ds_read_b64_tr_b16 a[10:11], v226 offset:5120
  v_mfma_f32_32x32x16_bf16 v[176:191], a[28:31], a[52:55], v[176:191]
  ds_read_b64_tr_b16 a[12:13], v227 offset:4096
  ds_read_b64_tr_b16 a[14:15], v227 offset:5120
  v_mfma_f32_4x4x4_16b_bf16 v[208:211], v[216:217], a[16:17], v[208:211]
  v_mfma_f32_4x4x4_16b_bf16 v[212:215], v[216:217], a[18:19], v[212:215]
  v_mfma_f32_4x4x4_16b_bf16 v[192:195], a[52:53], a[52:53], v[192:195]
  v_mfma_f32_4x4x4_16b_bf16 v[196:199], a[54:55], a[54:55], v[196:199]
  v_mfma_f32_4x4x4_16b_bf16 v[200:203], v[216:217], a[52:53], v[200:203]
  v_mfma_f32_4x4x4_16b_bf16 v[204:207], v[216:217], a[54:55], v[204:207]
  s_waitcnt lgkmcnt(9)
  v_mfma_f32_32x32x16_bf16 v[128:143], a[32:35], a[56:59], v[128:143]
  ds_read_b128 a[52:55], v234
  ds_read_b64_tr_b16 a[16:17], v224 offset:8192
  ds_read_b64_tr_b16 a[18:19], v224 offset:9216
  v_mfma_f32_32x32x16_bf16 v[144:159], a[36:39], a[56:59], v[144:159]
  ds_read_b64_tr_b16 a[20:21], v225 offset:8192
  ds_read_b64_tr_b16 a[22:23], v225 offset:9216
  v_mfma_f32_32x32x16_bf16 v[160:175], a[40:43], a[56:59], v[160:175]
  ds_read_b64_tr_b16 a[24:25], v226 offset:8192
  ds_read_b64_tr_b16 a[26:27], v226 offset:9216
  v_mfma_f32_32x32x16_bf16 v[176:191], a[44:47], a[56:59], v[176:191]
  ds_read_b64_tr_b16 a[28:29], v227 offset:8192
  ds_read_b64_tr_b16 a[30:31], v227 offset:9216
  s_add_u32 s99, s99, 1
  s_cmp_eq_u32 s99, 10
  s_cselect_b32 s99, 0, s99
  s_lshl_b32 s88, s99, 2
  s_sub_u32 s71, s57, s88
  s_and_b32 s71, s71, 15
  s_cmp_ge_u32 s71, 4
  s_cbranch_scc1 CW_33
  s_lshl_b32 s85, s71, 12
  s_add_u32 s85, s85, 0
  v_add_u32 v36, s85, v224
  s_add_u32 s71, s71, s88
  s_lshl_b32 s71, s71, 10
  s_add_u32 s71, s71, s59
  ds_read_b64_tr_b16 a[64:65], v36
  ds_read_b64_tr_b16 a[66:67], v36 offset:1024
  s_waitcnt lgkmcnt(0)
  buffer_store_dwordx4 a[64:67], v1, s[28:31], s71 offen sc1
CW_33:
  s_cmp_lg_u32 s99, s56
  s_cbranch_scc1 CX_34
  s_lshl_b32 s71, s99, 12
  s_add_u32 s71, s71, s70
  ds_read_b128 a[68:71], v232
  ds_read_b128 a[72:75], v233
  ds_read_b128 a[76:79], v234
  ds_read_b128 a[80:83], v235
  s_waitcnt lgkmcnt(0)
  buffer_store_dwordx4 a[68:71], v1, s[28:31], s71 offen sc1
  buffer_store_dwordx4 a[72:75], v1, s[28:31], s71 offen offset:1024 sc1
  buffer_store_dwordx4 a[76:79], v1, s[28:31], s71 offen offset:2048 sc1
  buffer_store_dwordx4 a[80:83], v1, s[28:31], s71 offen offset:3072 sc1
CX_34:
  v_mfma_f32_4x4x4_16b_bf16 v[208:211], v[216:217], a[32:33], v[208:211]
  v_mfma_f32_4x4x4_16b_bf16 v[212:215], v[216:217], a[34:35], v[212:215]
  v_mfma_f32_4x4x4_16b_bf16 v[192:195], a[56:57], a[56:57], v[192:195]
  v_mfma_f32_4x4x4_16b_bf16 v[196:199], a[58:59], a[58:59], v[196:199]
  v_mfma_f32_4x4x4_16b_bf16 v[200:203], v[216:217], a[56:57], v[200:203]
  v_mfma_f32_4x4x4_16b_bf16 v[204:207], v[216:217], a[58:59], v[204:207]
  s_waitcnt lgkmcnt(9)
  v_mfma_f32_32x32x16_bf16 v[128:143], a[0:3], a[48:51], v[128:143]
  ds_read_b128 a[56:59], v235
  ds_read_b64_tr_b16 a[32:33], v224 offset:12288
  ds_read_b64_tr_b16 a[34:35], v224 offset:13312
  v_mfma_f32_32x32x16_bf16 v[144:159], a[4:7], a[48:51], v[144:159]
  ds_read_b64_tr_b16 a[36:37], v225 offset:12288
  ds_read_b64_tr_b16 a[38:39], v225 offset:13312
  v_mfma_f32_32x32x16_bf16 v[160:175], a[8:11], a[48:51], v[160:175]
  ds_read_b64_tr_b16 a[40:41], v226 offset:12288
  ds_read_b64_tr_b16 a[42:43], v226 offset:13312
  v_mfma_f32_32x32x16_bf16 v[176:191], a[12:15], a[48:51], v[176:191]
  ds_read_b64_tr_b16 a[44:45], v227 offset:12288
  ds_read_b64_tr_b16 a[46:47], v227 offset:13312
  v_mfma_f32_4x4x4_16b_bf16 v[208:211], v[216:217], a[0:1], v[208:211]
  v_mfma_f32_4x4x4_16b_bf16 v[212:215], v[216:217], a[2:3], v[212:215]
  v_mfma_f32_4x4x4_16b_bf16 v[192:195], a[48:49], a[48:49], v[192:195]
  v_mfma_f32_4x4x4_16b_bf16 v[196:199], a[50:51], a[50:51], v[196:199]
  v_mfma_f32_4x4x4_16b_bf16 v[200:203], v[216:217], a[48:49], v[200:203]
  v_mfma_f32_4x4x4_16b_bf16 v[204:207], v[216:217], a[50:51], v[204:207]
  s_waitcnt lgkmcnt(9)
  v_mfma_f32_32x32x16_bf16 v[128:143], a[16:19], a[52:55], v[128:143]
  s_waitcnt vmcnt(4)
  s_waitcnt lgkmcnt(0)
  s_barrier
  ds_read_b128 a[48:51], v232 offset:32768
  ds_read_b64_tr_b16 a[0:1], v224 offset:32768
  ds_read_b64_tr_b16 a[2:3], v224 offset:33792
  v_mfma_f32_32x32x16_bf16 v[144:159], a[20:23], a[52:55], v[144:159]
  ds_read_b64_tr_b16 a[4:5], v225 offset:32768
  ds_read_b64_tr_b16 a[6:7], v225 offset:33792
  v_mfma_f32_32x32x16_bf16 v[160:175], a[24:27], a[52:55], v[160:175]
  ds_read_b64_tr_b16 a[8:9], v226 offset:32768
  ds_read_b64_tr_b16 a[10:11], v226 offset:33792
  v_mfma_f32_32x32x16_bf16 v[176:191], a[28:31], a[52:55], v[176:191]
  ds_read_b64_tr_b16 a[12:13], v227 offset:32768
  ds_read_b64_tr_b16 a[14:15], v227 offset:33792
  v_mfma_f32_4x4x4_16b_bf16 v[208:211], v[216:217], a[16:17], v[208:211]
  v_mfma_f32_4x4x4_16b_bf16 v[212:215], v[216:217], a[18:19], v[212:215]
  v_mfma_f32_4x4x4_16b_bf16 v[192:195], a[52:53], a[52:53], v[192:195]
  v_mfma_f32_4x4x4_16b_bf16 v[196:199], a[54:55], a[54:55], v[196:199]
  v_mfma_f32_4x4x4_16b_bf16 v[200:203], v[216:217], a[52:53], v[200:203]
  v_mfma_f32_4x4x4_16b_bf16 v[204:207], v[216:217], a[54:55], v[204:207]
  v_mfma_f32_32x32x16_bf16 v[128:143], a[32:35], a[56:59], v[128:143]
  ds_read_b128 a[52:55], v233 offset:32768
  ds_read_b64_tr_b16 a[16:17], v224 offset:36864
  ds_read_b64_tr_b16 a[18:19], v224 offset:37888
  v_mfma_f32_32x32x16_bf16 v[144:159], a[36:39], a[56:59], v[144:159]
  ds_read_b64_tr_b16 a[20:21], v225 offset:36864
  ds_read_b64_tr_b16 a[22:23], v225 offset:37888
  v_mfma_f32_32x32x16_bf16 v[160:175], a[40:43], a[56:59], v[160:175]
  ds_read_b64_tr_b16 a[24:25], v226 offset:36864
  ds_read_b64_tr_b16 a[26:27], v226 offset:37888
  v_mfma_f32_32x32x16_bf16 v[176:191], a[44:47], a[56:59], v[176:191]
  ds_read_b64_tr_b16 a[28:29], v227 offset:36864
  ds_read_b64_tr_b16 a[30:31], v227 offset:37888
  v_mfma_f32_4x4x4_16b_bf16 v[208:211], v[216:217], a[32:33], v[208:211]
  v_mfma_f32_4x4x4_16b_bf16 v[212:215], v[216:217], a[34:35], v[212:215]
  v_mfma_f32_4x4x4_16b_bf16 v[192:195], a[56:57], a[56:57], v[192:195]
  v_mfma_f32_4x4x4_16b_bf16 v[196:199], a[58:59], a[58:59], v[196:199]
  v_mfma_f32_4x4x4_16b_bf16 v[200:203], v[216:217], a[56:57], v[200:203]
  v_mfma_f32_4x4x4_16b_bf16 v[204:207], v[216:217], a[58:59], v[204:207]
  s_waitcnt lgkmcnt(9)
  v_mfma_f32_32x32x16_bf16 v[128:143], a[0:3], a[48:51], v[128:143]
  ds_read_b128 a[56:59], v234 offset:32768
  ds_read_b64_tr_b16 a[32:33], v224 offset:40960
  ds_read_b64_tr_b16 a[34:35], v224 offset:41984
  v_mfma_f32_32x32x16_bf16 v[144:159], a[4:7], a[48:51], v[144:159]
  ds_read_b64_tr_b16 a[36:37], v225 offset:40960
  ds_read_b64_tr_b16 a[38:39], v225 offset:41984
  s_waitcnt vmcnt(0)
  ds_read_b64_tr_b16 v[64:65], v15
  ds_read_b64_tr_b16 v[66:67], v15 offset:512
  ds_read_b64_tr_b16 v[68:69], v15 offset:1024
  ds_read_b64_tr_b16 v[70:71], v15 offset:1536
  ds_read_b64_tr_b16 v[72:73], v15 offset:2048
  ds_read_b64_tr_b16 v[74:75], v15 offset:2560
  ds_read_b64_tr_b16 v[76:77], v15 offset:3072
  ds_read_b64_tr_b16 v[78:79], v15 offset:3584
  v_mfma_f32_32x32x16_bf16 v[160:175], a[8:11], a[48:51], v[160:175]
  ds_read_b64_tr_b16 a[40:41], v226 offset:40960
  ds_read_b64_tr_b16 a[42:43], v226 offset:41984
  v_mfma_f32_32x32x16_bf16 v[176:191], a[12:15], a[48:51], v[176:191]
  ds_read_b64_tr_b16 a[44:45], v227 offset:40960
  ds_read_b64_tr_b16 a[46:47], v227 offset:41984
  s_add_u32 s99, s99, 1
  s_cmp_eq_u32 s99, 10
  s_cselect_b32 s99, 0, s99
  s_lshl_b32 s88, s99, 2
  s_sub_u32 s71, s57, s88
  s_and_b32 s71, s71, 15
  s_cmp_ge_u32 s71, 4
  s_cbranch_scc1 CW_35
  s_lshl_b32 s85, s71, 12
  s_add_u32 s85, s85, 32768
  v_add_u32 v36, s85, v224
  s_add_u32 s71, s71, s88
  s_lshl_b32 s71, s71, 10
  s_add_u32 s71, s71, s59
  ds_read_b64_tr_b16 a[64:65], v36
  ds_read_b64_tr_b16 a[66:67], v36 offset:1024
  s_waitcnt lgkmcnt(0)
  buffer_store_dwordx4 a[64:67], v1, s[28:31], s71 offen sc1
CW_35:
  s_cmp_lg_u32 s99, s56
  s_cbranch_scc1 CX_36
  s_lshl_b32 s71, s99, 12
  s_add_u32 s71, s71, s70
  ds_read_b128 a[68:71], v232 offset:32768
  ds_read_b128 a[72:75], v233 offset:32768
  ds_read_b128 a[76:79], v234 offset:32768
  ds_read_b128 a[80:83], v235 offset:32768
  s_waitcnt lgkmcnt(0)
  buffer_store_dwordx4 a[68:71], v1, s[28:31], s71 offen sc1
  buffer_store_dwordx4 a[72:75], v1, s[28:31], s71 offen offset:1024 sc1
  buffer_store_dwordx4 a[76:79], v1, s[28:31], s71 offen offset:2048 sc1
  buffer_store_dwordx4 a[80:83], v1, s[28:31], s71 offen offset:3072 sc1
CX_36:
  v_mfma_f32_4x4x4_16b_bf16 v[208:211], v[216:217], a[0:1], v[208:211]
  v_mfma_f32_4x4x4_16b_bf16 v[212:215], v[216:217], a[2:3], v[212:215]
  v_mfma_f32_4x4x4_16b_bf16 v[192:195], a[48:49], a[48:49], v[192:195]
  v_mfma_f32_4x4x4_16b_bf16 v[196:199], a[50:51], a[50:51], v[196:199]
  v_mfma_f32_4x4x4_16b_bf16 v[200:203], v[216:217], a[48:49], v[200:203]
  v_mfma_f32_4x4x4_16b_bf16 v[204:207], v[216:217], a[50:51], v[204:207]
  v_mfma_f32_32x32x16_bf16 v[128:143], a[16:19], a[52:55], v[128:143]
  ds_read_b128 a[48:51], v235 offset:32768
  ds_read_b64_tr_b16 a[0:1], v224 offset:45056
  ds_read_b64_tr_b16 a[2:3], v224 offset:46080
  s_mul_i32 s87, s38, 3
  s_sub_u32 s40, s40, s87
  s_add_u32 s40, s40, s41
  s_waitcnt lgkmcnt(13)
  buffer_store_dwordx4 v[64:67], v6, s[28:31], s40 offen sc1
  v_mfma_f32_32x32x16_bf16 v[144:159], a[20:23], a[52:55], v[144:159]
  ds_read_b64_tr_b16 a[4:5], v225 offset:45056
  ds_read_b64_tr_b16 a[6:7], v225 offset:46080
  s_add_u32 s40, s40, s38
  s_waitcnt lgkmcnt(13)
  buffer_store_dwordx4 v[68:71], v6, s[28:31], s40 offen sc1
  v_mfma_f32_32x32x16_bf16 v[160:175], a[24:27], a[52:55], v[160:175]
  ds_read_b64_tr_b16 a[8:9], v226 offset:45056
  ds_read_b64_tr_b16 a[10:11], v226 offset:46080
  s_add_u32 s40, s40, s38
  s_waitcnt lgkmcnt(13)
  buffer_store_dwordx4 v[72:75], v6, s[28:31], s40 offen sc1
  v_mfma_f32_32x32x16_bf16 v[176:191], a[28:31], a[52:55], v[176:191]
  ds_read_b64_tr_b16 a[12:13], v227 offset:45056
  ds_read_b64_tr_b16 a[14:15], v227 offset:46080
  s_add_u32 s40, s40, s38
  s_waitcnt lgkmcnt(13)
  buffer_store_dwordx4 v[76:79], v6, s[28:31], s40 offen sc1
  v_mfma_f32_4x4x4_16b_bf16 v[208:211], v[216:217], a[16:17], v[208:211]
  v_mfma_f32_4x4x4_16b_bf16 v[212:215], v[216:217], a[18:19], v[212:215]
  v_mfma_f32_4x4x4_16b_bf16 v[192:195], a[52:53], a[52:53], v[192:195]
  v_mfma_f32_4x4x4_16b_bf16 v[196:199], a[54:55], a[54:55], v[196:199]
  v_mfma_f32_4x4x4_16b_bf16 v[200:203], v[216:217], a[52:53], v[200:203]
  v_mfma_f32_4x4x4_16b_bf16 v[204:207], v[216:217], a[54:55], v[204:207]
  v_mfma_f32_4x4x4_16b_bf16 v[96:99], v[216:217], v[64:65], v[96:99]
  v_mfma_f32_4x4x4_16b_bf16 v[100:103], v[216:217], v[66:67], v[100:103]
  s_nop 0
  v_mfma_f32_4x4x4_16b_bf16 v[96:99], v[216:217], v[68:69], v[96:99]
  v_mfma_f32_4x4x4_16b_bf16 v[100:103], v[216:217], v[70:71], v[100:103]
  s_nop 0
  v_mfma_f32_4x4x4_16b_bf16 v[96:99], v[216:217], v[72:73], v[96:99]
  v_mfma_f32_4x4x4_16b_bf16 v[100:103], v[216:217], v[74:75], v[100:103]
  s_nop 0
  v_mfma_f32_4x4x4_16b_bf16 v[96:99], v[216:217], v[76:77], v[96:99]
  v_mfma_f32_4x4x4_16b_bf16 v[100:103], v[216:217], v[78:79], v[100:103]
  s_waitcnt lgkmcnt(9)
  v_mfma_f32_32x32x16_bf16 v[128:143], a[32:35], a[56:59], v[128:143]
  v_mfma_f32_32x32x16_bf16 v[144:159], a[36:39], a[56:59], v[144:159]
  v_mfma_f32_32x32x16_bf16 v[160:175], a[40:43], a[56:59], v[160:175]
  v_mfma_f32_32x32x16_bf16 v[176:191], a[44:47], a[56:59], v[176:191]
  v_mfma_f32_4x4x4_16b_bf16 v[208:211], v[216:217], a[32:33], v[208:211]
  v_mfma_f32_4x4x4_16b_bf16 v[212:215], v[216:217], a[34:35], v[212:215]
  v_mfma_f32_4x4x4_16b_bf16 v[192:195], a[56:57], a[56:57], v[192:195]
  v_mfma_f32_4x4x4_16b_bf16 v[196:199], a[58:59], a[58:59], v[196:199]
  v_mfma_f32_4x4x4_16b_bf16 v[200:203], v[216:217], a[56:57], v[200:203]
  v_mfma_f32_4x4x4_16b_bf16 v[204:207], v[216:217], a[58:59], v[204:207]
  v_add_f32 v96, v96, v100
  buffer_store_dword v96, v7, s[28:31], s42 offen sc1
  s_waitcnt lgkmcnt(0)
  v_mfma_f32_32x32x16_bf16 v[128:143], a[0:3], a[48:51], v[128:143]
  v_mfma_f32_32x32x16_bf16 v[144:159], a[4:7], a[48:51], v[144:159]
  v_mfma_f32_32x32x16_bf16 v[160:175], a[8:11], a[48:51], v[160:175]
  v_mfma_f32_32x32x16_bf16 v[176:191], a[12:15], a[48:51], v[176:191]
  v_mfma_f32_4x4x4_16b_bf16 v[208:211], v[216:217], a[0:1], v[208:211]
  v_mfma_f32_4x4x4_16b_bf16 v[212:215], v[216:217], a[2:3], v[212:215]
  v_mfma_f32_4x4x4_16b_bf16 v[192:195], a[48:49], a[48:49], v[192:195]
  v_mfma_f32_4x4x4_16b_bf16 v[196:199], a[50:51], a[50:51], v[196:199]
  v_mfma_f32_4x4x4_16b_bf16 v[200:203], v[216:217], a[48:49], v[200:203]
  v_mfma_f32_4x4x4_16b_bf16 v[204:207], v[216:217], a[50:51], v[204:207]
  s_nop 0
  v_add_f32 v40, v208, v212
  v_mov_b32 v41, 0
  v_add_f32 v192, v192, v196
  v_add_f32 v193, v193, v197
  v_add_f32 v194, v194, v198
  v_add_f32 v195, v195, v199
  v_add_f32 v20, v200, v204
  v_permlane32_swap_b32 v40, v41
  v_add_f32 v41, v40, v41
  v_cmp_eq_u32 vcc, 1, v17
  s_nop 1
  v_cndmask_b32 v21, v192, v193, vcc
  v_cmp_eq_u32 vcc, 2, v17
  s_nop 1
  v_cndmask_b32 v21, v21, v194, vcc
  v_cmp_eq_u32 vcc, 3, v17
  s_nop 1
  v_cndmask_b32 v21, v21, v195, vcc
  v_cvt_pk_bf16_f32 v42, v41, v41
  v_and_b32 v43, 0xffff0000, v42
  v_sub_f32 v43, v41, v43
  v_cvt_pk_bf16_f32 v44, v41, v43
  v_and_b32 v45, 0xffff, v42
  s_lshl_b32 s36, s3, 9
  s_add_u32 s36, s36, 147456
  v_lshl_add_u32 v46, v0, 3, s36
  ds_write_b64 v46, v[44:45]
  v_mov_b32 v22, v20
  v_mov_b32 v23, v21
  s_nop 0
  v_permlane32_swap_b32 v20, v22
  v_permlane32_swap_b32 v21, v23
  v_add_f32 v20, v20, v22
  v_add_f32 v21, v21, v23
  v_mul_f32 v20, 0xbacccccd, v20
  v_mul_f32 v21, 0x3acccccd, v21
  v_fma_f32 v21, -v20, v20, v21
  v_max_f32 v21, 0, v21
  v_add_f32 v21, 0x3727c5ac, v21
  v_rsq_f32 v24, v21
  v_cvt_pk_bf16_f32 v26, v20, v20
  v_and_b32 v22, 0xffff0000, v26
  v_sub_f32 v22, v20, v22
  v_cvt_pk_bf16_f32 v27, v22, 0
  v_mul_f32 v24, s84, v24
  v_mov_b32 v25, v24
  s_lshl_b32 s36, s76, 9
  s_add_u32 s36, s36, 147456
  v_lshl_add_u32 v48, v0, 3, s36
  s_lshl_b32 s36, s77, 9
  s_add_u32 s36, s36, 147456
  v_lshl_add_u32 v49, v0, 3, s36
  s_lshl_b32 s36, s78, 9
  s_add_u32 s36, s36, 147456
  v_lshl_add_u32 v50, v0, 3, s36
  s_lshl_b32 s36, s79, 9
  s_add_u32 s36, s36, 147456
  v_lshl_add_u32 v51, v0, 3, s36
  s_waitcnt lgkmcnt(0)
  s_barrier
  ds_read_b64 v[28:29], v48
  ds_read_b64 v[30:31], v49
  ds_read_b64 v[32:33], v50
  ds_read_b64 v[34:35], v51
  s_waitcnt lgkmcnt(3)
  v_mfma_f32_32x32x8_bf16 v[128:143], v[28:29], v[26:27], v[128:143]
  s_waitcnt lgkmcnt(2)
  v_mfma_f32_32x32x8_bf16 v[144:159], v[30:31], v[26:27], v[144:159]
  s_waitcnt lgkmcnt(1)
  v_mfma_f32_32x32x8_bf16 v[160:175], v[32:33], v[26:27], v[160:175]
  s_waitcnt lgkmcnt(0)
  v_mfma_f32_32x32x8_bf16 v[176:191], v[34:35], v[26:27], v[176:191]
  s_cmp_lg_u32 s57, 0
  s_cbranch_scc1 CSW_37
  s_lshl_b32 s36, s58, 7
  s_add_u32 s36, s36, 7028736
  v_mul_u32_u24 v46, 21504, v9
  v_lshl_add_u32 v46, v8, 2, v46
  v_mov_b32 v43, 0
  buffer_store_dword v41, v46, s[28:31], s36 offen
  s_add_u32 s36, s36, 43008
  buffer_store_dword v43, v46, s[28:31], s36 offen
  s_add_u32 s36, s36, 43008
  buffer_store_dword v43, v46, s[28:31], s36 offen
  s_add_u32 s36, s36, 43008
  buffer_store_dword v43, v46, s[28:31], s36 offen
  s_add_u32 s36, s36, 43008
  buffer_store_dword v43, v46, s[28:31], s36 offen
CSW_37:
  s_nop 3
  v_pk_mul_f32 v[128:129], v[128:129], v[24:25]
  v_pk_mul_f32 v[130:131], v[130:131], v[24:25]
  v_pk_mul_f32 v[132:133], v[132:133], v[24:25]
  v_pk_mul_f32 v[134:135], v[134:135], v[24:25]
  v_cvt_pk_bf16_f32 v48, v128, v129
  v_cvt_pk_bf16_f32 v49, v130, v131
  v_cvt_pk_bf16_f32 v50, v132, v133
  v_cvt_pk_bf16_f32 v51, v134, v135
  buffer_store_dwordx4 v[48:51], v1, s[28:31], s80 offen sc1
  v_pk_mul_f32 v[136:137], v[136:137], v[24:25]
  v_pk_mul_f32 v[138:139], v[138:139], v[24:25]
  v_pk_mul_f32 v[140:141], v[140:141], v[24:25]
  v_pk_mul_f32 v[142:143], v[142:143], v[24:25]
  v_cvt_pk_bf16_f32 v52, v136, v137
  v_cvt_pk_bf16_f32 v53, v138, v139
  v_cvt_pk_bf16_f32 v54, v140, v141
  v_cvt_pk_bf16_f32 v55, v142, v143
  buffer_store_dwordx4 v[52:55], v1, s[28:31], s80 offen offset:1024 sc1
  v_pk_mul_f32 v[144:145], v[144:145], v[24:25]
  v_pk_mul_f32 v[146:147], v[146:147], v[24:25]
  v_pk_mul_f32 v[148:149], v[148:149], v[24:25]
  v_pk_mul_f32 v[150:151], v[150:151], v[24:25]
  v_cvt_pk_bf16_f32 v56, v144, v145
  v_cvt_pk_bf16_f32 v57, v146, v147
  v_cvt_pk_bf16_f32 v58, v148, v149
  v_cvt_pk_bf16_f32 v59, v150, v151
  buffer_store_dwordx4 v[56:59], v1, s[28:31], s81 offen sc1
  v_pk_mul_f32 v[152:153], v[152:153], v[24:25]
  v_pk_mul_f32 v[154:155], v[154:155], v[24:25]
  v_pk_mul_f32 v[156:157], v[156:157], v[24:25]
  v_pk_mul_f32 v[158:159], v[158:159], v[24:25]
  v_cvt_pk_bf16_f32 v60, v152, v153
  v_cvt_pk_bf16_f32 v61, v154, v155
  v_cvt_pk_bf16_f32 v62, v156, v157
  v_cvt_pk_bf16_f32 v63, v158, v159
  buffer_store_dwordx4 v[60:63], v1, s[28:31], s81 offen offset:1024 sc1
  v_pk_mul_f32 v[160:161], v[160:161], v[24:25]
  v_pk_mul_f32 v[162:163], v[162:163], v[24:25]
  v_pk_mul_f32 v[164:165], v[164:165], v[24:25]
  v_pk_mul_f32 v[166:167], v[166:167], v[24:25]
  v_cvt_pk_bf16_f32 v48, v160, v161
  v_cvt_pk_bf16_f32 v49, v162, v163
  v_cvt_pk_bf16_f32 v50, v164, v165
  v_cvt_pk_bf16_f32 v51, v166, v167
  buffer_store_dwordx4 v[48:51], v1, s[28:31], s82 offen sc1
  v_pk_mul_f32 v[168:169], v[168:169], v[24:25]
  v_pk_mul_f32 v[170:171], v[170:171], v[24:25]
  v_pk_mul_f32 v[172:173], v[172:173], v[24:25]
  v_pk_mul_f32 v[174:175], v[174:175], v[24:25]
  v_cvt_pk_bf16_f32 v52, v168, v169
  v_cvt_pk_bf16_f32 v53, v170, v171
  v_cvt_pk_bf16_f32 v54, v172, v173
  v_cvt_pk_bf16_f32 v55, v174, v175
  buffer_store_dwordx4 v[52:55], v1, s[28:31], s82 offen offset:1024 sc1
  v_pk_mul_f32 v[176:177], v[176:177], v[24:25]
  v_pk_mul_f32 v[178:179], v[178:179], v[24:25]
  v_pk_mul_f32 v[180:181], v[180:181], v[24:25]
  v_pk_mul_f32 v[182:183], v[182:183], v[24:25]
  v_cvt_pk_bf16_f32 v56, v176, v177
  v_cvt_pk_bf16_f32 v57, v178, v179
  v_cvt_pk_bf16_f32 v58, v180, v181
  v_cvt_pk_bf16_f32 v59, v182, v183
  buffer_store_dwordx4 v[56:59], v1, s[28:31], s83 offen sc1
  v_pk_mul_f32 v[184:185], v[184:185], v[24:25]
  v_pk_mul_f32 v[186:187], v[186:187], v[24:25]
  v_pk_mul_f32 v[188:189], v[188:189], v[24:25]
  v_pk_mul_f32 v[190:191], v[190:191], v[24:25]
  v_cvt_pk_bf16_f32 v60, v184, v185
  v_cvt_pk_bf16_f32 v61, v186, v187
  v_cvt_pk_bf16_f32 v62, v188, v189
  v_cvt_pk_bf16_f32 v63, v190, v191
  buffer_store_dwordx4 v[60:63], v1, s[28:31], s83 offen offset:1024 sc1
  s_nop 1
  s_branch K1E_15
K1V_16:
  s_sub_u32 s37, s56, 10
  s_lshl_b32 s36, s37, 11
  s_add_u32 s36, s36, s47
  s_add_u32 s36, s36, 20893696
  s_lshl_b32 s37, s76, 9
  s_add_u32 s80, s36, s37
  s_lshl_b32 s37, s77, 9
  s_add_u32 s81, s36, s37
  s_lshl_b32 s37, s78, 9
  s_add_u32 s82, s36, s37
  s_lshl_b32 s37, s79, 9
  s_add_u32 s83, s36, s37
  v_mul_u32_u24 v218, 10240, v9
  v_lshl_add_u32 v218, v8, 4, v218
  v_add_u32 v219, 20480, v218
  s_mov_b32 s89, s36
  v_mul_u32_u24 v220, 10240, v11
  v_lshl_add_u32 v220, v10, 7, v220
  s_add_u32 m0, s45, 16384
  s_add_u32 s48, s47, 0
  buffer_load_dwordx4 v104, s[60:63], s48 offen lds
  buffer_load_dwordx4 v105, s[60:63], s48 offen offset:1024 lds
  buffer_load_dwordx4 v106, s[60:63], s48 offen offset:2048 lds
  buffer_load_dwordx4 v107, s[60:63], s48 offen offset:3072 lds
  s_add_u32 m0, s45, 32768
  s_add_u32 s48, s44, 245760
  buffer_load_dwordx4 v108, s[64:67], s48 offen lds
  buffer_load_dwordx4 v109, s[64:67], s48 offen offset:1024 lds
  buffer_load_dwordx4 v110, s[64:67], s48 offen offset:2048 lds
  buffer_load_dwordx4 v111, s[64:67], s48 offen offset:3072 lds
  s_add_u32 m0, s45, 49152
  s_add_u32 s48, s47, 128
  buffer_load_dwordx4 v104, s[60:63], s48 offen lds
  buffer_load_dwordx4 v105, s[60:63], s48 offen offset:1024 lds
  buffer_load_dwordx4 v106, s[60:63], s48 offen offset:2048 lds
  buffer_load_dwordx4 v107, s[60:63], s48 offen offset:3072 lds
  s_waitcnt vmcnt(8)
  s_barrier
  ds_read_b128 a[48:51], v232
  ds_read_b64_tr_b16 a[0:1], v224
  ds_read_b64_tr_b16 a[2:3], v224 offset:1024
  ds_read_b64_tr_b16 a[4:5], v225
  ds_read_b64_tr_b16 a[6:7], v225 offset:1024
  ds_read_b64_tr_b16 a[8:9], v226
  ds_read_b64_tr_b16 a[10:11], v226 offset:1024
  ds_read_b64_tr_b16 a[12:13], v227
  ds_read_b64_tr_b16 a[14:15], v227 offset:1024
  ds_read_b128 a[52:55], v233
  ds_read_b64_tr_b16 a[16:17], v224 offset:4096
  ds_read_b64_tr_b16 a[18:19], v224 offset:5120
  ds_read_b64_tr_b16 a[20:21], v225 offset:4096
  ds_read_b64_tr_b16 a[22:23], v225 offset:5120
  ds_read_b64_tr_b16 a[24:25], v226 offset:4096
  ds_read_b64_tr_b16 a[26:27], v226 offset:5120
  ds_read_b64_tr_b16 a[28:29], v227 offset:4096
  ds_read_b64_tr_b16 a[30:31], v227 offset:5120
  s_waitcnt lgkmcnt(9)
  v_mfma_f32_32x32x16_bf16 v[128:143], a[48:51], a[0:3], 0
  ds_read_b128 a[56:59], v234
  ds_read_b64_tr_b16 a[32:33], v224 offset:8192
  ds_read_b64_tr_b16 a[34:35], v224 offset:9216
  s_add_u32 m0, s45, 65536
  s_add_u32 s48, s44, 491520
  buffer_load_dwordx4 v108, s[64:67], s48 offen lds
  buffer_load_dwordx4 v109, s[64:67], s48 offen offset:1024 lds
  v_mfma_f32_32x32x16_bf16 v[144:159], a[48:51], a[4:7], 0
  ds_read_b64_tr_b16 a[36:37], v225 offset:8192
  ds_read_b64_tr_b16 a[38:39], v225 offset:9216
  buffer_load_dwordx4 v110, s[64:67], s48 offen offset:2048 lds
  buffer_load_dwordx4 v111, s[64:67], s48 offen offset:3072 lds
  v_mfma_f32_32x32x16_bf16 v[160:175], a[48:51], a[8:11], 0
  ds_read_b64_tr_b16 a[40:41], v226 offset:8192
  ds_read_b64_tr_b16 a[42:43], v226 offset:9216
  s_add_u32 m0, s45, 81920
  s_add_u32 s48, s47, 256
  buffer_load_dwordx4 v104, s[60:63], s48 offen lds
  buffer_load_dwordx4 v105, s[60:63], s48 offen offset:1024 lds
  v_mfma_f32_32x32x16_bf16 v[176:191], a[48:51], a[12:15], 0
  ds_read_b64_tr_b16 a[44:45], v227 offset:8192
  ds_read_b64_tr_b16 a[46:47], v227 offset:9216
  buffer_load_dwordx4 v106, s[60:63], s48 offen offset:2048 lds
  buffer_load_dwordx4 v107, s[60:63], s48 offen offset:3072 lds
  s_lshl_b32 s88, s99, 2
  s_sub_u32 s71, s57, s88
  s_and_b32 s71, s71, 15
  s_cmp_ge_u32 s71, 4
  s_cbranch_scc1 CW_38
  s_lshl_b32 s85, s71, 12
  s_add_u32 s85, s85, 0
  v_add_u32 v36, s85, v224
  s_add_u32 s71, s71, s88
  s_lshl_b32 s71, s71, 10
  s_add_u32 s71, s71, s59
  ds_read_b64_tr_b16 a[64:65], v36
  ds_read_b64_tr_b16 a[66:67], v36 offset:1024
  s_waitcnt lgkmcnt(0)
  buffer_store_dwordx4 a[64:67], v1, s[28:31], s71 offen sc1
CW_38:
  s_cmp_lg_u32 s99, s56
  s_cbranch_scc1 CX_39
  s_lshl_b32 s71, s99, 12
  s_add_u32 s71, s71, s70
  ds_read_b128 a[68:71], v232
  ds_read_b128 a[72:75], v233
  ds_read_b128 a[76:79], v234
  ds_read_b128 a[80:83], v235
  s_waitcnt lgkmcnt(0)
  buffer_store_dwordx4 a[68:71], v1, s[28:31], s71 offen sc1
  buffer_store_dwordx4 a[72:75], v1, s[28:31], s71 offen offset:1024 sc1
  buffer_store_dwordx4 a[76:79], v1, s[28:31], s71 offen offset:2048 sc1
  buffer_store_dwordx4 a[80:83], v1, s[28:31], s71 offen offset:3072 sc1
CX_39:
  v_mfma_f32_4x4x4_16b_bf16 v[208:211], v[216:217], a[0:1], 0
  v_mfma_f32_4x4x4_16b_bf16 v[212:215], v[216:217], a[2:3], 0
  v_mfma_f32_4x4x4_16b_bf16 v[192:195], a[48:49], a[48:49], 0
  v_mfma_f32_4x4x4_16b_bf16 v[196:199], a[50:51], a[50:51], 0
  v_mfma_f32_4x4x4_16b_bf16 v[200:203], v[216:217], a[48:49], 0
  v_mfma_f32_4x4x4_16b_bf16 v[204:207], v[216:217], a[50:51], 0
  s_waitcnt lgkmcnt(9)
  v_mfma_f32_32x32x16_bf16 v[128:143], a[52:55], a[16:19], v[128:143]
  ds_read_b128 a[48:51], v235
  ds_read_b64_tr_b16 a[0:1], v224 offset:12288
  ds_read_b64_tr_b16 a[2:3], v224 offset:13312
  s_add_u32 m0, s45, 98304
  s_add_u32 s48, s44, 737280
  buffer_load_dwordx4 v108, s[64:67], s48 offen lds
  buffer_load_dwordx4 v109, s[64:67], s48 offen offset:1024 lds
  v_mfma_f32_32x32x16_bf16 v[144:159], a[52:55], a[20:23], v[144:159]
  ds_read_b64_tr_b16 a[4:5], v225 offset:12288
  ds_read_b64_tr_b16 a[6:7], v225 offset:13312
  buffer_load_dwordx4 v110, s[64:67], s48 offen offset:2048 lds
  buffer_load_dwordx4 v111, s[64:67], s48 offen offset:3072 lds
  v_mfma_f32_32x32x16_bf16 v[160:175], a[52:55], a[24:27], v[160:175]
  ds_read_b64_tr_b16 a[8:9], v226 offset:12288
  ds_read_b64_tr_b16 a[10:11], v226 offset:13312
  s_add_u32 m0, s45, 114688
  s_add_u32 s48, s47, 384
  buffer_load_dwordx4 v104, s[60:63], s48 offen lds
  buffer_load_dwordx4 v105, s[60:63], s48 offen offset:1024 lds
  v_mfma_f32_32x32x16_bf16 v[176:191], a[52:55], a[28:31], v[176:191]
  ds_read_b64_tr_b16 a[12:13], v227 offset:12288
  ds_read_b64_tr_b16 a[14:15], v227 offset:13312
  buffer_load_dwordx4 v106, s[60:63], s48 offen offset:2048 lds
  buffer_load_dwordx4 v107, s[60:63], s48 offen offset:3072 lds
  v_mfma_f32_4x4x4_16b_bf16 v[208:211], v[216:217], a[16:17], v[208:211]
  v_mfma_f32_4x4x4_16b_bf16 v[212:215], v[216:217], a[18:19], v[212:215]
  v_mfma_f32_4x4x4_16b_bf16 v[192:195], a[52:53], a[52:53], v[192:195]
  v_mfma_f32_4x4x4_16b_bf16 v[196:199], a[54:55], a[54:55], v[196:199]
  v_mfma_f32_4x4x4_16b_bf16 v[200:203], v[216:217], a[52:53], v[200:203]
  v_mfma_f32_4x4x4_16b_bf16 v[204:207], v[216:217], a[54:55], v[204:207]
  s_waitcnt lgkmcnt(9)
  v_mfma_f32_32x32x16_bf16 v[128:143], a[56:59], a[32:35], v[128:143]
  s_waitcnt vmcnt(16)
  s_waitcnt lgkmcnt(0)
  s_barrier
  ds_read_b128 a[52:55], v232 offset:32768
  ds_read_b64_tr_b16 a[16:17], v224 offset:32768
  ds_read_b64_tr_b16 a[18:19], v224 offset:33792
  s_add_u32 m0, s45, 0
  s_add_u32 s48, s44, 983040
  buffer_load_dwordx4 v108, s[64:67], s48 offen lds
  v_mfma_f32_32x32x16_bf16 v[144:159], a[56:59], a[36:39], v[144:159]
  ds_read_b64_tr_b16 a[20:21], v225 offset:32768
  ds_read_b64_tr_b16 a[22:23], v225 offset:33792
  buffer_load_dwordx4 v109, s[64:67], s48 offen offset:1024 lds
  v_mfma_f32_32x32x16_bf16 v[160:175], a[56:59], a[40:43], v[160:175]
  ds_read_b64_tr_b16 a[24:25], v226 offset:32768
  ds_read_b64_tr_b16 a[26:27], v226 offset:33792
  buffer_load_dwordx4 v110, s[64:67], s48 offen offset:2048 lds
  v_mfma_f32_32x32x16_bf16 v[176:191], a[56:59], a[44:47], v[176:191]
  ds_read_b64_tr_b16 a[28:29], v227 offset:32768
  ds_read_b64_tr_b16 a[30:31], v227 offset:33792
  buffer_load_dwordx4 v111, s[64:67], s48 offen offset:3072 lds
  v_mfma_f32_4x4x4_16b_bf16 v[208:211], v[216:217], a[32:33], v[208:211]
  v_mfma_f32_4x4x4_16b_bf16 v[212:215], v[216:217], a[34:35], v[212:215]
  v_mfma_f32_4x4x4_16b_bf16 v[192:195], a[56:57], a[56:57], v[192:195]
  v_mfma_f32_4x4x4_16b_bf16 v[196:199], a[58:59], a[58:59], v[196:199]
  v_mfma_f32_4x4x4_16b_bf16 v[200:203], v[216:217], a[56:57], v[200:203]
  v_mfma_f32_4x4x4_16b_bf16 v[204:207], v[216:217], a[58:59], v[204:207]
  v_mfma_f32_32x32x16_bf16 v[128:143], a[48:51], a[0:3], v[128:143]
  ds_read_b128 a[56:59], v233 offset:32768
  ds_read_b64_tr_b16 a[32:33], v224 offset:36864
  ds_read_b64_tr_b16 a[34:35], v224 offset:37888
  s_add_u32 m0, s45, 16384
  s_add_u32 s48, s47, 512
  buffer_load_dwordx4 v104, s[60:63], s48 offen lds
  v_mfma_f32_32x32x16_bf16 v[144:159], a[48:51], a[4:7], v[144:159]
  ds_read_b64_tr_b16 a[36:37], v225 offset:36864
  ds_read_b64_tr_b16 a[38:39], v225 offset:37888
  buffer_load_dwordx4 v105, s[60:63], s48 offen offset:1024 lds
  v_mfma_f32_32x32x16_bf16 v[160:175], a[48:51], a[8:11], v[160:175]
  ds_read_b64_tr_b16 a[40:41], v226 offset:36864
  ds_read_b64_tr_b16 a[42:43], v226 offset:37888
  buffer_load_dwordx4 v106, s[60:63], s48 offen offset:2048 lds
  v_mfma_f32_32x32x16_bf16 v[176:191], a[48:51], a[12:15], v[176:191]
  ds_read_b64_tr_b16 a[44:45], v227 offset:36864
  ds_read_b64_tr_b16 a[46:47], v227 offset:37888
  buffer_load_dwordx4 v107, s[60:63], s48 offen offset:3072 lds
  v_mfma_f32_4x4x4_16b_bf16 v[208:211], v[216:217], a[0:1], v[208:211]
  v_mfma_f32_4x4x4_16b_bf16 v[212:215], v[216:217], a[2:3], v[212:215]
  v_mfma_f32_4x4x4_16b_bf16 v[192:195], a[48:49], a[48:49], v[192:195]
  v_mfma_f32_4x4x4_16b_bf16 v[196:199], a[50:51], a[50:51], v[196:199]
  v_mfma_f32_4x4x4_16b_bf16 v[200:203], v[216:217], a[48:49], v[200:203]
  v_mfma_f32_4x4x4_16b_bf16 v[204:207], v[216:217], a[50:51], v[204:207]
  s_waitcnt lgkmcnt(9)
  v_mfma_f32_32x32x16_bf16 v[128:143], a[52:55], a[16:19], v[128:143]
  ds_read_b128 a[48:51], v234 offset:32768
  ds_read_b64_tr_b16 a[0:1], v224 offset:40960
  ds_read_b64_tr_b16 a[2:3], v224 offset:41984
  s_add_u32 m0, s43, 0
  s_mul_i32 s87, s91, 0
  s_add_u32 s87, s87, s90
  buffer_load_dwordx4 v37, s[20:23], s87 offen nt lds
  v_mfma_f32_32x32x16_bf16 v[144:159], a[52:55], a[20:23], v[144:159]
  ds_read_b64_tr_b16 a[4:5], v225 offset:40960
  ds_read_b64_tr_b16 a[6:7], v225 offset:41984
  v_mfma_f32_32x32x16_bf16 v[160:175], a[52:55], a[24:27], v[160:175]
  ds_read_b64_tr_b16 a[8:9], v226 offset:40960
  ds_read_b64_tr_b16 a[10:11], v226 offset:41984
  v_mfma_f32_32x32x16_bf16 v[176:191], a[52:55], a[28:31], v[176:191]
  ds_read_b64_tr_b16 a[12:13], v227 offset:40960
  ds_read_b64_tr_b16 a[14:15], v227 offset:41984
  s_add_u32 s99, s99, 1
  s_cmp_eq_u32 s99, 10
  s_cselect_b32 s99, 0, s99
  s_lshl_b32 s88, s99, 2
  s_sub_u32 s71, s57, s88
  s_and_b32 s71, s71, 15
  s_cmp_ge_u32 s71, 4
  s_cbranch_scc1 CW_40
  s_lshl_b32 s85, s71, 12
  s_add_u32 s85, s85, 32768
  v_add_u32 v36, s85, v224
  s_add_u32 s71, s71, s88
  s_lshl_b32 s71, s71, 10
  s_add_u32 s71, s71, s59
  ds_read_b64_tr_b16 a[64:65], v36
  ds_read_b64_tr_b16 a[66:67], v36 offset:1024
  s_waitcnt lgkmcnt(0)
  buffer_store_dwordx4 a[64:67], v1, s[28:31], s71 offen sc1
CW_40:
  s_cmp_lg_u32 s99, s56
  s_cbranch_scc1 CX_41
  s_lshl_b32 s71, s99, 12
  s_add_u32 s71, s71, s70
  ds_read_b128 a[68:71], v232 offset:32768
  ds_read_b128 a[72:75], v233 offset:32768
  ds_read_b128 a[76:79], v234 offset:32768
  ds_read_b128 a[80:83], v235 offset:32768
  s_waitcnt lgkmcnt(0)
  buffer_store_dwordx4 a[68:71], v1, s[28:31], s71 offen sc1
  buffer_store_dwordx4 a[72:75], v1, s[28:31], s71 offen offset:1024 sc1
  buffer_store_dwordx4 a[76:79], v1, s[28:31], s71 offen offset:2048 sc1
  buffer_store_dwordx4 a[80:83], v1, s[28:31], s71 offen offset:3072 sc1
CX_41:
  v_mfma_f32_4x4x4_16b_bf16 v[208:211], v[216:217], a[16:17], v[208:211]
  v_mfma_f32_4x4x4_16b_bf16 v[212:215], v[216:217], a[18:19], v[212:215]
  v_mfma_f32_4x4x4_16b_bf16 v[192:195], a[52:53], a[52:53], v[192:195]
  v_mfma_f32_4x4x4_16b_bf16 v[196:199], a[54:55], a[54:55], v[196:199]
  v_mfma_f32_4x4x4_16b_bf16 v[200:203], v[216:217], a[52:53], v[200:203]
  v_mfma_f32_4x4x4_16b_bf16 v[204:207], v[216:217], a[54:55], v[204:207]
  s_waitcnt lgkmcnt(9)
  v_mfma_f32_32x32x16_bf16 v[128:143], a[56:59], a[32:35], v[128:143]
  ds_read_b128 a[52:55], v235 offset:32768
  ds_read_b64_tr_b16 a[16:17], v224 offset:45056
  ds_read_b64_tr_b16 a[18:19], v224 offset:46080
  s_add_u32 m0, s43, 1024
  s_mul_i32 s87, s91, 1
  s_add_u32 s87, s87, s90
  buffer_load_dwordx4 v37, s[20:23], s87 offen nt lds
  v_mfma_f32_32x32x16_bf16 v[144:159], a[56:59], a[36:39], v[144:159]
  ds_read_b64_tr_b16 a[20:21], v225 offset:45056
  ds_read_b64_tr_b16 a[22:23], v225 offset:46080
  v_mfma_f32_32x32x16_bf16 v[160:175], a[56:59], a[40:43], v[160:175]
  ds_read_b64_tr_b16 a[24:25], v226 offset:45056
  ds_read_b64_tr_b16 a[26:27], v226 offset:46080
  v_mfma_f32_32x32x16_bf16 v[176:191], a[56:59], a[44:47], v[176:191]
  ds_read_b64_tr_b16 a[28:29], v227 offset:45056
  ds_read_b64_tr_b16 a[30:31], v227 offset:46080
  v_mfma_f32_4x4x4_16b_bf16 v[208:211], v[216:217], a[32:33], v[208:211]
  v_mfma_f32_4x4x4_16b_bf16 v[212:215], v[216:217], a[34:35], v[212:215]
  v_mfma_f32_4x4x4_16b_bf16 v[192:195], a[56:57], a[56:57], v[192:195]
  v_mfma_f32_4x4x4_16b_bf16 v[196:199], a[58:59], a[58:59], v[196:199]
  v_mfma_f32_4x4x4_16b_bf16 v[200:203], v[216:217], a[56:57], v[200:203]
  v_mfma_f32_4x4x4_16b_bf16 v[204:207], v[216:217], a[58:59], v[204:207]
  s_waitcnt lgkmcnt(9)
  v_mfma_f32_32x32x16_bf16 v[128:143], a[48:51], a[0:3], v[128:143]
  s_waitcnt vmcnt(18)
  s_waitcnt lgkmcnt(0)
  s_barrier
  ds_read_b128 a[56:59], v236
  ds_read_b64_tr_b16 a[32:33], v228
  ds_read_b64_tr_b16 a[34:35], v228 offset:1024
  s_add_u32 m0, s45, 32768
  s_add_u32 s48, s44, 1228800
  buffer_load_dwordx4 v108, s[64:67], s48 offen lds
  v_mfma_f32_32x32x16_bf16 v[144:159], a[48:51], a[4:7], v[144:159]
  ds_read_b64_tr_b16 a[36:37], v229
  ds_read_b64_tr_b16 a[38:39], v229 offset:1024
  buffer_load_dwordx4 v109, s[64:67], s48 offen offset:1024 lds
  v_mfma_f32_32x32x16_bf16 v[160:175], a[48:51], a[8:11], v[160:175]
  ds_read_b64_tr_b16 a[40:41], v230
  ds_read_b64_tr_b16 a[42:43], v230 offset:1024
  buffer_load_dwordx4 v110, s[64:67], s48 offen offset:2048 lds
  v_mfma_f32_32x32x16_bf16 v[176:191], a[48:51], a[12:15], v[176:191]
  ds_read_b64_tr_b16 a[44:45], v231
  ds_read_b64_tr_b16 a[46:47], v231 offset:1024
  buffer_load_dwordx4 v111, s[64:67], s48 offen offset:3072 lds
  v_mfma_f32_4x4x4_16b_bf16 v[208:211], v[216:217], a[0:1], v[208:211]
  v_mfma_f32_4x4x4_16b_bf16 v[212:215], v[216:217], a[2:3], v[212:215]
  v_mfma_f32_4x4x4_16b_bf16 v[192:195], a[48:49], a[48:49], v[192:195]
  v_mfma_f32_4x4x4_16b_bf16 v[196:199], a[50:51], a[50:51], v[196:199]
  v_mfma_f32_4x4x4_16b_bf16 v[200:203], v[216:217], a[48:49], v[200:203]
  v_mfma_f32_4x4x4_16b_bf16 v[204:207], v[216:217], a[50:51], v[204:207]
  v_mfma_f32_32x32x16_bf16 v[128:143], a[52:55], a[16:19], v[128:143]
  ds_read_b128 a[48:51], v237
  ds_read_b64_tr_b16 a[0:1], v228 offset:4096
  ds_read_b64_tr_b16 a[2:3], v228 offset:5120
  s_add_u32 m0, s45, 49152
  s_add_u32 s48, s47, 640
  buffer_load_dwordx4 v104, s[60:63], s48 offen lds
  v_mfma_f32_32x32x16_bf16 v[144:159], a[52:55], a[20:23], v[144:159]
  ds_read_b64_tr_b16 a[4:5], v229 offset:4096
  ds_read_b64_tr_b16 a[6:7], v229 offset:5120
  buffer_load_dwordx4 v105, s[60:63], s48 offen offset:1024 lds
  v_mfma_f32_32x32x16_bf16 v[160:175], a[52:55], a[24:27], v[160:175]
  ds_read_b64_tr_b16 a[8:9], v230 offset:4096
  ds_read_b64_tr_b16 a[10:11], v230 offset:5120
  buffer_load_dwordx4 v106, s[60:63], s48 offen offset:2048 lds
  v_mfma_f32_32x32x16_bf16 v[176:191], a[52:55], a[28:31], v[176:191]
  ds_read_b64_tr_b16 a[12:13], v231 offset:4096
  ds_read_b64_tr_b16 a[14:15], v231 offset:5120
  buffer_load_dwordx4 v107, s[60:63], s48 offen offset:3072 lds
  v_mfma_f32_4x4x4_16b_bf16 v[208:211], v[216:217], a[16:17], v[208:211]
  v_mfma_f32_4x4x4_16b_bf16 v[212:215], v[216:217], a[18:19], v[212:215]
  v_mfma_f32_4x4x4_16b_bf16 v[192:195], a[52:53], a[52:53], v[192:195]
  v_mfma_f32_4x4x4_16b_bf16 v[196:199], a[54:55], a[54:55], v[196:199]
  v_mfma_f32_4x4x4_16b_bf16 v[200:203], v[216:217], a[52:53], v[200:203]
  v_mfma_f32_4x4x4_16b_bf16 v[204:207], v[216:217], a[54:55], v[204:207]
  s_waitcnt lgkmcnt(9)
  v_mfma_f32_32x32x16_bf16 v[128:143], a[56:59], a[32:35], v[128:143]
  ds_read_b128 a[52:55], v238
  ds_read_b64_tr_b16 a[16:17], v228 offset:8192
  ds_read_b64_tr_b16 a[18:19], v228 offset:9216
  s_add_u32 m0, s43, 2048
  s_mul_i32 s87, s91, 2
  s_add_u32 s87, s87, s90
  buffer_load_dwordx4 v37, s[20:23], s87 offen nt lds
  v_mfma_f32_32x32x16_bf16 v[144:159], a[56:59], a[36:39], v[144:159]
  ds_read_b64_tr_b16 a[20:21], v229 offset:8192
  ds_read_b64_tr_b16 a[22:23], v229 offset:9216
  v_mfma_f32_32x32x16_bf16 v[160:175], a[56:59], a[40:43], v[160:175]
  ds_read_b64_tr_b16 a[24:25], v230 offset:8192
  ds_read_b64_tr_b16 a[26:27], v230 offset:9216
  v_mfma_f32_32x32x16_bf16 v[176:191], a[56:59], a[44:47], v[176:191]
  ds_read_b64_tr_b16 a[28:29], v231 offset:8192
  ds_read_b64_tr_b16 a[30:31], v231 offset:9216
  s_add_u32 s99, s99, 1
  s_cmp_eq_u32 s99, 10
  s_cselect_b32 s99, 0, s99
  s_lshl_b32 s88, s99, 2
  s_sub_u32 s71, s57, s88
  s_and_b32 s71, s71, 15
  s_cmp_ge_u32 s71, 4
  s_cbranch_scc1 CW_42
  s_lshl_b32 s85, s71, 12
  s_add_u32 s85, s85, 65536
  v_add_u32 v36, s85, v224
  s_add_u32 s71, s71, s88
  s_lshl_b32 s71, s71, 10
  s_add_u32 s71, s71, s59
  ds_read_b64_tr_b16 a[64:65], v36
  ds_read_b64_tr_b16 a[66:67], v36 offset:1024
  s_waitcnt lgkmcnt(0)
  buffer_store_dwordx4 a[64:67], v1, s[28:31], s71 offen sc1
CW_42:
  s_cmp_lg_u32 s99, s56
  s_cbranch_scc1 CX_43
  s_lshl_b32 s71, s99, 12
  s_add_u32 s71, s71, s70
  ds_read_b128 a[68:71], v236
  ds_read_b128 a[72:75], v237
  ds_read_b128 a[76:79], v238
  ds_read_b128 a[80:83], v239
  s_waitcnt lgkmcnt(0)
  buffer_store_dwordx4 a[68:71], v1, s[28:31], s71 offen sc1
  buffer_store_dwordx4 a[72:75], v1, s[28:31], s71 offen offset:1024 sc1
  buffer_store_dwordx4 a[76:79], v1, s[28:31], s71 offen offset:2048 sc1
  buffer_store_dwordx4 a[80:83], v1, s[28:31], s71 offen offset:3072 sc1
CX_43:
  v_mfma_f32_4x4x4_16b_bf16 v[208:211], v[216:217], a[32:33], v[208:211]
  v_mfma_f32_4x4x4_16b_bf16 v[212:215], v[216:217], a[34:35], v[212:215]
  v_mfma_f32_4x4x4_16b_bf16 v[192:195], a[56:57], a[56:57], v[192:195]
  v_mfma_f32_4x4x4_16b_bf16 v[196:199], a[58:59], a[58:59], v[196:199]
  v_mfma_f32_4x4x4_16b_bf16 v[200:203], v[216:217], a[56:57], v[200:203]
  v_mfma_f32_4x4x4_16b_bf16 v[204:207], v[216:217], a[58:59], v[204:207]
  s_waitcnt lgkmcnt(9)
  v_mfma_f32_32x32x16_bf16 v[128:143], a[48:51], a[0:3], v[128:143]
  ds_read_b128 a[56:59], v239
  ds_read_b64_tr_b16 a[32:33], v228 offset:12288
  ds_read_b64_tr_b16 a[34:35], v228 offset:13312
  s_add_u32 m0, s43, 3072
  s_mul_i32 s87, s91, 3
  s_add_u32 s87, s87, s90
  buffer_load_dwordx4 v37, s[20:23], s87 offen nt lds
  v_mfma_f32_32x32x16_bf16 v[144:159], a[48:51], a[4:7], v[144:159]
  ds_read_b64_tr_b16 a[36:37], v229 offset:12288
  ds_read_b64_tr_b16 a[38:39], v229 offset:13312
  v_mfma_f32_32x32x16_bf16 v[160:175], a[48:51], a[8:11], v[160:175]
  ds_read_b64_tr_b16 a[40:41], v230 offset:12288
  ds_read_b64_tr_b16 a[42:43], v230 offset:13312
  v_mfma_f32_32x32x16_bf16 v[176:191], a[48:51], a[12:15], v[176:191]
  ds_read_b64_tr_b16 a[44:45], v231 offset:12288
  ds_read_b64_tr_b16 a[46:47], v231 offset:13312
  v_mfma_f32_4x4x4_16b_bf16 v[208:211], v[216:217], a[0:1], v[208:211]
  v_mfma_f32_4x4x4_16b_bf16 v[212:215], v[216:217], a[2:3], v[212:215]
  v_mfma_f32_4x4x4_16b_bf16 v[192:195], a[48:49], a[48:49], v[192:195]
  v_mfma_f32_4x4x4_16b_bf16 v[196:199], a[50:51], a[50:51], v[196:199]
  v_mfma_f32_4x4x4_16b_bf16 v[200:203], v[216:217], a[48:49], v[200:203]
  v_mfma_f32_4x4x4_16b_bf16 v[204:207], v[216:217], a[50:51], v[204:207]
  s_waitcnt lgkmcnt(9)
  v_mfma_f32_32x32x16_bf16 v[128:143], a[52:55], a[16:19], v[128:143]
  s_waitcnt vmcnt(20)
  s_waitcnt lgkmcnt(0)
  s_barrier
  ds_read_b128 a[48:51], v236 offset:32768
  ds_read_b64_tr_b16 a[0:1], v228 offset:32768
  ds_read_b64_tr_b16 a[2:3], v228 offset:33792
  s_add_u32 m0, s45, 65536
  s_add_u32 s48, s44, 1474560
  buffer_load_dwordx4 v108, s[64:67], s48 offen lds
  v_mfma_f32_32x32x16_bf16 v[144:159], a[52:55], a[20:23], v[144:159]
  ds_read_b64_tr_b16 a[4:5], v229 offset:32768
  ds_read_b64_tr_b16 a[6:7], v229 offset:33792
  buffer_load_dwordx4 v109, s[64:67], s48 offen offset:1024 lds
  v_mfma_f32_32x32x16_bf16 v[160:175], a[52:55], a[24:27], v[160:175]
  ds_read_b64_tr_b16 a[8:9], v230 offset:32768
  ds_read_b64_tr_b16 a[10:11], v230 offset:33792
  buffer_load_dwordx4 v110, s[64:67], s48 offen offset:2048 lds
  v_mfma_f32_32x32x16_bf16 v[176:191], a[52:55], a[28:31], v[176:191]
  ds_read_b64_tr_b16 a[12:13], v231 offset:32768
  ds_read_b64_tr_b16 a[14:15], v231 offset:33792
  buffer_load_dwordx4 v111, s[64:67], s48 offen offset:3072 lds
  v_mfma_f32_4x4x4_16b_bf16 v[208:211], v[216:217], a[16:17], v[208:211]
  v_mfma_f32_4x4x4_16b_bf16 v[212:215], v[216:217], a[18:19], v[212:215]
  v_mfma_f32_4x4x4_16b_bf16 v[192:195], a[52:53], a[52:53], v[192:195]
  v_mfma_f32_4x4x4_16b_bf16 v[196:199], a[54:55], a[54:55], v[196:199]
  v_mfma_f32_4x4x4_16b_bf16 v[200:203], v[216:217], a[52:53], v[200:203]
  v_mfma_f32_4x4x4_16b_bf16 v[204:207], v[216:217], a[54:55], v[204:207]
  v_mfma_f32_32x32x16_bf16 v[128:143], a[56:59], a[32:35], v[128:143]
  ds_read_b128 a[52:55], v237 offset:32768
  ds_read_b64_tr_b16 a[16:17], v228 offset:36864
  ds_read_b64_tr_b16 a[18:19], v228 offset:37888
  s_add_u32 m0, s45, 81920
  s_add_u32 s48, s47, 768
  buffer_load_dwordx4 v104, s[60:63], s48 offen lds
  v_mfma_f32_32x32x16_bf16 v[144:159], a[56:59], a[36:39], v[144:159]
  ds_read_b64_tr_b16 a[20:21], v229 offset:36864
  ds_read_b64_tr_b16 a[22:23], v229 offset:37888
  buffer_load_dwordx4 v105, s[60:63], s48 offen offset:1024 lds
  v_mfma_f32_32x32x16_bf16 v[160:175], a[56:59], a[40:43], v[160:175]
  ds_read_b64_tr_b16 a[24:25], v230 offset:36864
  ds_read_b64_tr_b16 a[26:27], v230 offset:37888
  buffer_load_dwordx4 v106, s[60:63], s48 offen offset:2048 lds
  v_mfma_f32_32x32x16_bf16 v[176:191], a[56:59], a[44:47], v[176:191]
  ds_read_b64_tr_b16 a[28:29], v231 offset:36864
  ds_read_b64_tr_b16 a[30:31], v231 offset:37888
  buffer_load_dwordx4 v107, s[60:63], s48 offen offset:3072 lds
  v_mfma_f32_4x4x4_16b_bf16 v[208:211], v[216:217], a[32:33], v[208:211]
  v_mfma_f32_4x4x4_16b_bf16 v[212:215], v[216:217], a[34:35], v[212:215]
  v_mfma_f32_4x4x4_16b_bf16 v[192:195], a[56:57], a[56:57], v[192:195]
  v_mfma_f32_4x4x4_16b_bf16 v[196:199], a[58:59], a[58:59], v[196:199]
  v_mfma_f32_4x4x4_16b_bf16 v[200:203], v[216:217], a[56:57], v[200:203]
  v_mfma_f32_4x4x4_16b_bf16 v[204:207], v[216:217], a[58:59], v[204:207]
  s_waitcnt lgkmcnt(9)
  v_mfma_f32_32x32x16_bf16 v[128:143], a[48:51], a[0:3], v[128:143]
  ds_read_b128 a[56:59], v238 offset:32768
  ds_read_b64_tr_b16 a[32:33], v228 offset:40960
  ds_read_b64_tr_b16 a[34:35], v228 offset:41984
  v_mfma_f32_32x32x16_bf16 v[144:159], a[48:51], a[4:7], v[144:159]
  ds_read_b64_tr_b16 a[36:37], v229 offset:40960
  ds_read_b64_tr_b16 a[38:39], v229 offset:41984
  v_mfma_f32_32x32x16_bf16 v[160:175], a[48:51], a[8:11], v[160:175]
  ds_read_b64_tr_b16 a[40:41], v230 offset:40960
  ds_read_b64_tr_b16 a[42:43], v230 offset:41984
  v_mfma_f32_32x32x16_bf16 v[176:191], a[48:51], a[12:15], v[176:191]
  ds_read_b64_tr_b16 a[44:45], v231 offset:40960
  ds_read_b64_tr_b16 a[46:47], v231 offset:41984
  s_add_u32 s99, s99, 1
  s_cmp_eq_u32 s99, 10
  s_cselect_b32 s99, 0, s99
  s_lshl_b32 s88, s99, 2
  s_sub_u32 s71, s57, s88
  s_and_b32 s71, s71, 15
  s_cmp_ge_u32 s71, 4
  s_cbranch_scc1 CW_44
  s_lshl_b32 s85, s71, 12
  s_add_u32 s85, s85, 98304
  v_add_u32 v36, s85, v224
  s_add_u32 s71, s71, s88
  s_lshl_b32 s71, s71, 10
  s_add_u32 s71, s71, s59
  ds_read_b64_tr_b16 a[64:65], v36
  ds_read_b64_tr_b16 a[66:67], v36 offset:1024
  s_waitcnt lgkmcnt(0)
  buffer_store_dwordx4 a[64:67], v1, s[28:31], s71 offen sc1
CW_44:
  s_cmp_lg_u32 s99, s56
  s_cbranch_scc1 CX_45
  s_lshl_b32 s71, s99, 12
  s_add_u32 s71, s71, s70
  ds_read_b128 a[68:71], v236 offset:32768
  ds_read_b128 a[72:75], v237 offset:32768
  ds_read_b128 a[76:79], v238 offset:32768
  ds_read_b128 a[80:83], v239 offset:32768
  s_waitcnt lgkmcnt(0)
  buffer_store_dwordx4 a[68:71], v1, s[28:31], s71 offen sc1
  buffer_store_dwordx4 a[72:75], v1, s[28:31], s71 offen offset:1024 sc1
  buffer_store_dwordx4 a[76:79], v1, s[28:31], s71 offen offset:2048 sc1
  buffer_store_dwordx4 a[80:83], v1, s[28:31], s71 offen offset:3072 sc1
CX_45:
  v_mfma_f32_4x4x4_16b_bf16 v[208:211], v[216:217], a[0:1], v[208:211]
  v_mfma_f32_4x4x4_16b_bf16 v[212:215], v[216:217], a[2:3], v[212:215]
  v_mfma_f32_4x4x4_16b_bf16 v[192:195], a[48:49], a[48:49], v[192:195]
  v_mfma_f32_4x4x4_16b_bf16 v[196:199], a[50:51], a[50:51], v[196:199]
  v_mfma_f32_4x4x4_16b_bf16 v[200:203], v[216:217], a[48:49], v[200:203]
  v_mfma_f32_4x4x4_16b_bf16 v[204:207], v[216:217], a[50:51], v[204:207]
  s_waitcnt lgkmcnt(9)
  v_mfma_f32_32x32x16_bf16 v[128:143], a[52:55], a[16:19], v[128:143]
  ds_read_b128 a[48:51], v239 offset:32768
  ds_read_b64_tr_b16 a[0:1], v228 offset:45056
  ds_read_b64_tr_b16 a[2:3], v228 offset:46080
  v_mfma_f32_32x32x16_bf16 v[144:159], a[52:55], a[20:23], v[144:159]
  ds_read_b64_tr_b16 a[4:5], v229 offset:45056
  ds_read_b64_tr_b16 a[6:7], v229 offset:46080
  v_mfma_f32_32x32x16_bf16 v[160:175], a[52:55], a[24:27], v[160:175]
  ds_read_b64_tr_b16 a[8:9], v230 offset:45056
  ds_read_b64_tr_b16 a[10:11], v230 offset:46080
  v_mfma_f32_32x32x16_bf16 v[176:191], a[52:55], a[28:31], v[176:191]
  ds_read_b64_tr_b16 a[12:13], v231 offset:45056
  ds_read_b64_tr_b16 a[14:15], v231 offset:46080
  v_mfma_f32_4x4x4_16b_bf16 v[208:211], v[216:217], a[16:17], v[208:211]
  v_mfma_f32_4x4x4_16b_bf16 v[212:215], v[216:217], a[18:19], v[212:215]
  v_mfma_f32_4x4x4_16b_bf16 v[192:195], a[52:53], a[52:53], v[192:195]
  v_mfma_f32_4x4x4_16b_bf16 v[196:199], a[54:55], a[54:55], v[196:199]
  v_mfma_f32_4x4x4_16b_bf16 v[200:203], v[216:217], a[52:53], v[200:203]
  v_mfma_f32_4x4x4_16b_bf16 v[204:207], v[216:217], a[54:55], v[204:207]
  s_waitcnt lgkmcnt(9)
  v_mfma_f32_32x32x16_bf16 v[128:143], a[56:59], a[32:35], v[128:143]
  s_waitcnt vmcnt(20)
  s_waitcnt lgkmcnt(0)
  s_barrier
  ds_read_b128 a[52:55], v232
  ds_read_b64_tr_b16 a[16:17], v224
  ds_read_b64_tr_b16 a[18:19], v224 offset:1024
  s_add_u32 m0, s45, 98304
  s_add_u32 s48, s44, 1720320
  buffer_load_dwordx4 v108, s[64:67], s48 offen lds
  v_mfma_f32_32x32x16_bf16 v[144:159], a[56:59], a[36:39], v[144:159]
  ds_read_b64_tr_b16 a[20:21], v225
  ds_read_b64_tr_b16 a[22:23], v225 offset:1024
  buffer_load_dwordx4 v109, s[64:67], s48 offen offset:1024 lds
  v_mfma_f32_32x32x16_bf16 v[160:175], a[56:59], a[40:43], v[160:175]
  ds_read_b64_tr_b16 a[24:25], v226
  ds_read_b64_tr_b16 a[26:27], v226 offset:1024
  buffer_load_dwordx4 v110, s[64:67], s48 offen offset:2048 lds
  v_mfma_f32_32x32x16_bf16 v[176:191], a[56:59], a[44:47], v[176:191]
  ds_read_b64_tr_b16 a[28:29], v227
  ds_read_b64_tr_b16 a[30:31], v227 offset:1024
  buffer_load_dwordx4 v111, s[64:67], s48 offen offset:3072 lds
  v_mfma_f32_4x4x4_16b_bf16 v[208:211], v[216:217], a[32:33], v[208:211]
  v_mfma_f32_4x4x4_16b_bf16 v[212:215], v[216:217], a[34:35], v[212:215]
  v_mfma_f32_4x4x4_16b_bf16 v[192:195], a[56:57], a[56:57], v[192:195]
  v_mfma_f32_4x4x4_16b_bf16 v[196:199], a[58:59], a[58:59], v[196:199]
  v_mfma_f32_4x4x4_16b_bf16 v[200:203], v[216:217], a[56:57], v[200:203]
  v_mfma_f32_4x4x4_16b_bf16 v[204:207], v[216:217], a[58:59], v[204:207]
  v_mfma_f32_32x32x16_bf16 v[128:143], a[48:51], a[0:3], v[128:143]
  ds_read_b128 a[56:59], v233
  ds_read_b64_tr_b16 a[32:33], v224 offset:4096
  ds_read_b64_tr_b16 a[34:35], v224 offset:5120
  s_add_u32 m0, s45, 114688
  s_add_u32 s48, s47, 896
  buffer_load_dwordx4 v104, s[60:63], s48 offen lds
  v_mfma_f32_32x32x16_bf16 v[144:159], a[48:51], a[4:7], v[144:159]
  ds_read_b64_tr_b16 a[36:37], v225 offset:4096
  ds_read_b64_tr_b16 a[38:39], v225 offset:5120
  buffer_load_dwordx4 v105, s[60:63], s48 offen offset:1024 lds
  v_mfma_f32_32x32x16_bf16 v[160:175], a[48:51], a[8:11], v[160:175]
  ds_read_b64_tr_b16 a[40:41], v226 offset:4096
  ds_read_b64_tr_b16 a[42:43], v226 offset:5120
  buffer_load_dwordx4 v106, s[60:63], s48 offen offset:2048 lds
  v_mfma_f32_32x32x16_bf16 v[176:191], a[48:51], a[12:15], v[176:191]
  ds_read_b64_tr_b16 a[44:45], v227 offset:4096
  ds_read_b64_tr_b16 a[46:47], v227 offset:5120
  buffer_load_dwordx4 v107, s[60:63], s48 offen offset:3072 lds
  v_mfma_f32_4x4x4_16b_bf16 v[208:211], v[216:217], a[0:1], v[208:211]
  v_mfma_f32_4x4x4_16b_bf16 v[212:215], v[216:217], a[2:3], v[212:215]
  v_mfma_f32_4x4x4_16b_bf16 v[192:195], a[48:49], a[48:49], v[192:195]
  v_mfma_f32_4x4x4_16b_bf16 v[196:199], a[50:51], a[50:51], v[196:199]
  v_mfma_f32_4x4x4_16b_bf16 v[200:203], v[216:217], a[48:49], v[200:203]
  v_mfma_f32_4x4x4_16b_bf16 v[204:207], v[216:217], a[50:51], v[204:207]
  s_waitcnt lgkmcnt(9)
  v_mfma_f32_32x32x16_bf16 v[128:143], a[52:55], a[16:19], v[128:143]
  ds_read_b128 a[48:51], v234
  ds_read_b64_tr_b16 a[0:1], v224 offset:8192
  ds_read_b64_tr_b16 a[2:3], v224 offset:9216
  v_mfma_f32_32x32x16_bf16 v[144:159], a[52:55], a[20:23], v[144:159]
  ds_read_b64_tr_b16 a[4:5], v225 offset:8192
  ds_read_b64_tr_b16 a[6:7], v225 offset:9216
  v_mfma_f32_32x32x16_bf16 v[160:175], a[52:55], a[24:27], v[160:175]
  ds_read_b64_tr_b16 a[8:9], v226 offset:8192
  ds_read_b64_tr_b16 a[10:11], v226 offset:9216
  v_mfma_f32_32x32x16_bf16 v[176:191], a[52:55], a[28:31], v[176:191]
  ds_read_b64_tr_b16 a[12:13], v227 offset:8192
  ds_read_b64_tr_b16 a[14:15], v227 offset:9216
  s_add_u32 s99, s99, 1
  s_cmp_eq_u32 s99, 10
  s_cselect_b32 s99, 0, s99
  s_lshl_b32 s88, s99, 2
  s_sub_u32 s71, s57, s88
  s_and_b32 s71, s71, 15
  s_cmp_ge_u32 s71, 4
  s_cbranch_scc1 CW_46
  s_lshl_b32 s85, s71, 12
  s_add_u32 s85, s85, 0
  v_add_u32 v36, s85, v224
  s_add_u32 s71, s71, s88
  s_lshl_b32 s71, s71, 10
  s_add_u32 s71, s71, s59
  ds_read_b64_tr_b16 a[64:65], v36
  ds_read_b64_tr_b16 a[66:67], v36 offset:1024
  s_waitcnt lgkmcnt(0)
  buffer_store_dwordx4 a[64:67], v1, s[28:31], s71 offen sc1
CW_46:
  s_cmp_lg_u32 s99, s56
  s_cbranch_scc1 CX_47
  s_lshl_b32 s71, s99, 12
  s_add_u32 s71, s71, s70
  ds_read_b128 a[68:71], v232
  ds_read_b128 a[72:75], v233
  ds_read_b128 a[76:79], v234
  ds_read_b128 a[80:83], v235
  s_waitcnt lgkmcnt(0)
  buffer_store_dwordx4 a[68:71], v1, s[28:31], s71 offen sc1
  buffer_store_dwordx4 a[72:75], v1, s[28:31], s71 offen offset:1024 sc1
  buffer_store_dwordx4 a[76:79], v1, s[28:31], s71 offen offset:2048 sc1
  buffer_store_dwordx4 a[80:83], v1, s[28:31], s71 offen offset:3072 sc1
CX_47:
  v_mfma_f32_4x4x4_16b_bf16 v[208:211], v[216:217], a[16:17], v[208:211]
  v_mfma_f32_4x4x4_16b_bf16 v[212:215], v[216:217], a[18:19], v[212:215]
  v_mfma_f32_4x4x4_16b_bf16 v[192:195], a[52:53], a[52:53], v[192:195]
  v_mfma_f32_4x4x4_16b_bf16 v[196:199], a[54:55], a[54:55], v[196:199]
  v_mfma_f32_4x4x4_16b_bf16 v[200:203], v[216:217], a[52:53], v[200:203]
  v_mfma_f32_4x4x4_16b_bf16 v[204:207], v[216:217], a[54:55], v[204:207]
  s_waitcnt lgkmcnt(9)
  v_mfma_f32_32x32x16_bf16 v[128:143], a[56:59], a[32:35], v[128:143]
  ds_read_b128 a[52:55], v235
  ds_read_b64_tr_b16 a[16:17], v224 offset:12288
  ds_read_b64_tr_b16 a[18:19], v224 offset:13312
  v_mfma_f32_32x32x16_bf16 v[144:159], a[56:59], a[36:39], v[144:159]
  ds_read_b64_tr_b16 a[20:21], v225 offset:12288
  ds_read_b64_tr_b16 a[22:23], v225 offset:13312
  v_mfma_f32_32x32x16_bf16 v[160:175], a[56:59], a[40:43], v[160:175]
  ds_read_b64_tr_b16 a[24:25], v226 offset:12288
  ds_read_b64_tr_b16 a[26:27], v226 offset:13312
  v_mfma_f32_32x32x16_bf16 v[176:191], a[56:59], a[44:47], v[176:191]
  ds_read_b64_tr_b16 a[28:29], v227 offset:12288
  ds_read_b64_tr_b16 a[30:31], v227 offset:13312
  v_mfma_f32_4x4x4_16b_bf16 v[208:211], v[216:217], a[32:33], v[208:211]
  v_mfma_f32_4x4x4_16b_bf16 v[212:215], v[216:217], a[34:35], v[212:215]
  v_mfma_f32_4x4x4_16b_bf16 v[192:195], a[56:57], a[56:57], v[192:195]
  v_mfma_f32_4x4x4_16b_bf16 v[196:199], a[58:59], a[58:59], v[196:199]
  v_mfma_f32_4x4x4_16b_bf16 v[200:203], v[216:217], a[56:57], v[200:203]
  v_mfma_f32_4x4x4_16b_bf16 v[204:207], v[216:217], a[58:59], v[204:207]
  s_waitcnt lgkmcnt(9)
  v_mfma_f32_32x32x16_bf16 v[128:143], a[48:51], a[0:3], v[128:143]
  s_waitcnt vmcnt(18)
  s_waitcnt lgkmcnt(0)
  s_barrier
  ds_read_b128 a[56:59], v232 offset:32768
  ds_read_b64_tr_b16 a[32:33], v224 offset:32768
  ds_read_b64_tr_b16 a[34:35], v224 offset:33792
  s_add_u32 m0, s45, 0
  s_add_u32 s48, s44, 1966080
  buffer_load_dwordx4 v108, s[64:67], s48 offen lds
  v_mfma_f32_32x32x16_bf16 v[144:159], a[48:51], a[4:7], v[144:159]
  ds_read_b64_tr_b16 a[36:37], v225 offset:32768
  ds_read_b64_tr_b16 a[38:39], v225 offset:33792
  buffer_load_dwordx4 v109, s[64:67], s48 offen offset:1024 lds
  s_waitcnt vmcnt(18)
  ds_read_b64_tr_b16 v[64:65], v15
  ds_read_b64_tr_b16 v[66:67], v15 offset:512
  ds_read_b64_tr_b16 v[68:69], v15 offset:1024
  ds_read_b64_tr_b16 v[70:71], v15 offset:1536
  ds_read_b64_tr_b16 v[72:73], v15 offset:2048
  ds_read_b64_tr_b16 v[74:75], v15 offset:2560
  ds_read_b64_tr_b16 v[76:77], v15 offset:3072
  ds_read_b64_tr_b16 v[78:79], v15 offset:3584
  v_mfma_f32_32x32x16_bf16 v[160:175], a[48:51], a[8:11], v[160:175]
  ds_read_b64_tr_b16 a[40:41], v226 offset:32768
  ds_read_b64_tr_b16 a[42:43], v226 offset:33792
  buffer_load_dwordx4 v110, s[64:67], s48 offen offset:2048 lds
  v_mfma_f32_32x32x16_bf16 v[176:191], a[48:51], a[12:15], v[176:191]
  ds_read_b64_tr_b16 a[44:45], v227 offset:32768
  ds_read_b64_tr_b16 a[46:47], v227 offset:33792
  buffer_load_dwordx4 v111, s[64:67], s48 offen offset:3072 lds
  v_mfma_f32_4x4x4_16b_bf16 v[208:211], v[216:217], a[0:1], v[208:211]
  v_mfma_f32_4x4x4_16b_bf16 v[212:215], v[216:217], a[2:3], v[212:215]
  v_mfma_f32_4x4x4_16b_bf16 v[192:195], a[48:49], a[48:49], v[192:195]
  v_mfma_f32_4x4x4_16b_bf16 v[196:199], a[50:51], a[50:51], v[196:199]
  v_mfma_f32_4x4x4_16b_bf16 v[200:203], v[216:217], a[48:49], v[200:203]
  v_mfma_f32_4x4x4_16b_bf16 v[204:207], v[216:217], a[50:51], v[204:207]
  v_mfma_f32_32x32x16_bf16 v[128:143], a[52:55], a[16:19], v[128:143]
  ds_read_b128 a[48:51], v233 offset:32768
  ds_read_b64_tr_b16 a[0:1], v224 offset:36864
  ds_read_b64_tr_b16 a[2:3], v224 offset:37888
  s_add_u32 m0, s45, 16384
  s_add_u32 s48, s47, 1024
  buffer_load_dwordx4 v104, s[60:63], s48 offen lds
  s_waitcnt lgkmcnt(13)
  buffer_store_dwordx4 v[64:67], v6, s[28:31], s40 offen sc1
  v_mfma_f32_32x32x16_bf16 v[144:159], a[52:55], a[20:23], v[144:159]
  ds_read_b64_tr_b16 a[4:5], v225 offset:36864
  ds_read_b64_tr_b16 a[6:7], v225 offset:37888
  buffer_load_dwordx4 v105, s[60:63], s48 offen offset:1024 lds
  s_add_u32 s40, s40, s38
  s_waitcnt lgkmcnt(13)
  buffer_store_dwordx4 v[68:71], v6, s[28:31], s40 offen sc1
  v_mfma_f32_32x32x16_bf16 v[160:175], a[52:55], a[24:27], v[160:175]
  ds_read_b64_tr_b16 a[8:9], v226 offset:36864
  ds_read_b64_tr_b16 a[10:11], v226 offset:37888
  buffer_load_dwordx4 v106, s[60:63], s48 offen offset:2048 lds
  s_add_u32 s40, s40, s38
  s_waitcnt lgkmcnt(13)
  buffer_store_dwordx4 v[72:75], v6, s[28:31], s40 offen sc1
  v_mfma_f32_32x32x16_bf16 v[176:191], a[52:55], a[28:31], v[176:191]
  ds_read_b64_tr_b16 a[12:13], v227 offset:36864
  ds_read_b64_tr_b16 a[14:15], v227 offset:37888
  buffer_load_dwordx4 v107, s[60:63], s48 offen offset:3072 lds
  s_add_u32 s40, s40, s38
  s_waitcnt lgkmcnt(13)
  buffer_store_dwordx4 v[76:79], v6, s[28:31], s40 offen sc1
  v_mfma_f32_4x4x4_16b_bf16 v[208:211], v[216:217], a[16:17], v[208:211]
  v_mfma_f32_4x4x4_16b_bf16 v[212:215], v[216:217], a[18:19], v[212:215]
  v_mfma_f32_4x4x4_16b_bf16 v[192:195], a[52:53], a[52:53], v[192:195]
  v_mfma_f32_4x4x4_16b_bf16 v[196:199], a[54:55], a[54:55], v[196:199]
  v_mfma_f32_4x4x4_16b_bf16 v[200:203], v[216:217], a[52:53], v[200:203]
  v_mfma_f32_4x4x4_16b_bf16 v[204:207], v[216:217], a[54:55], v[204:207]
  v_mfma_f32_4x4x4_16b_bf16 v[96:99], v[216:217], v[64:65], 0
  v_mfma_f32_4x4x4_16b_bf16 v[100:103], v[216:217], v[66:67], 0
  s_nop 0
  v_mfma_f32_4x4x4_16b_bf16 v[96:99], v[216:217], v[68:69], v[96:99]
  v_mfma_f32_4x4x4_16b_bf16 v[100:103], v[216:217], v[70:71], v[100:103]
  s_nop 0
  v_mfma_f32_4x4x4_16b_bf16 v[96:99], v[216:217], v[72:73], v[96:99]
  v_mfma_f32_4x4x4_16b_bf16 v[100:103], v[216:217], v[74:75], v[100:103]
  s_nop 0
  v_mfma_f32_4x4x4_16b_bf16 v[96:99], v[216:217], v[76:77], v[96:99]
  v_mfma_f32_4x4x4_16b_bf16 v[100:103], v[216:217], v[78:79], v[100:103]
  s_waitcnt lgkmcnt(9)
  v_mfma_f32_32x32x16_bf16 v[128:143], a[56:59], a[32:35], v[128:143]
  ds_read_b128 a[52:55], v234 offset:32768
  ds_read_b64_tr_b16 a[16:17], v224 offset:40960
  ds_read_b64_tr_b16 a[18:19], v224 offset:41984
  v_mfma_f32_32x32x16_bf16 v[144:159], a[56:59], a[36:39], v[144:159]
  ds_read_b64_tr_b16 a[20:21], v225 offset:40960
  ds_read_b64_tr_b16 a[22:23], v225 offset:41984
  v_mfma_f32_32x32x16_bf16 v[160:175], a[56:59], a[40:43], v[160:175]
  ds_read_b64_tr_b16 a[24:25], v226 offset:40960
  ds_read_b64_tr_b16 a[26:27], v226 offset:41984
  v_mfma_f32_32x32x16_bf16 v[176:191], a[56:59], a[44:47], v[176:191]
  ds_read_b64_tr_b16 a[28:29], v227 offset:40960
  ds_read_b64_tr_b16 a[30:31], v227 offset:41984
  s_add_u32 s99, s99, 1
  s_cmp_eq_u32 s99, 10
  s_cselect_b32 s99, 0, s99
  s_lshl_b32 s88, s99, 2
  s_sub_u32 s71, s57, s88
  s_and_b32 s71, s71, 15
  s_cmp_ge_u32 s71, 4
  s_cbranch_scc1 CW_48
  s_lshl_b32 s85, s71, 12
  s_add_u32 s85, s85, 32768
  v_add_u32 v36, s85, v224
  s_add_u32 s71, s71, s88
  s_lshl_b32 s71, s71, 10
  s_add_u32 s71, s71, s59
  ds_read_b64_tr_b16 a[64:65], v36
  ds_read_b64_tr_b16 a[66:67], v36 offset:1024
  s_waitcnt lgkmcnt(0)
  buffer_store_dwordx4 a[64:67], v1, s[28:31], s71 offen sc1
CW_48:
  s_cmp_lg_u32 s99, s56
  s_cbranch_scc1 CX_49
  s_lshl_b32 s71, s99, 12
  s_add_u32 s71, s71, s70
  ds_read_b128 a[68:71], v232 offset:32768
  ds_read_b128 a[72:75], v233 offset:32768
  ds_read_b128 a[76:79], v234 offset:32768
  ds_read_b128 a[80:83], v235 offset:32768
  s_waitcnt lgkmcnt(0)
  buffer_store_dwordx4 a[68:71], v1, s[28:31], s71 offen sc1
  buffer_store_dwordx4 a[72:75], v1, s[28:31], s71 offen offset:1024 sc1
  buffer_store_dwordx4 a[76:79], v1, s[28:31], s71 offen offset:2048 sc1
  buffer_store_dwordx4 a[80:83], v1, s[28:31], s71 offen offset:3072 sc1
CX_49:
  v_mfma_f32_4x4x4_16b_bf16 v[208:211], v[216:217], a[32:33], v[208:211]
  v_mfma_f32_4x4x4_16b_bf16 v[212:215], v[216:217], a[34:35], v[212:215]
  v_mfma_f32_4x4x4_16b_bf16 v[192:195], a[56:57], a[56:57], v[192:195]
  v_mfma_f32_4x4x4_16b_bf16 v[196:199], a[58:59], a[58:59], v[196:199]
  v_mfma_f32_4x4x4_16b_bf16 v[200:203], v[216:217], a[56:57], v[200:203]
  v_mfma_f32_4x4x4_16b_bf16 v[204:207], v[216:217], a[58:59], v[204:207]
  s_waitcnt lgkmcnt(9)
  v_mfma_f32_32x32x16_bf16 v[128:143], a[48:51], a[0:3], v[128:143]
  ds_read_b128 a[56:59], v235 offset:32768
  ds_read_b64_tr_b16 a[32:33], v224 offset:45056
  ds_read_b64_tr_b16 a[34:35], v224 offset:46080
  v_mfma_f32_32x32x16_bf16 v[144:159], a[48:51], a[4:7], v[144:159]
  ds_read_b64_tr_b16 a[36:37], v225 offset:45056
  ds_read_b64_tr_b16 a[38:39], v225 offset:46080
  v_mfma_f32_32x32x16_bf16 v[160:175], a[48:51], a[8:11], v[160:175]
  ds_read_b64_tr_b16 a[40:41], v226 offset:45056
  ds_read_b64_tr_b16 a[42:43], v226 offset:46080
  v_mfma_f32_32x32x16_bf16 v[176:191], a[48:51], a[12:15], v[176:191]
  ds_read_b64_tr_b16 a[44:45], v227 offset:45056
  ds_read_b64_tr_b16 a[46:47], v227 offset:46080
  v_mfma_f32_4x4x4_16b_bf16 v[208:211], v[216:217], a[0:1], v[208:211]
  v_mfma_f32_4x4x4_16b_bf16 v[212:215], v[216:217], a[2:3], v[212:215]
  v_mfma_f32_4x4x4_16b_bf16 v[192:195], a[48:49], a[48:49], v[192:195]
  v_mfma_f32_4x4x4_16b_bf16 v[196:199], a[50:51], a[50:51], v[196:199]
  v_mfma_f32_4x4x4_16b_bf16 v[200:203], v[216:217], a[48:49], v[200:203]
  v_mfma_f32_4x4x4_16b_bf16 v[204:207], v[216:217], a[50:51], v[204:207]
  s_waitcnt lgkmcnt(9)
  v_mfma_f32_32x32x16_bf16 v[128:143], a[52:55], a[16:19], v[128:143]
  s_waitcnt vmcnt(20)
  s_waitcnt lgkmcnt(0)
  s_barrier
  ds_read_b128 a[48:51], v236
  ds_read_b64_tr_b16 a[0:1], v228
  ds_read_b64_tr_b16 a[2:3], v228 offset:1024
  s_add_u32 m0, s45, 32768
  s_add_u32 s48, s44, 2211840
  buffer_load_dwordx4 v108, s[64:67], s48 offen lds
  v_mfma_f32_32x32x16_bf16 v[144:159], a[52:55], a[20:23], v[144:159]
  ds_read_b64_tr_b16 a[4:5], v229
  ds_read_b64_tr_b16 a[6:7], v229 offset:1024
  buffer_load_dwordx4 v109, s[64:67], s48 offen offset:1024 lds
  v_mfma_f32_32x32x16_bf16 v[160:175], a[52:55], a[24:27], v[160:175]
  ds_read_b64_tr_b16 a[8:9], v230
  ds_read_b64_tr_b16 a[10:11], v230 offset:1024
  buffer_load_dwordx4 v110, s[64:67], s48 offen offset:2048 lds
  v_mfma_f32_32x32x16_bf16 v[176:191], a[52:55], a[28:31], v[176:191]
  ds_read_b64_tr_b16 a[12:13], v231
  ds_read_b64_tr_b16 a[14:15], v231 offset:1024
  buffer_load_dwordx4 v111, s[64:67], s48 offen offset:3072 lds
  v_mfma_f32_4x4x4_16b_bf16 v[208:211], v[216:217], a[16:17], v[208:211]
  v_mfma_f32_4x4x4_16b_bf16 v[212:215], v[216:217], a[18:19], v[212:215]
  v_mfma_f32_4x4x4_16b_bf16 v[192:195], a[52:53], a[52:53], v[192:195]
  v_mfma_f32_4x4x4_16b_bf16 v[196:199], a[54:55], a[54:55], v[196:199]
  v_mfma_f32_4x4x4_16b_bf16 v[200:203], v[216:217], a[52:53], v[200:203]
  v_mfma_f32_4x4x4_16b_bf16 v[204:207], v[216:217], a[54:55], v[204:207]
  v_mfma_f32_32x32x16_bf16 v[128:143], a[56:59], a[32:35], v[128:143]
  ds_read_b128 a[52:55], v237
  ds_read_b64_tr_b16 a[16:17], v228 offset:4096
  ds_read_b64_tr_b16 a[18:19], v228 offset:5120
  s_add_u32 m0, s45, 49152
  s_add_u32 s48, s47, 1152
  buffer_load_dwordx4 v104, s[60:63], s48 offen lds
  v_mfma_f32_32x32x16_bf16 v[144:159], a[56:59], a[36:39], v[144:159]
  ds_read_b64_tr_b16 a[20:21], v229 offset:4096
  ds_read_b64_tr_b16 a[22:23], v229 offset:5120
  buffer_load_dwordx4 v105, s[60:63], s48 offen offset:1024 lds
  v_mfma_f32_32x32x16_bf16 v[160:175], a[56:59], a[40:43], v[160:175]
  ds_read_b64_tr_b16 a[24:25], v230 offset:4096
  ds_read_b64_tr_b16 a[26:27], v230 offset:5120
  buffer_load_dwordx4 v106, s[60:63], s48 offen offset:2048 lds
  v_mfma_f32_32x32x16_bf16 v[176:191], a[56:59], a[44:47], v[176:191]
  ds_read_b64_tr_b16 a[28:29], v231 offset:4096
  ds_read_b64_tr_b16 a[30:31], v231 offset:5120
  buffer_load_dwordx4 v107, s[60:63], s48 offen offset:3072 lds
  v_mfma_f32_4x4x4_16b_bf16 v[208:211], v[216:217], a[32:33], v[208:211]
  v_mfma_f32_4x4x4_16b_bf16 v[212:215], v[216:217], a[34:35], v[212:215]
  v_mfma_f32_4x4x4_16b_bf16 v[192:195], a[56:57], a[56:57], v[192:195]
  v_mfma_f32_4x4x4_16b_bf16 v[196:199], a[58:59], a[58:59], v[196:199]
  v_mfma_f32_4x4x4_16b_bf16 v[200:203], v[216:217], a[56:57], v[200:203]
  v_mfma_f32_4x4x4_16b_bf16 v[204:207], v[216:217], a[58:59], v[204:207]
  s_waitcnt lgkmcnt(9)
  v_mfma_f32_32x32x16_bf16 v[128:143], a[48:51], a[0:3], v[128:143]
  ds_read_b128 a[56:59], v238
  ds_read_b64_tr_b16 a[32:33], v228 offset:8192
  ds_read_b64_tr_b16 a[34:35], v228 offset:9216
  s_add_u32 m0, s43, 0
  s_mul_i32 s87, s91, 4
  s_add_u32 s87, s87, s90
  buffer_load_dwordx4 v37, s[20:23], s87 offen nt lds
  v_mfma_f32_32x32x16_bf16 v[144:159], a[48:51], a[4:7], v[144:159]
  ds_read_b64_tr_b16 a[36:37], v229 offset:8192
  ds_read_b64_tr_b16 a[38:39], v229 offset:9216
  v_mfma_f32_32x32x16_bf16 v[160:175], a[48:51], a[8:11], v[160:175]
  ds_read_b64_tr_b16 a[40:41], v230 offset:8192
  ds_read_b64_tr_b16 a[42:43], v230 offset:9216
  v_mfma_f32_32x32x16_bf16 v[176:191], a[48:51], a[12:15], v[176:191]
  ds_read_b64_tr_b16 a[44:45], v231 offset:8192
  ds_read_b64_tr_b16 a[46:47], v231 offset:9216
  s_add_u32 s99, s99, 1
  s_cmp_eq_u32 s99, 10
  s_cselect_b32 s99, 0, s99
  s_lshl_b32 s88, s99, 2
  s_sub_u32 s71, s57, s88
  s_and_b32 s71, s71, 15
  s_cmp_ge_u32 s71, 4
  s_cbranch_scc1 CW_50
  s_lshl_b32 s85, s71, 12
  s_add_u32 s85, s85, 65536
  v_add_u32 v36, s85, v224
  s_add_u32 s71, s71, s88
  s_lshl_b32 s71, s71, 10
  s_add_u32 s71, s71, s59
  ds_read_b64_tr_b16 a[64:65], v36
  ds_read_b64_tr_b16 a[66:67], v36 offset:1024
  s_waitcnt lgkmcnt(0)
  buffer_store_dwordx4 a[64:67], v1, s[28:31], s71 offen sc1
CW_50:
  s_cmp_lg_u32 s99, s56
  s_cbranch_scc1 CX_51
  s_lshl_b32 s71, s99, 12
  s_add_u32 s71, s71, s70
  ds_read_b128 a[68:71], v236
  ds_read_b128 a[72:75], v237
  ds_read_b128 a[76:79], v238
  ds_read_b128 a[80:83], v239
  s_waitcnt lgkmcnt(0)
  buffer_store_dwordx4 a[68:71], v1, s[28:31], s71 offen sc1
  buffer_store_dwordx4 a[72:75], v1, s[28:31], s71 offen offset:1024 sc1
  buffer_store_dwordx4 a[76:79], v1, s[28:31], s71 offen offset:2048 sc1
  buffer_store_dwordx4 a[80:83], v1, s[28:31], s71 offen offset:3072 sc1
CX_51:
  v_mfma_f32_4x4x4_16b_bf16 v[208:211], v[216:217], a[0:1], v[208:211]
  v_mfma_f32_4x4x4_16b_bf16 v[212:215], v[216:217], a[2:3], v[212:215]
  v_mfma_f32_4x4x4_16b_bf16 v[192:195], a[48:49], a[48:49], v[192:195]
  v_mfma_f32_4x4x4_16b_bf16 v[196:199], a[50:51], a[50:51], v[196:199]
  v_mfma_f32_4x4x4_16b_bf16 v[200:203], v[216:217], a[48:49], v[200:203]
  v_mfma_f32_4x4x4_16b_bf16 v[204:207], v[216:217], a[50:51], v[204:207]
  s_waitcnt lgkmcnt(9)
  v_mfma_f32_32x32x16_bf16 v[128:143], a[52:55], a[16:19], v[128:143]
  ds_read_b128 a[48:51], v239
  ds_read_b64_tr_b16 a[0:1], v228 offset:12288
  ds_read_b64_tr_b16 a[2:3], v228 offset:13312
  s_add_u32 m0, s43, 1024
  s_mul_i32 s87, s91, 5
  s_add_u32 s87, s87, s90
  buffer_load_dwordx4 v37, s[20:23], s87 offen nt lds
  v_mfma_f32_32x32x16_bf16 v[144:159], a[52:55], a[20:23], v[144:159]
  ds_read_b64_tr_b16 a[4:5], v229 offset:12288
  ds_read_b64_tr_b16 a[6:7], v229 offset:13312
  v_mfma_f32_32x32x16_bf16 v[160:175], a[52:55], a[24:27], v[160:175]
  ds_read_b64_tr_b16 a[8:9], v230 offset:12288
  ds_read_b64_tr_b16 a[10:11], v230 offset:13312
  v_mfma_f32_32x32x16_bf16 v[176:191], a[52:55], a[28:31], v[176:191]
  ds_read_b64_tr_b16 a[12:13], v231 offset:12288
  ds_read_b64_tr_b16 a[14:15], v231 offset:13312
  v_mfma_f32_4x4x4_16b_bf16 v[208:211], v[216:217], a[16:17], v[208:211]
  v_mfma_f32_4x4x4_16b_bf16 v[212:215], v[216:217], a[18:19], v[212:215]
  v_mfma_f32_4x4x4_16b_bf16 v[192:195], a[52:53], a[52:53], v[192:195]
  v_mfma_f32_4x4x4_16b_bf16 v[196:199], a[54:55], a[54:55], v[196:199]
  v_mfma_f32_4x4x4_16b_bf16 v[200:203], v[216:217], a[52:53], v[200:203]
  v_mfma_f32_4x4x4_16b_bf16 v[204:207], v[216:217], a[54:55], v[204:207]
  s_waitcnt lgkmcnt(9)
  v_mfma_f32_32x32x16_bf16 v[128:143], a[56:59], a[32:35], v[128:143]
  s_waitcnt vmcnt(22)
  s_waitcnt lgkmcnt(0)
  s_barrier
  ds_read_b128 a[52:55], v236 offset:32768
  ds_read_b64_tr_b16 a[16:17], v228 offset:32768
  ds_read_b64_tr_b16 a[18:19], v228 offset:33792
  s_add_u32 m0, s43, 2048
  s_mul_i32 s87, s91, 6
  s_add_u32 s87, s87, s90
  buffer_load_dwordx4 v37, s[20:23], s87 offen nt lds
  v_mfma_f32_32x32x16_bf16 v[144:159], a[56:59], a[36:39], v[144:159]
  ds_read_b64_tr_b16 a[20:21], v229 offset:32768
  ds_read_b64_tr_b16 a[22:23], v229 offset:33792
  v_mfma_f32_32x32x16_bf16 v[160:175], a[56:59], a[40:43], v[160:175]
  ds_read_b64_tr_b16 a[24:25], v230 offset:32768
  ds_read_b64_tr_b16 a[26:27], v230 offset:33792
  v_mfma_f32_32x32x16_bf16 v[176:191], a[56:59], a[44:47], v[176:191]
  ds_read_b64_tr_b16 a[28:29], v231 offset:32768
  ds_read_b64_tr_b16 a[30:31], v231 offset:33792
  v_mfma_f32_4x4x4_16b_bf16 v[208:211], v[216:217], a[32:33], v[208:211]
  v_mfma_f32_4x4x4_16b_bf16 v[212:215], v[216:217], a[34:35], v[212:215]
  v_mfma_f32_4x4x4_16b_bf16 v[192:195], a[56:57], a[56:57], v[192:195]
  v_mfma_f32_4x4x4_16b_bf16 v[196:199], a[58:59], a[58:59], v[196:199]
  v_mfma_f32_4x4x4_16b_bf16 v[200:203], v[216:217], a[56:57], v[200:203]
  v_mfma_f32_4x4x4_16b_bf16 v[204:207], v[216:217], a[58:59], v[204:207]
  v_mfma_f32_32x32x16_bf16 v[128:143], a[48:51], a[0:3], v[128:143]
  ds_read_b128 a[56:59], v237 offset:32768
  ds_read_b64_tr_b16 a[32:33], v228 offset:36864
  ds_read_b64_tr_b16 a[34:35], v228 offset:37888
  s_add_u32 m0, s43, 3072
  s_mul_i32 s87, s91, 7
  s_add_u32 s87, s87, s90
  buffer_load_dwordx4 v37, s[20:23], s87 offen nt lds
  v_mfma_f32_32x32x16_bf16 v[144:159], a[48:51], a[4:7], v[144:159]
  ds_read_b64_tr_b16 a[36:37], v229 offset:36864
  ds_read_b64_tr_b16 a[38:39], v229 offset:37888
  v_mfma_f32_32x32x16_bf16 v[160:175], a[48:51], a[8:11], v[160:175]
  ds_read_b64_tr_b16 a[40:41], v230 offset:36864
  ds_read_b64_tr_b16 a[42:43], v230 offset:37888
  v_mfma_f32_32x32x16_bf16 v[176:191], a[48:51], a[12:15], v[176:191]
  ds_read_b64_tr_b16 a[44:45], v231 offset:36864
  ds_read_b64_tr_b16 a[46:47], v231 offset:37888
  v_mfma_f32_4x4x4_16b_bf16 v[208:211], v[216:217], a[0:1], v[208:211]
  v_mfma_f32_4x4x4_16b_bf16 v[212:215], v[216:217], a[2:3], v[212:215]
  v_mfma_f32_4x4x4_16b_bf16 v[192:195], a[48:49], a[48:49], v[192:195]
  v_mfma_f32_4x4x4_16b_bf16 v[196:199], a[50:51], a[50:51], v[196:199]
  v_mfma_f32_4x4x4_16b_bf16 v[200:203], v[216:217], a[48:49], v[200:203]
  v_mfma_f32_4x4x4_16b_bf16 v[204:207], v[216:217], a[50:51], v[204:207]
  s_waitcnt lgkmcnt(9)
  v_mfma_f32_32x32x16_bf16 v[128:143], a[52:55], a[16:19], v[128:143]
  ds_read_b128 a[48:51], v238 offset:32768
  ds_read_b64_tr_b16 a[0:1], v228 offset:40960
  ds_read_b64_tr_b16 a[2:3], v228 offset:41984
  v_mfma_f32_32x32x16_bf16 v[144:159], a[52:55], a[20:23], v[144:159]
  ds_read_b64_tr_b16 a[4:5], v229 offset:40960
  ds_read_b64_tr_b16 a[6:7], v229 offset:41984
  v_mfma_f32_32x32x16_bf16 v[160:175], a[52:55], a[24:27], v[160:175]
  ds_read_b64_tr_b16 a[8:9], v230 offset:40960
  ds_read_b64_tr_b16 a[10:11], v230 offset:41984
  v_mfma_f32_32x32x16_bf16 v[176:191], a[52:55], a[28:31], v[176:191]
  ds_read_b64_tr_b16 a[12:13], v231 offset:40960
  ds_read_b64_tr_b16 a[14:15], v231 offset:41984
  s_add_u32 s99, s99, 1
  s_cmp_eq_u32 s99, 10
  s_cselect_b32 s99, 0, s99
  s_lshl_b32 s88, s99, 2
  s_sub_u32 s71, s57, s88
  s_and_b32 s71, s71, 15
  s_cmp_ge_u32 s71, 4
  s_cbranch_scc1 CW_52
  s_lshl_b32 s85, s71, 12
  s_add_u32 s85, s85, 98304
  v_add_u32 v36, s85, v224
  s_add_u32 s71, s71, s88
  s_lshl_b32 s71, s71, 10
  s_add_u32 s71, s71, s59
  ds_read_b64_tr_b16 a[64:65], v36
  ds_read_b64_tr_b16 a[66:67], v36 offset:1024
  s_waitcnt lgkmcnt(0)
  buffer_store_dwordx4 a[64:67], v1, s[28:31], s71 offen sc1
CW_52:
  s_cmp_lg_u32 s99, s56
  s_cbranch_scc1 CX_53
  s_lshl_b32 s71, s99, 12
  s_add_u32 s71, s71, s70
  ds_read_b128 a[68:71], v236 offset:32768
  ds_read_b128 a[72:75], v237 offset:32768
  ds_read_b128 a[76:79], v238 offset:32768
  ds_read_b128 a[80:83], v239 offset:32768
  s_waitcnt lgkmcnt(0)
  buffer_store_dwordx4 a[68:71], v1, s[28:31], s71 offen sc1
  buffer_store_dwordx4 a[72:75], v1, s[28:31], s71 offen offset:1024 sc1
  buffer_store_dwordx4 a[76:79], v1, s[28:31], s71 offen offset:2048 sc1
  buffer_store_dwordx4 a[80:83], v1, s[28:31], s71 offen offset:3072 sc1
CX_53:
  v_mfma_f32_4x4x4_16b_bf16 v[208:211], v[216:217], a[16:17], v[208:211]
  v_mfma_f32_4x4x4_16b_bf16 v[212:215], v[216:217], a[18:19], v[212:215]
  v_mfma_f32_4x4x4_16b_bf16 v[192:195], a[52:53], a[52:53], v[192:195]
  v_mfma_f32_4x4x4_16b_bf16 v[196:199], a[54:55], a[54:55], v[196:199]
  v_mfma_f32_4x4x4_16b_bf16 v[200:203], v[216:217], a[52:53], v[200:203]
  v_mfma_f32_4x4x4_16b_bf16 v[204:207], v[216:217], a[54:55], v[204:207]
  s_waitcnt lgkmcnt(9)
  v_mfma_f32_32x32x16_bf16 v[128:143], a[56:59], a[32:35], v[128:143]
  ds_read_b128 a[52:55], v239 offset:32768
  ds_read_b64_tr_b16 a[16:17], v228 offset:45056
  ds_read_b64_tr_b16 a[18:19], v228 offset:46080
  v_mfma_f32_32x32x16_bf16 v[144:159], a[56:59], a[36:39], v[144:159]
  ds_read_b64_tr_b16 a[20:21], v229 offset:45056
  ds_read_b64_tr_b16 a[22:23], v229 offset:46080
  v_mfma_f32_32x32x16_bf16 v[160:175], a[56:59], a[40:43], v[160:175]
  ds_read_b64_tr_b16 a[24:25], v230 offset:45056
  ds_read_b64_tr_b16 a[26:27], v230 offset:46080
  v_mfma_f32_32x32x16_bf16 v[176:191], a[56:59], a[44:47], v[176:191]
  ds_read_b64_tr_b16 a[28:29], v231 offset:45056
  ds_read_b64_tr_b16 a[30:31], v231 offset:46080
  v_mfma_f32_4x4x4_16b_bf16 v[208:211], v[216:217], a[32:33], v[208:211]
  v_mfma_f32_4x4x4_16b_bf16 v[212:215], v[216:217], a[34:35], v[212:215]
  v_mfma_f32_4x4x4_16b_bf16 v[192:195], a[56:57], a[56:57], v[192:195]
  v_mfma_f32_4x4x4_16b_bf16 v[196:199], a[58:59], a[58:59], v[196:199]
  v_mfma_f32_4x4x4_16b_bf16 v[200:203], v[216:217], a[56:57], v[200:203]
  v_mfma_f32_4x4x4_16b_bf16 v[204:207], v[216:217], a[58:59], v[204:207]
  s_waitcnt lgkmcnt(9)
  v_mfma_f32_32x32x16_bf16 v[128:143], a[48:51], a[0:3], v[128:143]
  s_waitcnt vmcnt(13)
  s_waitcnt lgkmcnt(0)
  s_barrier
  ds_read_b128 a[56:59], v232
  ds_read_b64_tr_b16 a[32:33], v224
  ds_read_b64_tr_b16 a[34:35], v224 offset:1024
  v_mfma_f32_32x32x16_bf16 v[144:159], a[48:51], a[4:7], v[144:159]
  ds_read_b64_tr_b16 a[36:37], v225
  ds_read_b64_tr_b16 a[38:39], v225 offset:1024
  v_mfma_f32_32x32x16_bf16 v[160:175], a[48:51], a[8:11], v[160:175]
  ds_read_b64_tr_b16 a[40:41], v226
  ds_read_b64_tr_b16 a[42:43], v226 offset:1024
  v_mfma_f32_32x32x16_bf16 v[176:191], a[48:51], a[12:15], v[176:191]
  ds_read_b64_tr_b16 a[44:45], v227
  ds_read_b64_tr_b16 a[46:47], v227 offset:1024
  v_mfma_f32_4x4x4_16b_bf16 v[208:211], v[216:217], a[0:1], v[208:211]
  v_mfma_f32_4x4x4_16b_bf16 v[212:215], v[216:217], a[2:3], v[212:215]
  v_mfma_f32_4x4x4_16b_bf16 v[192:195], a[48:49], a[48:49], v[192:195]
  v_mfma_f32_4x4x4_16b_bf16 v[196:199], a[50:51], a[50:51], v[196:199]
  v_mfma_f32_4x4x4_16b_bf16 v[200:203], v[216:217], a[48:49], v[200:203]
  v_mfma_f32_4x4x4_16b_bf16 v[204:207], v[216:217], a[50:51], v[204:207]
  v_mfma_f32_32x32x16_bf16 v[128:143], a[52:55], a[16:19], v[128:143]
  ds_read_b128 a[48:51], v233
  ds_read_b64_tr_b16 a[0:1], v224 offset:4096
  ds_read_b64_tr_b16 a[2:3], v224 offset:5120
  v_mfma_f32_32x32x16_bf16 v[144:159], a[52:55], a[20:23], v[144:159]
  ds_read_b64_tr_b16 a[4:5], v225 offset:4096
  ds_read_b64_tr_b16 a[6:7], v225 offset:5120
  v_mfma_f32_32x32x16_bf16 v[160:175], a[52:55], a[24:27], v[160:175]
  ds_read_b64_tr_b16 a[8:9], v226 offset:4096
  ds_read_b64_tr_b16 a[10:11], v226 offset:5120
  v_mfma_f32_32x32x16_bf16 v[176:191], a[52:55], a[28:31], v[176:191]
  ds_read_b64_tr_b16 a[12:13], v227 offset:4096
  ds_read_b64_tr_b16 a[14:15], v227 offset:5120
  v_mfma_f32_4x4x4_16b_bf16 v[208:211], v[216:217], a[16:17], v[208:211]
  v_mfma_f32_4x4x4_16b_bf16 v[212:215], v[216:217], a[18:19], v[212:215]
  v_mfma_f32_4x4x4_16b_bf16 v[192:195], a[52:53], a[52:53], v[192:195]
  v_mfma_f32_4x4x4_16b_bf16 v[196:199], a[54:55], a[54:55], v[196:199]
  v_mfma_f32_4x4x4_16b_bf16 v[200:203], v[216:217], a[52:53], v[200:203]
  v_mfma_f32_4x4x4_16b_bf16 v[204:207], v[216:217], a[54:55], v[204:207]
  s_waitcnt lgkmcnt(9)
  v_mfma_f32_32x32x16_bf16 v[128:143], a[56:59], a[32:35], v[128:143]
  ds_read_b128 a[52:55], v234
  ds_read_b64_tr_b16 a[16:17], v224 offset:8192
  ds_read_b64_tr_b16 a[18:19], v224 offset:9216
  v_mfma_f32_32x32x16_bf16 v[144:159], a[56:59], a[36:39], v[144:159]
  ds_read_b64_tr_b16 a[20:21], v225 offset:8192
  ds_read_b64_tr_b16 a[22:23], v225 offset:9216
  v_mfma_f32_32x32x16_bf16 v[160:175], a[56:59], a[40:43], v[160:175]
  ds_read_b64_tr_b16 a[24:25], v226 offset:8192
  ds_read_b64_tr_b16 a[26:27], v226 offset:9216
  v_mfma_f32_32x32x16_bf16 v[176:191], a[56:59], a[44:47], v[176:191]
  ds_read_b64_tr_b16 a[28:29], v227 offset:8192
  ds_read_b64_tr_b16 a[30:31], v227 offset:9216
  s_add_u32 s99, s99, 1
  s_cmp_eq_u32 s99, 10
  s_cselect_b32 s99, 0, s99
  s_lshl_b32 s88, s99, 2
  s_sub_u32 s71, s57, s88
  s_and_b32 s71, s71, 15
  s_cmp_ge_u32 s71, 4
  s_cbranch_scc1 CW_54
  s_lshl_b32 s85, s71, 12
  s_add_u32 s85, s85, 0
  v_add_u32 v36, s85, v224
  s_add_u32 s71, s71, s88
  s_lshl_b32 s71, s71, 10
  s_add_u32 s71, s71, s59
  ds_read_b64_tr_b16 a[64:65], v36
  ds_read_b64_tr_b16 a[66:67], v36 offset:1024
  s_waitcnt lgkmcnt(0)
  buffer_store_dwordx4 a[64:67], v1, s[28:31], s71 offen sc1
CW_54:
  s_cmp_lg_u32 s99, s56
  s_cbranch_scc1 CX_55
  s_lshl_b32 s71, s99, 12
  s_add_u32 s71, s71, s70
  ds_read_b128 a[68:71], v232
  ds_read_b128 a[72:75], v233
  ds_read_b128 a[76:79], v234
  ds_read_b128 a[80:83], v235
  s_waitcnt lgkmcnt(0)
  buffer_store_dwordx4 a[68:71], v1, s[28:31], s71 offen sc1
  buffer_store_dwordx4 a[72:75], v1, s[28:31], s71 offen offset:1024 sc1
  buffer_store_dwordx4 a[76:79], v1, s[28:31], s71 offen offset:2048 sc1
  buffer_store_dwordx4 a[80:83], v1, s[28:31], s71 offen offset:3072 sc1
CX_55:
  v_mfma_f32_4x4x4_16b_bf16 v[208:211], v[216:217], a[32:33], v[208:211]
  v_mfma_f32_4x4x4_16b_bf16 v[212:215], v[216:217], a[34:35], v[212:215]
  v_mfma_f32_4x4x4_16b_bf16 v[192:195], a[56:57], a[56:57], v[192:195]
  v_mfma_f32_4x4x4_16b_bf16 v[196:199], a[58:59], a[58:59], v[196:199]
  v_mfma_f32_4x4x4_16b_bf16 v[200:203], v[216:217], a[56:57], v[200:203]
  v_mfma_f32_4x4x4_16b_bf16 v[204:207], v[216:217], a[58:59], v[204:207]
  s_waitcnt lgkmcnt(9)
  v_mfma_f32_32x32x16_bf16 v[128:143], a[48:51], a[0:3], v[128:143]
  ds_read_b128 a[56:59], v235
  ds_read_b64_tr_b16 a[32:33], v224 offset:12288
  ds_read_b64_tr_b16 a[34:35], v224 offset:13312
  v_mfma_f32_32x32x16_bf16 v[144:159], a[48:51], a[4:7], v[144:159]
  ds_read_b64_tr_b16 a[36:37], v225 offset:12288
  ds_read_b64_tr_b16 a[38:39], v225 offset:13312
  v_mfma_f32_32x32x16_bf16 v[160:175], a[48:51], a[8:11], v[160:175]
  ds_read_b64_tr_b16 a[40:41], v226 offset:12288
  ds_read_b64_tr_b16 a[42:43], v226 offset:13312
  v_mfma_f32_32x32x16_bf16 v[176:191], a[48:51], a[12:15], v[176:191]
  ds_read_b64_tr_b16 a[44:45], v227 offset:12288
  ds_read_b64_tr_b16 a[46:47], v227 offset:13312
  v_mfma_f32_4x4x4_16b_bf16 v[208:211], v[216:217], a[0:1], v[208:211]
  v_mfma_f32_4x4x4_16b_bf16 v[212:215], v[216:217], a[2:3], v[212:215]
  v_mfma_f32_4x4x4_16b_bf16 v[192:195], a[48:49], a[48:49], v[192:195]
  v_mfma_f32_4x4x4_16b_bf16 v[196:199], a[50:51], a[50:51], v[196:199]
  v_mfma_f32_4x4x4_16b_bf16 v[200:203], v[216:217], a[48:49], v[200:203]
  v_mfma_f32_4x4x4_16b_bf16 v[204:207], v[216:217], a[50:51], v[204:207]
  s_waitcnt lgkmcnt(9)
  v_mfma_f32_32x32x16_bf16 v[128:143], a[52:55], a[16:19], v[128:143]
  s_waitcnt vmcnt(4)
  s_waitcnt lgkmcnt(0)
  s_barrier
  ds_read_b128 a[48:51], v232 offset:32768
  ds_read_b64_tr_b16 a[0:1], v224 offset:32768
  ds_read_b64_tr_b16 a[2:3], v224 offset:33792
  v_mfma_f32_32x32x16_bf16 v[144:159], a[52:55], a[20:23], v[144:159]
  ds_read_b64_tr_b16 a[4:5], v225 offset:32768
  ds_read_b64_tr_b16 a[6:7], v225 offset:33792
  v_mfma_f32_32x32x16_bf16 v[160:175], a[52:55], a[24:27], v[160:175]
  ds_read_b64_tr_b16 a[8:9], v226 offset:32768
  ds_read_b64_tr_b16 a[10:11], v226 offset:33792
  v_mfma_f32_32x32x16_bf16 v[176:191], a[52:55], a[28:31], v[176:191]
  ds_read_b64_tr_b16 a[12:13], v227 offset:32768
  ds_read_b64_tr_b16 a[14:15], v227 offset:33792
  v_mfma_f32_4x4x4_16b_bf16 v[208:211], v[216:217], a[16:17], v[208:211]
  v_mfma_f32_4x4x4_16b_bf16 v[212:215], v[216:217], a[18:19], v[212:215]
  v_mfma_f32_4x4x4_16b_bf16 v[192:195], a[52:53], a[52:53], v[192:195]
  v_mfma_f32_4x4x4_16b_bf16 v[196:199], a[54:55], a[54:55], v[196:199]
  v_mfma_f32_4x4x4_16b_bf16 v[200:203], v[216:217], a[52:53], v[200:203]
  v_mfma_f32_4x4x4_16b_bf16 v[204:207], v[216:217], a[54:55], v[204:207]
  v_mfma_f32_32x32x16_bf16 v[128:143], a[56:59], a[32:35], v[128:143]
  ds_read_b128 a[52:55], v233 offset:32768
  ds_read_b64_tr_b16 a[16:17], v224 offset:36864
  ds_read_b64_tr_b16 a[18:19], v224 offset:37888
  v_mfma_f32_32x32x16_bf16 v[144:159], a[56:59], a[36:39], v[144:159]
  ds_read_b64_tr_b16 a[20:21], v225 offset:36864
  ds_read_b64_tr_b16 a[22:23], v225 offset:37888
  v_mfma_f32_32x32x16_bf16 v[160:175], a[56:59], a[40:43], v[160:175]
  ds_read_b64_tr_b16 a[24:25], v226 offset:36864
  ds_read_b64_tr_b16 a[26:27], v226 offset:37888
  v_mfma_f32_32x32x16_bf16 v[176:191], a[56:59], a[44:47], v[176:191]
  ds_read_b64_tr_b16 a[28:29], v227 offset:36864
  ds_read_b64_tr_b16 a[30:31], v227 offset:37888
  v_mfma_f32_4x4x4_16b_bf16 v[208:211], v[216:217], a[32:33], v[208:211]
  v_mfma_f32_4x4x4_16b_bf16 v[212:215], v[216:217], a[34:35], v[212:215]
  v_mfma_f32_4x4x4_16b_bf16 v[192:195], a[56:57], a[56:57], v[192:195]
  v_mfma_f32_4x4x4_16b_bf16 v[196:199], a[58:59], a[58:59], v[196:199]
  v_mfma_f32_4x4x4_16b_bf16 v[200:203], v[216:217], a[56:57], v[200:203]
  v_mfma_f32_4x4x4_16b_bf16 v[204:207], v[216:217], a[58:59], v[204:207]
  s_waitcnt lgkmcnt(9)
  v_mfma_f32_32x32x16_bf16 v[128:143], a[48:51], a[0:3], v[128:143]
  ds_read_b128 a[56:59], v234 offset:32768
  ds_read_b64_tr_b16 a[32:33], v224 offset:40960
  ds_read_b64_tr_b16 a[34:35], v224 offset:41984
  v_mfma_f32_32x32x16_bf16 v[144:159], a[48:51], a[4:7], v[144:159]
  ds_read_b64_tr_b16 a[36:37], v225 offset:40960
  ds_read_b64_tr_b16 a[38:39], v225 offset:41984
  s_waitcnt vmcnt(0)
  ds_read_b64_tr_b16 v[64:65], v15
  ds_read_b64_tr_b16 v[66:67], v15 offset:512
  ds_read_b64_tr_b16 v[68:69], v15 offset:1024
  ds_read_b64_tr_b16 v[70:71], v15 offset:1536
  ds_read_b64_tr_b16 v[72:73], v15 offset:2048
  ds_read_b64_tr_b16 v[74:75], v15 offset:2560
  ds_read_b64_tr_b16 v[76:77], v15 offset:3072
  ds_read_b64_tr_b16 v[78:79], v15 offset:3584
  v_mfma_f32_32x32x16_bf16 v[160:175], a[48:51], a[8:11], v[160:175]
  ds_read_b64_tr_b16 a[40:41], v226 offset:40960
  ds_read_b64_tr_b16 a[42:43], v226 offset:41984
  v_mfma_f32_32x32x16_bf16 v[176:191], a[48:51], a[12:15], v[176:191]
  ds_read_b64_tr_b16 a[44:45], v227 offset:40960
  ds_read_b64_tr_b16 a[46:47], v227 offset:41984
  s_add_u32 s99, s99, 1
  s_cmp_eq_u32 s99, 10
  s_cselect_b32 s99, 0, s99
  s_lshl_b32 s88, s99, 2
  s_sub_u32 s71, s57, s88
  s_and_b32 s71, s71, 15
  s_cmp_ge_u32 s71, 4
  s_cbranch_scc1 CW_56
  s_lshl_b32 s85, s71, 12
  s_add_u32 s85, s85, 32768
  v_add_u32 v36, s85, v224
  s_add_u32 s71, s71, s88
  s_lshl_b32 s71, s71, 10
  s_add_u32 s71, s71, s59
  ds_read_b64_tr_b16 a[64:65], v36
  ds_read_b64_tr_b16 a[66:67], v36 offset:1024
  s_waitcnt lgkmcnt(0)
  buffer_store_dwordx4 a[64:67], v1, s[28:31], s71 offen sc1
CW_56:
  s_cmp_lg_u32 s99, s56
  s_cbranch_scc1 CX_57
  s_lshl_b32 s71, s99, 12
  s_add_u32 s71, s71, s70
  ds_read_b128 a[68:71], v232 offset:32768
  ds_read_b128 a[72:75], v233 offset:32768
  ds_read_b128 a[76:79], v234 offset:32768
  ds_read_b128 a[80:83], v235 offset:32768
  s_waitcnt lgkmcnt(0)
  buffer_store_dwordx4 a[68:71], v1, s[28:31], s71 offen sc1
  buffer_store_dwordx4 a[72:75], v1, s[28:31], s71 offen offset:1024 sc1
  buffer_store_dwordx4 a[76:79], v1, s[28:31], s71 offen offset:2048 sc1
  buffer_store_dwordx4 a[80:83], v1, s[28:31], s71 offen offset:3072 sc1
CX_57:
  v_mfma_f32_4x4x4_16b_bf16 v[208:211], v[216:217], a[0:1], v[208:211]
  v_mfma_f32_4x4x4_16b_bf16 v[212:215], v[216:217], a[2:3], v[212:215]
  v_mfma_f32_4x4x4_16b_bf16 v[192:195], a[48:49], a[48:49], v[192:195]
  v_mfma_f32_4x4x4_16b_bf16 v[196:199], a[50:51], a[50:51], v[196:199]
  v_mfma_f32_4x4x4_16b_bf16 v[200:203], v[216:217], a[48:49], v[200:203]
  v_mfma_f32_4x4x4_16b_bf16 v[204:207], v[216:217], a[50:51], v[204:207]
  v_mfma_f32_32x32x16_bf16 v[128:143], a[52:55], a[16:19], v[128:143]
  ds_read_b128 a[48:51], v235 offset:32768
  ds_read_b64_tr_b16 a[0:1], v224 offset:45056
  ds_read_b64_tr_b16 a[2:3], v224 offset:46080
  s_mul_i32 s87, s38, 3
  s_sub_u32 s40, s40, s87
  s_add_u32 s40, s40, s41
  s_waitcnt lgkmcnt(13)
  buffer_store_dwordx4 v[64:67], v6, s[28:31], s40 offen sc1
  v_mfma_f32_32x32x16_bf16 v[144:159], a[52:55], a[20:23], v[144:159]
  ds_read_b64_tr_b16 a[4:5], v225 offset:45056
  ds_read_b64_tr_b16 a[6:7], v225 offset:46080
  s_add_u32 s40, s40, s38
  s_waitcnt lgkmcnt(13)
  buffer_store_dwordx4 v[68:71], v6, s[28:31], s40 offen sc1
  v_mfma_f32_32x32x16_bf16 v[160:175], a[52:55], a[24:27], v[160:175]
  ds_read_b64_tr_b16 a[8:9], v226 offset:45056
  ds_read_b64_tr_b16 a[10:11], v226 offset:46080
  s_add_u32 s40, s40, s38
  s_waitcnt lgkmcnt(13)
  buffer_store_dwordx4 v[72:75], v6, s[28:31], s40 offen sc1
  v_mfma_f32_32x32x16_bf16 v[176:191], a[52:55], a[28:31], v[176:191]
  ds_read_b64_tr_b16 a[12:13], v227 offset:45056
  ds_read_b64_tr_b16 a[14:15], v227 offset:46080
  s_add_u32 s40, s40, s38
  s_waitcnt lgkmcnt(13)
  buffer_store_dwordx4 v[76:79], v6, s[28:31], s40 offen sc1
  v_mfma_f32_4x4x4_16b_bf16 v[208:211], v[216:217], a[16:17], v[208:211]
  v_mfma_f32_4x4x4_16b_bf16 v[212:215], v[216:217], a[18:19], v[212:215]
  v_mfma_f32_4x4x4_16b_bf16 v[192:195], a[52:53], a[52:53], v[192:195]
  v_mfma_f32_4x4x4_16b_bf16 v[196:199], a[54:55], a[54:55], v[196:199]
  v_mfma_f32_4x4x4_16b_bf16 v[200:203], v[216:217], a[52:53], v[200:203]
  v_mfma_f32_4x4x4_16b_bf16 v[204:207], v[216:217], a[54:55], v[204:207]
  v_mfma_f32_4x4x4_16b_bf16 v[96:99], v[216:217], v[64:65], v[96:99]
  v_mfma_f32_4x4x4_16b_bf16 v[100:103], v[216:217], v[66:67], v[100:103]
  s_nop 0
  v_mfma_f32_4x4x4_16b_bf16 v[96:99], v[216:217], v[68:69], v[96:99]
  v_mfma_f32_4x4x4_16b_bf16 v[100:103], v[216:217], v[70:71], v[100:103]
  s_nop 0
  v_mfma_f32_4x4x4_16b_bf16 v[96:99], v[216:217], v[72:73], v[96:99]
  v_mfma_f32_4x4x4_16b_bf16 v[100:103], v[216:217], v[74:75], v[100:103]
  s_nop 0
  v_mfma_f32_4x4x4_16b_bf16 v[96:99], v[216:217], v[76:77], v[96:99]
  v_mfma_f32_4x4x4_16b_bf16 v[100:103], v[216:217], v[78:79], v[100:103]
  s_waitcnt lgkmcnt(9)
  v_mfma_f32_32x32x16_bf16 v[128:143], a[56:59], a[32:35], v[128:143]
  v_mfma_f32_32x32x16_bf16 v[144:159], a[56:59], a[36:39], v[144:159]
  v_mfma_f32_32x32x16_bf16 v[160:175], a[56:59], a[40:43], v[160:175]
  v_mfma_f32_32x32x16_bf16 v[176:191], a[56:59], a[44:47], v[176:191]
  v_mfma_f32_4x4x4_16b_bf16 v[208:211], v[216:217], a[32:33], v[208:211]
  v_mfma_f32_4x4x4_16b_bf16 v[212:215], v[216:217], a[34:35], v[212:215]
  v_mfma_f32_4x4x4_16b_bf16 v[192:195], a[56:57], a[56:57], v[192:195]
  v_mfma_f32_4x4x4_16b_bf16 v[196:199], a[58:59], a[58:59], v[196:199]
  v_mfma_f32_4x4x4_16b_bf16 v[200:203], v[216:217], a[56:57], v[200:203]
  v_mfma_f32_4x4x4_16b_bf16 v[204:207], v[216:217], a[58:59], v[204:207]
  v_add_f32 v96, v96, v100
  buffer_store_dword v96, v7, s[28:31], s42 offen sc1
  s_waitcnt lgkmcnt(0)
  v_mfma_f32_32x32x16_bf16 v[128:143], a[48:51], a[0:3], v[128:143]
  v_mfma_f32_32x32x16_bf16 v[144:159], a[48:51], a[4:7], v[144:159]
  v_mfma_f32_32x32x16_bf16 v[160:175], a[48:51], a[8:11], v[160:175]
  v_mfma_f32_32x32x16_bf16 v[176:191], a[48:51], a[12:15], v[176:191]
  v_mfma_f32_4x4x4_16b_bf16 v[208:211], v[216:217], a[0:1], v[208:211]
  v_mfma_f32_4x4x4_16b_bf16 v[212:215], v[216:217], a[2:3], v[212:215]
  v_mfma_f32_4x4x4_16b_bf16 v[192:195], a[48:49], a[48:49], v[192:195]
  v_mfma_f32_4x4x4_16b_bf16 v[196:199], a[50:51], a[50:51], v[196:199]
  v_mfma_f32_4x4x4_16b_bf16 v[200:203], v[216:217], a[48:49], v[200:203]
  v_mfma_f32_4x4x4_16b_bf16 v[204:207], v[216:217], a[50:51], v[204:207]
  s_nop 0
  v_add_f32 v40, v208, v212
  v_mov_b32 v41, 0
  v_add_f32 v192, v192, v196
  v_add_f32 v193, v193, v197
  v_add_f32 v194, v194, v198
  v_add_f32 v195, v195, v199
  v_add_f32 v20, v200, v204
  v_permlane32_swap_b32 v40, v41
  v_add_f32 v41, v40, v41
  v_cmp_eq_u32 vcc, 1, v17
  s_nop 1
  v_cndmask_b32 v21, v192, v193, vcc
  v_cmp_eq_u32 vcc, 2, v17
  s_nop 1
  v_cndmask_b32 v21, v21, v194, vcc
  v_cmp_eq_u32 vcc, 3, v17
  s_nop 1
  v_cndmask_b32 v21, v21, v195, vcc
  v_cvt_pk_bf16_f32 v42, v41, v41
  v_and_b32 v43, 0xffff0000, v42
  v_sub_f32 v43, v41, v43
  v_cvt_pk_bf16_f32 v44, v41, v43
  v_and_b32 v45, 0xffff, v42
  s_lshl_b32 s36, s3, 9
  s_add_u32 s36, s36, 147456
  v_lshl_add_u32 v46, v0, 3, s36
  ds_write_b64 v46, v[44:45]
  v_mov_b32 v22, v20
  v_mov_b32 v23, v21
  s_nop 0
  v_permlane32_swap_b32 v20, v22
  v_permlane32_swap_b32 v21, v23
  v_add_f32 v20, v20, v22
  v_add_f32 v21, v21, v23
  v_mul_f32 v20, 0xbacccccd, v20
  v_mul_f32 v21, 0x3acccccd, v21
  v_fma_f32 v21, -v20, v20, v21
  v_max_f32 v21, 0, v21
  v_add_f32 v21, 0x3727c5ac, v21
  v_rsq_f32 v24, v21
  v_cvt_pk_bf16_f32 v26, v20, v20
  v_and_b32 v22, 0xffff0000, v26
  v_sub_f32 v22, v20, v22
  v_cvt_pk_bf16_f32 v27, v22, 0
  s_lshl_b32 s36, s3, 8
  s_add_u32 s36, s36, 149504
  v_lshl_add_u32 v47, v0, 2, s36
  ds_write_b32 v47, v24
  v_lshl_add_u32 v47, v9, 4, s36
  s_lshl_b32 s36, s76, 9
  s_add_u32 s36, s36, 147456
  v_lshl_add_u32 v48, v0, 3, s36
  s_lshl_b32 s36, s77, 9
  s_add_u32 s36, s36, 147456
  v_lshl_add_u32 v49, v0, 3, s36
  s_lshl_b32 s36, s78, 9
  s_add_u32 s36, s36, 147456
  v_lshl_add_u32 v50, v0, 3, s36
  s_lshl_b32 s36, s79, 9
  s_add_u32 s36, s36, 147456
  v_lshl_add_u32 v51, v0, 3, s36
  s_waitcnt lgkmcnt(0)
  s_barrier
  ds_read_b64 v[28:29], v48
  ds_read_b64 v[30:31], v49
  ds_read_b64 v[32:33], v50
  ds_read_b64 v[34:35], v51
  ds_read_b128 v[240:243], v47
  ds_read_b128 v[244:247], v47 offset:32
  ds_read_b128 v[248:251], v47 offset:64
  ds_read_b128 v[252:255], v47 offset:96
  s_waitcnt lgkmcnt(7)
  v_mfma_f32_32x32x8_bf16 v[128:143], v[26:27], v[28:29], v[128:143]
  s_waitcnt lgkmcnt(6)
  v_mfma_f32_32x32x8_bf16 v[144:159], v[26:27], v[30:31], v[144:159]
  s_waitcnt lgkmcnt(5)
  v_mfma_f32_32x32x8_bf16 v[160:175], v[26:27], v[32:33], v[160:175]
  s_waitcnt lgkmcnt(4)
  v_mfma_f32_32x32x8_bf16 v[176:191], v[26:27], v[34:35], v[176:191]
  s_cmp_lg_u32 s57, 0
  s_cbranch_scc1 CSW_58
  s_lshl_b32 s36, s58, 7
  s_add_u32 s36, s36, 7028736
  v_mul_u32_u24 v46, 21504, v9
  v_lshl_add_u32 v46, v8, 2, v46
  v_mov_b32 v43, 0
  buffer_store_dword v41, v46, s[28:31], s36 offen
  s_add_u32 s36, s36, 43008
  buffer_store_dword v43, v46, s[28:31], s36 offen
  s_add_u32 s36, s36, 43008
  buffer_store_dword v43, v46, s[28:31], s36 offen
  s_add_u32 s36, s36, 43008
  buffer_store_dword v43, v46, s[28:31], s36 offen
  s_add_u32 s36, s36, 43008
  buffer_store_dword v43, v46, s[28:31], s36 offen
CSW_58:
  s_waitcnt lgkmcnt(3)
  s_nop 2
  v_pk_mul_f32 v[128:129], v[128:129], v[240:241]
  v_pk_mul_f32 v[130:131], v[130:131], v[242:243]
  s_waitcnt lgkmcnt(2)
  v_pk_mul_f32 v[132:133], v[132:133], v[244:245]
  v_pk_mul_f32 v[134:135], v[134:135], v[246:247]
  v_cvt_pk_bf16_f32 v48, v128, v129
  v_cvt_pk_bf16_f32 v49, v130, v131
  v_cvt_pk_bf16_f32 v50, v132, v133
  v_cvt_pk_bf16_f32 v51, v134, v135
  buffer_store_dwordx4 v[48:51], v218, s[28:31], s80 offen sc1
  s_waitcnt lgkmcnt(1)
  v_pk_mul_f32 v[136:137], v[136:137], v[248:249]
  v_pk_mul_f32 v[138:139], v[138:139], v[250:251]
  s_waitcnt lgkmcnt(0)
  v_pk_mul_f32 v[140:141], v[140:141], v[252:253]
  v_pk_mul_f32 v[142:143], v[142:143], v[254:255]
  v_cvt_pk_bf16_f32 v52, v136, v137
  v_cvt_pk_bf16_f32 v53, v138, v139
  v_cvt_pk_bf16_f32 v54, v140, v141
  v_cvt_pk_bf16_f32 v55, v142, v143
  buffer_store_dwordx4 v[52:55], v219, s[28:31], s80 offen sc1
  v_pk_mul_f32 v[144:145], v[144:145], v[240:241]
  v_pk_mul_f32 v[146:147], v[146:147], v[242:243]
  v_pk_mul_f32 v[148:149], v[148:149], v[244:245]
  v_pk_mul_f32 v[150:151], v[150:151], v[246:247]
  v_cvt_pk_bf16_f32 v56, v144, v145
  v_cvt_pk_bf16_f32 v57, v146, v147
  v_cvt_pk_bf16_f32 v58, v148, v149
  v_cvt_pk_bf16_f32 v59, v150, v151
  buffer_store_dwordx4 v[56:59], v218, s[28:31], s81 offen sc1
  v_pk_mul_f32 v[152:153], v[152:153], v[248:249]
  v_pk_mul_f32 v[154:155], v[154:155], v[250:251]
  v_pk_mul_f32 v[156:157], v[156:157], v[252:253]
  v_pk_mul_f32 v[158:159], v[158:159], v[254:255]
  v_cvt_pk_bf16_f32 v60, v152, v153
  v_cvt_pk_bf16_f32 v61, v154, v155
  v_cvt_pk_bf16_f32 v62, v156, v157
  v_cvt_pk_bf16_f32 v63, v158, v159
  buffer_store_dwordx4 v[60:63], v219, s[28:31], s81 offen sc1
  v_pk_mul_f32 v[160:161], v[160:161], v[240:241]
  v_pk_mul_f32 v[162:163], v[162:163], v[242:243]
  v_pk_mul_f32 v[164:165], v[164:165], v[244:245]
  v_pk_mul_f32 v[166:167], v[166:167], v[246:247]
  v_cvt_pk_bf16_f32 v48, v160, v161
  v_cvt_pk_bf16_f32 v49, v162, v163
  v_cvt_pk_bf16_f32 v50, v164, v165
  v_cvt_pk_bf16_f32 v51, v166, v167
  buffer_store_dwordx4 v[48:51], v218, s[28:31], s82 offen sc1
  v_pk_mul_f32 v[168:169], v[168:169], v[248:249]
  v_pk_mul_f32 v[170:171], v[170:171], v[250:251]
  v_pk_mul_f32 v[172:173], v[172:173], v[252:253]
  v_pk_mul_f32 v[174:175], v[174:175], v[254:255]
  v_cvt_pk_bf16_f32 v52, v168, v169
  v_cvt_pk_bf16_f32 v53, v170, v171
  v_cvt_pk_bf16_f32 v54, v172, v173
  v_cvt_pk_bf16_f32 v55, v174, v175
  buffer_store_dwordx4 v[52:55], v219, s[28:31], s82 offen sc1
  v_pk_mul_f32 v[176:177], v[176:177], v[240:241]
  v_pk_mul_f32 v[178:179], v[178:179], v[242:243]
  v_pk_mul_f32 v[180:181], v[180:181], v[244:245]
  v_pk_mul_f32 v[182:183], v[182:183], v[246:247]
  v_cvt_pk_bf16_f32 v56, v176, v177
  v_cvt_pk_bf16_f32 v57, v178, v179
  v_cvt_pk_bf16_f32 v58, v180, v181
  v_cvt_pk_bf16_f32 v59, v182, v183
  buffer_store_dwordx4 v[56:59], v218, s[28:31], s83 offen sc1
  v_pk_mul_f32 v[184:185], v[184:185], v[248:249]
  v_pk_mul_f32 v[186:187], v[186:187], v[250:251]
  v_pk_mul_f32 v[188:189], v[188:189], v[252:253]
  v_pk_mul_f32 v[190:191], v[190:191], v[254:255]
  v_cvt_pk_bf16_f32 v60, v184, v185
  v_cvt_pk_bf16_f32 v61, v186, v187
  v_cvt_pk_bf16_f32 v62, v188, v189
  v_cvt_pk_bf16_f32 v63, v190, v191
  buffer_store_dwordx4 v[60:63], v219, s[28:31], s83 offen sc1
  s_nop 1
  s_branch K1E_15
K1I_2:
  s_add_u32 m0, s43, 0
  s_mul_i32 s87, s91, 0
  s_add_u32 s87, s87, s90
  buffer_load_dwordx4 v37, s[20:23], s87 offen nt lds
  s_add_u32 m0, s43, 1024
  s_mul_i32 s87, s91, 1
  s_add_u32 s87, s87, s90
  buffer_load_dwordx4 v37, s[20:23], s87 offen nt lds
  s_add_u32 m0, s43, 2048
  s_mul_i32 s87, s91, 2
  s_add_u32 s87, s87, s90
  buffer_load_dwordx4 v37, s[20:23], s87 offen nt lds
  s_add_u32 m0, s43, 3072
  s_mul_i32 s87, s91, 3
  s_add_u32 s87, s87, s90
  buffer_load_dwordx4 v37, s[20:23], s87 offen nt lds
  s_waitcnt vmcnt(0)
  ds_read_b64_tr_b16 v[64:65], v15
  ds_read_b64_tr_b16 v[66:67], v15 offset:512
  ds_read_b64_tr_b16 v[68:69], v15 offset:1024
  ds_read_b64_tr_b16 v[70:71], v15 offset:1536
  ds_read_b64_tr_b16 v[72:73], v15 offset:2048
  ds_read_b64_tr_b16 v[74:75], v15 offset:2560
  ds_read_b64_tr_b16 v[76:77], v15 offset:3072
  ds_read_b64_tr_b16 v[78:79], v15 offset:3584
  s_waitcnt lgkmcnt(6)
  buffer_store_dwordx4 v[64:67], v6, s[28:31], s40 offen sc1
  s_add_u32 s40, s40, s38
  s_waitcnt lgkmcnt(4)
  buffer_store_dwordx4 v[68:71], v6, s[28:31], s40 offen sc1
  s_add_u32 s40, s40, s38
  s_waitcnt lgkmcnt(2)
  buffer_store_dwordx4 v[72:75], v6, s[28:31], s40 offen sc1
  s_add_u32 s40, s40, s38
  s_waitcnt lgkmcnt(0)
  buffer_store_dwordx4 v[76:79], v6, s[28:31], s40 offen sc1
  v_mfma_f32_4x4x4_16b_bf16 v[96:99], v[216:217], v[64:65], 0
  v_mfma_f32_4x4x4_16b_bf16 v[100:103], v[216:217], v[66:67], 0
  s_nop 0
  v_mfma_f32_4x4x4_16b_bf16 v[96:99], v[216:217], v[68:69], v[96:99]
  v_mfma_f32_4x4x4_16b_bf16 v[100:103], v[216:217], v[70:71], v[100:103]
  s_nop 0
  v_mfma_f32_4x4x4_16b_bf16 v[96:99], v[216:217], v[72:73], v[96:99]
  v_mfma_f32_4x4x4_16b_bf16 v[100:103], v[216:217], v[74:75], v[100:103]
  s_nop 0
  v_mfma_f32_4x4x4_16b_bf16 v[96:99], v[216:217], v[76:77], v[96:99]
  v_mfma_f32_4x4x4_16b_bf16 v[100:103], v[216:217], v[78:79], v[100:103]
  s_add_u32 m0, s43, 0
  s_mul_i32 s87, s91, 4
  s_add_u32 s87, s87, s90
  buffer_load_dwordx4 v37, s[20:23], s87 offen nt lds
  s_add_u32 m0, s43, 1024
  s_mul_i32 s87, s91, 5
  s_add_u32 s87, s87, s90
  buffer_load_dwordx4 v37, s[20:23], s87 offen nt lds
  s_add_u32 m0, s43, 2048
  s_mul_i32 s87, s91, 6
  s_add_u32 s87, s87, s90
  buffer_load_dwordx4 v37, s[20:23], s87 offen nt lds
  s_add_u32 m0, s43, 3072
  s_mul_i32 s87, s91, 7
  s_add_u32 s87, s87, s90
  buffer_load_dwordx4 v37, s[20:23], s87 offen nt lds
  s_waitcnt vmcnt(0)
  ds_read_b64_tr_b16 v[64:65], v15
  ds_read_b64_tr_b16 v[66:67], v15 offset:512
  ds_read_b64_tr_b16 v[68:69], v15 offset:1024
  ds_read_b64_tr_b16 v[70:71], v15 offset:1536
  ds_read_b64_tr_b16 v[72:73], v15 offset:2048
  ds_read_b64_tr_b16 v[74:75], v15 offset:2560
  ds_read_b64_tr_b16 v[76:77], v15 offset:3072
  ds_read_b64_tr_b16 v[78:79], v15 offset:3584
  s_mul_i32 s87, s38, 3
  s_sub_u32 s40, s40, s87
  s_add_u32 s40, s40, s41
  s_waitcnt lgkmcnt(6)
  buffer_store_dwordx4 v[64:67], v6, s[28:31], s40 offen sc1
  s_add_u32 s40, s40, s38
  s_waitcnt lgkmcnt(4)
  buffer_store_dwordx4 v[68:71], v6, s[28:31], s40 offen sc1
  s_add_u32 s40, s40, s38
  s_waitcnt lgkmcnt(2)
  buffer_store_dwordx4 v[72:75], v6, s[28:31], s40 offen sc1
  s_add_u32 s40, s40, s38
  s_waitcnt lgkmcnt(0)
  buffer_store_dwordx4 v[76:79], v6, s[28:31], s40 offen sc1
  v_mfma_f32_4x4x4_16b_bf16 v[96:99], v[216:217], v[64:65], v[96:99]
  v_mfma_f32_4x4x4_16b_bf16 v[100:103], v[216:217], v[66:67], v[100:103]
  s_nop 0
  v_mfma_f32_4x4x4_16b_bf16 v[96:99], v[216:217], v[68:69], v[96:99]
  v_mfma_f32_4x4x4_16b_bf16 v[100:103], v[216:217], v[70:71], v[100:103]
  s_nop 0
  v_mfma_f32_4x4x4_16b_bf16 v[96:99], v[216:217], v[72:73], v[96:99]
  v_mfma_f32_4x4x4_16b_bf16 v[100:103], v[216:217], v[74:75], v[100:103]
  s_nop 0
  v_mfma_f32_4x4x4_16b_bf16 v[96:99], v[216:217], v[76:77], v[96:99]
  v_mfma_f32_4x4x4_16b_bf16 v[100:103], v[216:217], v[78:79], v[100:103]
  s_nop 4
  v_add_f32 v96, v96, v100
  buffer_store_dword v96, v7, s[28:31], s42 offen sc1
  s_getpc_b64 s[68:69]
K1_PC2:
  s_add_u32 s68, s68, main_kernel-K1_PC2
  s_addc_u32 s69, s69, 0
  s_and_b32 s36, s54, 1
  s_lshl_b32 s36, s36, 2
  s_add_u32 s36, s36, s3
  s_lshl_b32 s36, s36, 13
  v_lshl_add_u32 v16, v0, 7, s36
  v_min_u32 v16, MAIN_END-main_kernel, v16
  s_waitcnt vmcnt(0) lgkmcnt(0)
  global_load_dword v63, v16, s[68:69]
K1E_15:
K1_END:

  s_endpgm
.globl main_kernel
.p2align 8
.type main_kernel,@function
main_kernel:
  s_cmp_ge_u32 s2, 256
  s_cbranch_scc1 MAIN_END
  s_load_dwordx2 s[14:15], s[0:1], 56
  s_load_dwordx2 s[12:13], s[0:1], 72
  v_lshrrev_b32 v1, 6, v0
  v_and_b32 v0, 63, v0
  v_readfirstlane_b32 s18, v1
  s_getreg_b32 s16, hwreg(HW_REG_XCC_ID)
  s_and_b32 s16, s16, 7
  s_lshr_b32 s17, s2, 3
  v_lshlrev_b32 v1, 4, v0
  v_mov_b32 v61, 0
  v_mov_b32 v60, 1
  s_lshl_b32 s21, s16, 7
  s_lshl_b32 s26, s18, 12
  s_lshl_b32 s36, s17, 2
  s_add_u32 s36, s36, s21
  s_add_u32 s36, s36, 12288
  s_waitcnt lgkmcnt(0)
  s_mov_b32 s4, s12
  s_mov_b32 s5, s13
  s_mov_b32 s6, 62312448
  s_mov_b32 s7, 0x20000
  s_cmp_lg_u32 s18, 0
  s_cbranch_scc1 CL0_1
  s_mov_b64 exec, 1
  buffer_atomic_add v60, v61, s[4:7], s36 offen sc0
  s_mov_b64 exec, -1
CL0_1:
  s_mov_b32 s66, 0
  s_mov_b32 s8, s12
  s_mov_b32 s9, s13
  s_mov_b32 s10, 62312448
  s_mov_b32 s11, 0x20000
  s_mov_b32 s20, 0
  s_mov_b32 s19, 15650816
  s_mov_b32 s65, 10276864
  v_and_b32 v4, 31, v0
  v_lshrrev_b32 v5, 5, v0
  v_mov_b32 v8, 1073741824
  s_nop 2
  s_branch ATT_ENTRY
LAYER_LOOP:
  s_cmp_ge_u32 s17, 30
  s_cbranch_scc1 QKV_I_4
  s_lshl_b32 s36, s28, 1
  s_lshr_b32 s37, s18, 1
  s_add_u32 s36, s36, s37
  s_and_b32 s37, s18, 1
  s_lshl_b32 s37, s37, 4
  s_lshl_b32 s37, 0x0101, s37
  v_lshrrev_b32 v13, 3, v0
  v_cmp_eq_u32 vcc, s36, v13
  v_mov_b32 v14, s37
  s_nop 0
  v_cndmask_b32 v13, 0, v14, vcc
  s_lshl_b32 s44, s16, 3
  s_lshl_b32 s36, s28, 2
  s_add_u32 s44, s44, s36
  s_add_u32 s44, s44, s18
  s_mul_i32 s45, s44, 40960
  s_add_u32 s40, s45, s65
  s_lshl_b32 s41, s44, 8
  s_add_u32 s41, s41, 15519744
  v_lshlrev_b32 v15, 16, v5
  v_lshl_add_u32 v15, v4, 3, v15
  ds_read_b64 v[28:29], v11
  ds_read_b64 v[30:31], v11 offset:512
  ds_read_b64 v[32:33], v11 offset:1024
  ds_read_b64 v[34:35], v11 offset:1536
  v_lshlrev_b32 v12, 2, v4
  s_add_u32 s58, s21, 0
  s_mov_b32 s59, 0
  s_nop 0
POLL_5:
  buffer_load_dword v14, v12, s[4:7], s58 offen sc1
  s_add_u32 s59, s59, 1
  s_waitcnt vmcnt(0)
  v_and_b32 v14, v14, v13
  v_cmp_ne_u32 vcc, v14, v13
  s_cmp_ge_u32 s59, 60000
  s_cbranch_scc1 POLLD_6
  s_nop 0
  s_cbranch_vccnz POLL_5
POLLD_6:
  s_barrier
  buffer_load_dwordx4 a[0:3], v1, s[4:7], s40 offen sc1
  buffer_load_dwordx4 a[4:7], v1, s[4:7], s40 offen offset:1024 sc1
  buffer_load_dwordx4 a[8:11], v1, s[4:7], s40 offen offset:2048 sc1
  buffer_load_dwordx4 a[12:15], v1, s[4:7], s40 offen offset:3072 sc1
  s_add_u32 s42, s40, 4096
  buffer_load_dwordx4 a[16:19], v1, s[4:7], s42 offen sc1
  buffer_load_dwordx4 a[20:23], v1, s[4:7], s42 offen offset:1024 sc1
  buffer_load_dwordx4 a[24:27], v1, s[4:7], s42 offen offset:2048 sc1
  buffer_load_dwordx4 a[28:31], v1, s[4:7], s42 offen offset:3072 sc1
  s_cmp_ge_u32 s29, 10
  s_cbranch_scc1 QKV_V_2
  ds_read_b128 a[160:163], v2
  ds_read_b128 a[164:167], v2 offset:4096
  ds_read_b128 a[168:171], v2 offset:8192
  ds_read_b128 a[172:175], v2 offset:12288
  ds_read_b128 a[176:179], v2 offset:1024
  ds_read_b128 a[180:183], v2 offset:5120
  ds_read_b128 a[184:187], v2 offset:9216
  ds_read_b128 a[188:191], v2 offset:13312
  s_waitcnt lgkmcnt(4)
  s_waitcnt vmcnt(7)
  v_mfma_f32_32x32x16_bf16 v[128:143], a[160:163], a[0:3], 0
  ds_read_b128 a[192:195], v2 offset:2048
  s_add_u32 s42, s40, 8192
  buffer_load_dwordx4 a[32:35], v1, s[4:7], s42 offen sc1
  v_mfma_f32_32x32x16_bf16 v[144:159], a[164:167], a[0:3], 0
  ds_read_b128 a[196:199], v2 offset:6144
  buffer_load_dwordx2 v[16:17], v15, s[4:7], s41 offen sc1
  v_mfma_f32_32x32x16_bf16 v[160:175], a[168:171], a[0:3], 0
  ds_read_b128 a[200:203], v2 offset:10240
  s_add_u32 s43, s41, 16384
  buffer_load_dwordx2 v[18:19], v15, s[4:7], s43 offen sc1
  v_mfma_f32_32x32x16_bf16 v[176:191], a[172:175], a[0:3], 0
  ds_read_b128 a[204:207], v2 offset:14336
  s_waitcnt lgkmcnt(4)
  s_waitcnt vmcnt(9)
  v_mfma_f32_32x32x16_bf16 v[128:143], a[176:179], a[4:7], v[128:143]
  ds_read_b128 a[160:163], v2 offset:3072
  buffer_load_dwordx4 a[36:39], v1, s[4:7], s42 offen offset:1024 sc1
  v_mfma_f32_32x32x16_bf16 v[144:159], a[180:183], a[4:7], v[144:159]
  ds_read_b128 a[164:167], v2 offset:7168
  s_add_u32 s43, s41, 32768
  buffer_load_dwordx2 v[20:21], v15, s[4:7], s43 offen sc1
  v_mfma_f32_32x32x16_bf16 v[160:175], a[184:187], a[4:7], v[160:175]
  ds_read_b128 a[168:171], v2 offset:11264
  s_add_u32 s43, s41, 49152
  buffer_load_dwordx2 v[22:23], v15, s[4:7], s43 offen sc1
  v_mfma_f32_32x32x16_bf16 v[176:191], a[188:191], a[4:7], v[176:191]
  ds_read_b128 a[172:175], v2 offset:15360
  s_add_u32 m0, s26, 0
  s_add_u32 s32, s22, 20480
  buffer_load_dwordx4 v1, s[4:7], s32 offen offset:0 lds
  s_waitcnt lgkmcnt(4)
  s_waitcnt vmcnt(12)
  v_mfma_f32_32x32x16_bf16 v[128:143], a[192:195], a[8:11], v[128:143]
  ds_read_b128 a[176:179], v2 offset:16384
  buffer_load_dwordx4 a[40:43], v1, s[4:7], s42 offen offset:2048 sc1
  v_mfma_f32_32x32x16_bf16 v[144:159], a[196:199], a[8:11], v[144:159]
  ds_read_b128 a[180:183], v2 offset:20480
  buffer_load_dwordx4 v1, s[4:7], s32 offen offset:1024 lds
  v_mfma_f32_32x32x16_bf16 v[160:175], a[200:203], a[8:11], v[160:175]
  ds_read_b128 a[184:187], v2 offset:24576
  v_mfma_f32_32x32x16_bf16 v[176:191], a[204:207], a[8:11], v[176:191]
  ds_read_b128 a[188:191], v2 offset:28672
  s_waitcnt lgkmcnt(4)
  s_waitcnt vmcnt(13)
  v_mfma_f32_32x32x16_bf16 v[128:143], a[160:163], a[12:15], v[128:143]
  ds_read_b128 a[192:195], v2 offset:17408
  buffer_load_dwordx4 a[44:47], v1, s[4:7], s42 offen offset:3072 sc1
  v_mfma_f32_32x32x16_bf16 v[144:159], a[164:167], a[12:15], v[144:159]
  ds_read_b128 a[196:199], v2 offset:21504
  buffer_load_dwordx4 v1, s[4:7], s32 offen offset:2048 lds
  v_mfma_f32_32x32x16_bf16 v[160:175], a[168:171], a[12:15], v[160:175]
  ds_read_b128 a[200:203], v2 offset:25600
  v_mfma_f32_32x32x16_bf16 v[176:191], a[172:175], a[12:15], v[176:191]
  ds_read_b128 a[204:207], v2 offset:29696
  s_waitcnt lgkmcnt(4)
  s_waitcnt vmcnt(14)
  v_mfma_f32_32x32x16_bf16 v[128:143], a[176:179], a[16:19], v[128:143]
  ds_read_b128 a[160:163], v2 offset:18432
  s_add_u32 s42, s40, 12288
  buffer_load_dwordx4 a[48:51], v1, s[4:7], s42 offen sc1
  v_mfma_f32_32x32x16_bf16 v[144:159], a[180:183], a[16:19], v[144:159]
  ds_read_b128 a[164:167], v2 offset:22528
  buffer_load_dwordx4 v1, s[4:7], s32 offen offset:3072 lds
  v_mfma_f32_32x32x16_bf16 v[160:175], a[184:187], a[16:19], v[160:175]
  ds_read_b128 a[168:171], v2 offset:26624
  v_mfma_f32_32x32x16_bf16 v[176:191], a[188:191], a[16:19], v[176:191]
  ds_read_b128 a[172:175], v2 offset:30720
  s_waitcnt lgkmcnt(4)
  s_waitcnt vmcnt(15)
  v_mfma_f32_32x32x16_bf16 v[128:143], a[192:195], a[20:23], v[128:143]
  ds_read_b128 a[176:179], v2 offset:19456
  buffer_load_dwordx4 a[52:55], v1, s[4:7], s42 offen offset:1024 sc1
  v_mfma_f32_32x32x16_bf16 v[144:159], a[196:199], a[20:23], v[144:159]
  ds_read_b128 a[180:183], v2 offset:23552
  s_add_u32 m0, s26, 16384
  s_add_u32 s32, s70, 24576
  buffer_load_dwordx4 v1, s[4:7], s32 offen offset:0 lds
  v_mfma_f32_32x32x16_bf16 v[160:175], a[200:203], a[20:23], v[160:175]
  ds_read_b128 a[184:187], v2 offset:27648
  v_mfma_f32_32x32x16_bf16 v[176:191], a[204:207], a[20:23], v[176:191]
  ds_read_b128 a[188:191], v2 offset:31744
  s_waitcnt lgkmcnt(4)
  s_waitcnt vmcnt(16)
  v_mfma_f32_32x32x16_bf16 v[128:143], a[160:163], a[24:27], v[128:143]
  ds_read_b128 a[192:195], v2 offset:32768
  buffer_load_dwordx4 a[56:59], v1, s[4:7], s42 offen offset:2048 sc1
  v_mfma_f32_32x32x16_bf16 v[144:159], a[164:167], a[24:27], v[144:159]
  ds_read_b128 a[196:199], v2 offset:36864
  buffer_load_dwordx4 v1, s[4:7], s32 offen offset:1024 lds
  v_mfma_f32_32x32x16_bf16 v[160:175], a[168:171], a[24:27], v[160:175]
  ds_read_b128 a[200:203], v2 offset:40960
  v_mfma_f32_32x32x16_bf16 v[176:191], a[172:175], a[24:27], v[176:191]
  ds_read_b128 a[204:207], v2 offset:45056
  s_waitcnt lgkmcnt(4)
  s_waitcnt vmcnt(17)
  v_mfma_f32_32x32x16_bf16 v[128:143], a[176:179], a[28:31], v[128:143]
  ds_read_b128 a[160:163], v2 offset:33792
  buffer_load_dwordx4 a[60:63], v1, s[4:7], s42 offen offset:3072 sc1
  v_mfma_f32_32x32x16_bf16 v[144:159], a[180:183], a[28:31], v[144:159]
  ds_read_b128 a[164:167], v2 offset:37888
  buffer_load_dwordx4 v1, s[4:7], s32 offen offset:2048 lds
  v_mfma_f32_32x32x16_bf16 v[160:175], a[184:187], a[28:31], v[160:175]
  ds_read_b128 a[168:171], v2 offset:41984
  v_mfma_f32_32x32x16_bf16 v[176:191], a[188:191], a[28:31], v[176:191]
  ds_read_b128 a[172:175], v2 offset:46080
  s_waitcnt lgkmcnt(4)
  s_waitcnt vmcnt(18)
  v_mfma_f32_32x32x16_bf16 v[128:143], a[192:195], a[32:35], v[128:143]
  ds_read_b128 a[176:179], v2 offset:34816
  s_add_u32 s42, s40, 16384
  buffer_load_dwordx4 a[64:67], v1, s[4:7], s42 offen sc1
  s_waitcnt vmcnt(17)
  v_add_f32 v16, v16, v18
  v_add_f32 v17, v17, v19
  s_waitcnt vmcnt(14)
  v_add_f32 v20, v20, v22
  v_mfma_f32_32x32x16_bf16 v[144:159], a[196:199], a[32:35], v[144:159]
  ds_read_b128 a[180:183], v2 offset:38912
  buffer_load_dwordx4 v1, s[4:7], s32 offen offset:3072 lds
  v_mfma_f32_32x32x16_bf16 v[160:175], a[200:203], a[32:35], v[160:175]
  ds_read_b128 a[184:187], v2 offset:43008
  v_mfma_f32_32x32x16_bf16 v[176:191], a[204:207], a[32:35], v[176:191]
  ds_read_b128 a[188:191], v2 offset:47104
  s_waitcnt lgkmcnt(4)
  v_mfma_f32_32x32x16_bf16 v[128:143], a[160:163], a[36:39], v[128:143]
  ds_read_b128 a[192:195], v2 offset:35840
  buffer_load_dwordx4 a[68:71], v1, s[4:7], s42 offen offset:1024 sc1
  v_add_f32 v21, v21, v23
  v_add_f32 v16, v16, v20
  v_add_f32 v17, v17, v21
  v_mfma_f32_32x32x16_bf16 v[144:159], a[164:167], a[36:39], v[144:159]
  ds_read_b128 a[196:199], v2 offset:39936
  s_add_u32 m0, s26, 32768
  s_add_u32 s32, s70, 32768
  buffer_load_dwordx4 v1, s[4:7], s32 offen offset:0 lds
  v_mfma_f32_32x32x16_bf16 v[160:175], a[168:171], a[36:39], v[160:175]
  ds_read_b128 a[200:203], v2 offset:44032
  v_mfma_f32_32x32x16_bf16 v[176:191], a[172:175], a[36:39], v[176:191]
  ds_read_b128 a[204:207], v2 offset:48128
  s_waitcnt lgkmcnt(4)
  s_waitcnt vmcnt(15)
  v_mfma_f32_32x32x16_bf16 v[128:143], a[176:179], a[40:43], v[128:143]
  ds_read_b128 a[160:163], v2 offset:49152
  buffer_load_dwordx4 a[72:75], v1, s[4:7], s42 offen offset:2048 sc1
  v_mov_b32 v18, v16
  v_mov_b32 v19, v17
  s_nop 0
  v_permlane32_swap_b32 v16, v18
  v_mfma_f32_32x32x16_bf16 v[144:159], a[180:183], a[40:43], v[144:159]
  ds_read_b128 a[164:167], v2 offset:53248
  buffer_load_dwordx4 v1, s[4:7], s32 offen offset:1024 lds
  v_mfma_f32_32x32x16_bf16 v[160:175], a[184:187], a[40:43], v[160:175]
  ds_read_b128 a[168:171], v2 offset:57344
  v_mfma_f32_32x32x16_bf16 v[176:191], a[188:191], a[40:43], v[176:191]
  ds_read_b128 a[172:175], v2 offset:61440
  s_waitcnt lgkmcnt(4)
  s_waitcnt vmcnt(15)
  v_mfma_f32_32x32x16_bf16 v[128:143], a[192:195], a[44:47], v[128:143]
  ds_read_b128 a[176:179], v2 offset:50176
  buffer_load_dwordx4 a[76:79], v1, s[4:7], s42 offen offset:3072 sc1
  v_permlane32_swap_b32 v17, v19
  v_add_f32 v16, v16, v18
  v_add_f32 v17, v17, v19
  v_mfma_f32_32x32x16_bf16 v[144:159], a[196:199], a[44:47], v[144:159]
  ds_read_b128 a[180:183], v2 offset:54272
  v_mfma_f32_32x32x16_bf16 v[160:175], a[200:203], a[44:47], v[160:175]
  ds_read_b128 a[184:187], v2 offset:58368
  v_mfma_f32_32x32x16_bf16 v[176:191], a[204:207], a[44:47], v[176:191]
  ds_read_b128 a[188:191], v2 offset:62464
  s_waitcnt lgkmcnt(4)
  s_waitcnt vmcnt(14)
  v_mfma_f32_32x32x16_bf16 v[128:143], a[160:163], a[48:51], v[128:143]
  ds_read_b128 a[192:195], v2 offset:51200
  s_add_u32 s42, s40, 20480
  buffer_load_dwordx4 a[80:83], v1, s[4:7], s42 offen sc1
  v_mul_f32 v16, 0xbacccccd, v16
  v_mul_f32 v17, 0x3acccccd, v17
  v_fma_f32 v17, -v16, v16, v17
  v_mfma_f32_32x32x16_bf16 v[144:159], a[164:167], a[48:51], v[144:159]
  ds_read_b128 a[196:199], v2 offset:55296
  buffer_load_dwordx4 v1, s[4:7], s32 offen offset:2048 lds
  v_mfma_f32_32x32x16_bf16 v[160:175], a[168:171], a[48:51], v[160:175]
  ds_read_b128 a[200:203], v2 offset:59392
  v_mfma_f32_32x32x16_bf16 v[176:191], a[172:175], a[48:51], v[176:191]
  ds_read_b128 a[204:207], v2 offset:63488
  s_waitcnt lgkmcnt(4)
  s_waitcnt vmcnt(14)
  v_mfma_f32_32x32x16_bf16 v[128:143], a[176:179], a[52:55], v[128:143]
  ds_read_b128 a[160:163], v2 offset:52224
  buffer_load_dwordx4 a[84:87], v1, s[4:7], s42 offen offset:1024 sc1
  v_max_f32 v17, 0, v17
  v_add_f32 v17, 0x3727c5ac, v17
  v_rsq_f32 v24, v17
  v_mfma_f32_32x32x16_bf16 v[144:159], a[180:183], a[52:55], v[144:159]
  ds_read_b128 a[164:167], v2 offset:56320
  buffer_load_dwordx4 v1, s[4:7], s32 offen offset:3072 lds
  v_mfma_f32_32x32x16_bf16 v[160:175], a[184:187], a[52:55], v[160:175]
  ds_read_b128 a[168:171], v2 offset:60416
  v_mfma_f32_32x32x16_bf16 v[176:191], a[188:191], a[52:55], v[176:191]
  ds_read_b128 a[172:175], v2 offset:64512
  s_waitcnt lgkmcnt(4)
  s_waitcnt vmcnt(14)
  v_mfma_f32_32x32x16_bf16 v[128:143], a[192:195], a[56:59], v[128:143]
  ds_read_b128 a[176:179], v3
  buffer_load_dwordx4 a[88:91], v1, s[4:7], s42 offen offset:2048 sc1
  v_cvt_pk_bf16_f32 v26, v16, v16
  v_and_b32 v18, 0xffff0000, v26
  v_sub_f32 v18, v16, v18
  v_mfma_f32_32x32x16_bf16 v[144:159], a[196:199], a[56:59], v[144:159]
  ds_read_b128 a[180:183], v3 offset:4096
  s_add_u32 m0, s26, 49152
  s_add_u32 s32, s70, 106496
  buffer_load_dwordx4 v1, s[4:7], s32 offen offset:0 lds
  v_mfma_f32_32x32x16_bf16 v[160:175], a[200:203], a[56:59], v[160:175]
  ds_read_b128 a[184:187], v3 offset:8192
  v_mfma_f32_32x32x16_bf16 v[176:191], a[204:207], a[56:59], v[176:191]
  ds_read_b128 a[188:191], v3 offset:12288
  s_waitcnt lgkmcnt(4)
  s_waitcnt vmcnt(14)
  v_mfma_f32_32x32x16_bf16 v[128:143], a[160:163], a[60:63], v[128:143]
  ds_read_b128 a[192:195], v3 offset:1024
  buffer_load_dwordx4 a[92:95], v1, s[4:7], s42 offen offset:3072 sc1
  v_cvt_pk_bf16_f32 v27, v18, 0
  v_mfma_f32_32x32x16_bf16 v[144:159], a[164:167], a[60:63], v[144:159]
  ds_read_b128 a[196:199], v3 offset:5120
  buffer_load_dwordx4 v1, s[4:7], s32 offen offset:1024 lds
  v_mfma_f32_32x32x16_bf16 v[160:175], a[168:171], a[60:63], v[160:175]
  ds_read_b128 a[200:203], v3 offset:9216
  v_mfma_f32_32x32x16_bf16 v[176:191], a[172:175], a[60:63], v[176:191]
  ds_read_b128 a[204:207], v3 offset:13312
  s_waitcnt lgkmcnt(4)
  s_waitcnt vmcnt(14)
  v_mfma_f32_32x32x16_bf16 v[128:143], a[176:179], a[64:67], v[128:143]
  ds_read_b128 a[160:163], v3 offset:2048
  s_add_u32 s42, s40, 24576
  buffer_load_dwordx4 a[96:99], v1, s[4:7], s42 offen sc1
  v_mfma_f32_32x32x16_bf16 v[144:159], a[180:183], a[64:67], v[144:159]
  ds_read_b128 a[164:167], v3 offset:6144
  buffer_load_dwordx4 a[100:103], v1, s[4:7], s42 offen offset:1024 sc1
  v_mfma_f32_32x32x16_bf16 v[160:175], a[184:187], a[64:67], v[160:175]
  ds_read_b128 a[168:171], v3 offset:10240
  buffer_load_dwordx4 v1, s[4:7], s32 offen offset:2048 lds
  v_mfma_f32_32x32x16_bf16 v[176:191], a[188:191], a[64:67], v[176:191]
  ds_read_b128 a[172:175], v3 offset:14336
  s_waitcnt lgkmcnt(4)
  s_waitcnt vmcnt(15)
  v_mfma_f32_32x32x16_bf16 v[128:143], a[192:195], a[68:71], v[128:143]
  ds_read_b128 a[176:179], v3 offset:3072
  buffer_load_dwordx4 a[104:107], v1, s[4:7], s42 offen offset:2048 sc1
  v_mfma_f32_32x32x16_bf16 v[144:159], a[196:199], a[68:71], v[144:159]
  ds_read_b128 a[180:183], v3 offset:7168
  buffer_load_dwordx4 a[108:111], v1, s[4:7], s42 offen offset:3072 sc1
  v_mfma_f32_32x32x16_bf16 v[160:175], a[200:203], a[68:71], v[160:175]
  ds_read_b128 a[184:187], v3 offset:11264
  buffer_load_dwordx4 v1, s[4:7], s32 offen offset:3072 lds
  v_mfma_f32_32x32x16_bf16 v[176:191], a[204:207], a[68:71], v[176:191]
  ds_read_b128 a[188:191], v3 offset:15360
  s_waitcnt lgkmcnt(4)
  s_waitcnt vmcnt(16)
  v_mfma_f32_32x32x16_bf16 v[128:143], a[160:163], a[72:75], v[128:143]
  s_barrier
  ds_read_b128 a[192:195], v1
  s_add_u32 s42, s40, 28672
  buffer_load_dwordx4 a[112:115], v1, s[4:7], s42 offen sc1
  v_mfma_f32_32x32x16_bf16 v[144:159], a[164:167], a[72:75], v[144:159]
  ds_read_b128 a[196:199], v1 offset:4096
  buffer_load_dwordx4 a[116:119], v1, s[4:7], s42 offen offset:1024 sc1
  v_mfma_f32_32x32x16_bf16 v[160:175], a[168:171], a[72:75], v[160:175]
  ds_read_b128 a[200:203], v1 offset:8192
  v_mfma_f32_32x32x16_bf16 v[176:191], a[172:175], a[72:75], v[176:191]
  ds_read_b128 a[204:207], v1 offset:12288
  s_waitcnt lgkmcnt(4)
  s_waitcnt vmcnt(16)
  v_mfma_f32_32x32x16_bf16 v[128:143], a[176:179], a[76:79], v[128:143]
  ds_read_b128 a[160:163], v1 offset:1024
  buffer_load_dwordx4 a[120:123], v1, s[4:7], s42 offen offset:2048 sc1
  v_mfma_f32_32x32x16_bf16 v[144:159], a[180:183], a[76:79], v[144:159]
  ds_read_b128 a[164:167], v1 offset:5120
  buffer_load_dwordx4 a[124:127], v1, s[4:7], s42 offen offset:3072 sc1
  v_mfma_f32_32x32x16_bf16 v[160:175], a[184:187], a[76:79], v[160:175]
  ds_read_b128 a[168:171], v1 offset:9216
  v_mfma_f32_32x32x16_bf16 v[176:191], a[188:191], a[76:79], v[176:191]
  ds_read_b128 a[172:175], v1 offset:13312
  s_waitcnt lgkmcnt(4)
  s_waitcnt vmcnt(17)
  v_mfma_f32_32x32x16_bf16 v[128:143], a[192:195], a[80:83], v[128:143]
  ds_read_b128 a[176:179], v1 offset:2048
  s_add_u32 s42, s40, 32768
  buffer_load_dwordx4 a[128:131], v1, s[4:7], s42 offen sc1
  v_mfma_f32_32x32x16_bf16 v[144:159], a[196:199], a[80:83], v[144:159]
  ds_read_b128 a[180:183], v1 offset:6144
  buffer_load_dwordx4 a[132:135], v1, s[4:7], s42 offen offset:1024 sc1
  v_mfma_f32_32x32x16_bf16 v[160:175], a[200:203], a[80:83], v[160:175]
  ds_read_b128 a[184:187], v1 offset:10240
  v_mfma_f32_32x32x16_bf16 v[176:191], a[204:207], a[80:83], v[176:191]
  ds_read_b128 a[188:191], v1 offset:14336
  s_waitcnt lgkmcnt(4)
  s_waitcnt vmcnt(17)
  v_mfma_f32_32x32x16_bf16 v[128:143], a[160:163], a[84:87], v[128:143]
  ds_read_b128 a[192:195], v1 offset:3072
  buffer_load_dwordx4 a[136:139], v1, s[4:7], s42 offen offset:2048 sc1
  v_mfma_f32_32x32x16_bf16 v[144:159], a[164:167], a[84:87], v[144:159]
  ds_read_b128 a[196:199], v1 offset:7168
  buffer_load_dwordx4 a[140:143], v1, s[4:7], s42 offen offset:3072 sc1
  v_mfma_f32_32x32x16_bf16 v[160:175], a[168:171], a[84:87], v[160:175]
  ds_read_b128 a[200:203], v1 offset:11264
  v_mfma_f32_32x32x16_bf16 v[176:191], a[172:175], a[84:87], v[176:191]
  ds_read_b128 a[204:207], v1 offset:15360
  s_waitcnt lgkmcnt(4)
  s_waitcnt vmcnt(17)
  v_mfma_f32_32x32x16_bf16 v[128:143], a[176:179], a[88:91], v[128:143]
  s_barrier
  ds_read_b128 a[160:163], v1 offset:16384
  s_add_u32 s42, s40, 36864
  buffer_load_dwordx4 a[144:147], v1, s[4:7], s42 offen sc1
  v_mfma_f32_32x32x16_bf16 v[144:159], a[180:183], a[88:91], v[144:159]
  ds_read_b128 a[164:167], v1 offset:20480
  buffer_load_dwordx4 a[148:151], v1, s[4:7], s42 offen offset:1024 sc1
  v_mfma_f32_32x32x16_bf16 v[160:175], a[184:187], a[88:91], v[160:175]
  ds_read_b128 a[168:171], v1 offset:17408
  v_mfma_f32_32x32x16_bf16 v[176:191], a[188:191], a[88:91], v[176:191]
  ds_read_b128 a[172:175], v1 offset:21504
  s_waitcnt lgkmcnt(4)
  s_waitcnt vmcnt(17)
  v_mfma_f32_32x32x16_bf16 v[128:143], a[192:195], a[92:95], v[128:143]
  ds_read_b128 a[176:179], v1 offset:18432
  buffer_load_dwordx4 a[152:155], v1, s[4:7], s42 offen offset:2048 sc1
  v_mfma_f32_32x32x16_bf16 v[144:159], a[196:199], a[92:95], v[144:159]
  ds_read_b128 a[180:183], v1 offset:22528
  buffer_load_dwordx4 a[156:159], v1, s[4:7], s42 offen offset:3072 sc1
  v_mfma_f32_32x32x16_bf16 v[160:175], a[200:203], a[92:95], v[160:175]
  ds_read_b128 a[184:187], v1 offset:19456
  v_mfma_f32_32x32x16_bf16 v[176:191], a[204:207], a[92:95], v[176:191]
  ds_read_b128 a[188:191], v1 offset:23552
  s_waitcnt lgkmcnt(4)
  s_waitcnt vmcnt(17)
  v_mfma_f32_32x32x16_bf16 v[128:143], a[160:163], a[96:99], v[128:143]
  ds_read_b128 a[192:195], v1 offset:24576
  s_add_u32 m0, s26, 65536
  s_add_u32 s32, s70, 114688
  buffer_load_dwordx4 v1, s[4:7], s32 offen offset:0 lds
  s_cmp_ge_u32 s29, 5
  s_cselect_b32 s46, 0x3f800000, 0x3ea52b5c
  s_cselect_b32 s48, 2580480, 0
  s_lshl_b32 s47, s29, 13
  s_add_u32 s48, s48, s47
  s_add_u32 s48, s48, s45
  s_add_u32 s48, s48, s19
  s_add_u32 s49, s48, 4096
  v_mul_f32 v24, s46, v24
  v_mov_b32 v25, v24
  v_mfma_f32_32x32x16_bf16 v[144:159], a[164:167], a[96:99], v[144:159]
  ds_read_b128 a[196:199], v1 offset:28672
  s_waitcnt vmcnt(17)
  v_mfma_f32_32x32x16_bf16 v[128:143], a[168:171], a[100:103], v[128:143]
  ds_read_b128 a[200:203], v1 offset:25600
  v_mfma_f32_32x32x16_bf16 v[144:159], a[172:175], a[100:103], v[144:159]
  ds_read_b128 a[204:207], v1 offset:29696
  s_waitcnt lgkmcnt(4)
  s_waitcnt vmcnt(15)
  v_mfma_f32_32x32x16_bf16 v[128:143], a[176:179], a[104:107], v[128:143]
  ds_read_b128 a[160:163], v1 offset:26624
  buffer_load_dwordx4 v1, s[4:7], s32 offen offset:1024 lds
  v_mfma_f32_32x32x16_bf16 v[144:159], a[180:183], a[104:107], v[144:159]
  ds_read_b128 a[164:167], v1 offset:30720
  s_waitcnt vmcnt(15)
  v_mfma_f32_32x32x16_bf16 v[128:143], a[184:187], a[108:111], v[128:143]
  ds_read_b128 a[168:171], v1 offset:27648
  v_mfma_f32_32x32x16_bf16 v[144:159], a[188:191], a[108:111], v[144:159]
  ds_read_b128 a[172:175], v1 offset:31744
  s_waitcnt lgkmcnt(4)
  s_waitcnt vmcnt(13)
  v_mfma_f32_32x32x16_bf16 v[128:143], a[192:195], a[112:115], v[128:143]
  ds_read_b128 a[176:179], v1 offset:32768
  buffer_load_dwordx4 v1, s[4:7], s32 offen offset:2048 lds
  v_mfma_f32_32x32x16_bf16 v[144:159], a[196:199], a[112:115], v[144:159]
  ds_read_b128 a[180:183], v1 offset:36864
  s_waitcnt vmcnt(13)
  v_mfma_f32_32x32x16_bf16 v[128:143], a[200:203], a[116:119], v[128:143]
  ds_read_b128 a[184:187], v1 offset:33792
  v_mfma_f32_32x32x16_bf16 v[144:159], a[204:207], a[116:119], v[144:159]
  ds_read_b128 a[188:191], v1 offset:37888
  s_waitcnt lgkmcnt(4)
  s_waitcnt vmcnt(12)
  v_mfma_f32_32x32x16_bf16 v[128:143], a[160:163], a[120:123], v[128:143]
  ds_read_b128 a[192:195], v1 offset:34816
  buffer_load_dwordx4 v1, s[4:7], s32 offen offset:3072 lds
  v_mfma_f32_32x32x16_bf16 v[144:159], a[164:167], a[120:123], v[144:159]
  ds_read_b128 a[196:199], v1 offset:38912
  s_waitcnt vmcnt(12)
  v_mfma_f32_32x32x16_bf16 v[128:143], a[168:171], a[124:127], v[128:143]
  ds_read_b128 a[200:203], v1 offset:35840
  v_mfma_f32_32x32x16_bf16 v[144:159], a[172:175], a[124:127], v[144:159]
  ds_read_b128 a[204:207], v1 offset:39936
  s_waitcnt lgkmcnt(4)
  s_waitcnt vmcnt(11)
  v_mfma_f32_32x32x16_bf16 v[128:143], a[176:179], a[128:131], v[128:143]
  ds_read_b128 a[160:163], v1 offset:40960
  v_mfma_f32_32x32x16_bf16 v[144:159], a[180:183], a[128:131], v[144:159]
  ds_read_b128 a[164:167], v1 offset:45056
  s_waitcnt vmcnt(10)
  v_mfma_f32_32x32x16_bf16 v[128:143], a[184:187], a[132:135], v[128:143]
  ds_read_b128 a[168:171], v1 offset:41984
  v_mfma_f32_32x32x16_bf16 v[144:159], a[188:191], a[132:135], v[144:159]
  ds_read_b128 a[172:175], v1 offset:46080
  s_waitcnt lgkmcnt(4)
  s_waitcnt vmcnt(9)
  v_mfma_f32_32x32x16_bf16 v[128:143], a[192:195], a[136:139], v[128:143]
  ds_read_b128 a[176:179], v1 offset:43008
  v_mfma_f32_32x32x16_bf16 v[144:159], a[196:199], a[136:139], v[144:159]
  ds_read_b128 a[180:183], v1 offset:47104
  s_waitcnt vmcnt(8)
  v_mfma_f32_32x32x16_bf16 v[128:143], a[200:203], a[140:143], v[128:143]
  ds_read_b128 a[184:187], v1 offset:44032
  v_mfma_f32_32x32x16_bf16 v[144:159], a[204:207], a[140:143], v[144:159]
  ds_read_b128 a[188:191], v1 offset:48128
  s_waitcnt lgkmcnt(4)
  s_waitcnt vmcnt(7)
  v_mfma_f32_32x32x16_bf16 v[128:143], a[160:163], a[144:147], v[128:143]
  s_waitcnt vmcnt(0)
  s_barrier
  ds_read_b128 a[192:195], v1 offset:49152
  v_mfma_f32_32x32x16_bf16 v[144:159], a[164:167], a[144:147], v[144:159]
  ds_read_b128 a[196:199], v1 offset:53248
  v_mfma_f32_32x32x16_bf16 v[128:143], a[168:171], a[148:151], v[128:143]
  ds_read_b128 a[200:203], v1 offset:50176
  v_mfma_f32_32x32x16_bf16 v[144:159], a[172:175], a[148:151], v[144:159]
  ds_read_b128 a[204:207], v1 offset:54272
  s_waitcnt lgkmcnt(4)
  v_mfma_f32_32x32x16_bf16 v[128:143], a[176:179], a[152:155], v[128:143]
  ds_read_b128 a[160:163], v1 offset:51200
  v_mfma_f32_32x32x16_bf16 v[144:159], a[180:183], a[152:155], v[144:159]
  ds_read_b128 a[164:167], v1 offset:55296
  v_mfma_f32_32x32x16_bf16 v[128:143], a[184:187], a[156:159], v[128:143]
  ds_read_b128 a[168:171], v1 offset:52224
  v_mfma_f32_32x32x8_bf16 v[128:143], v[28:29], v[26:27], v[128:143]
  v_mfma_f32_32x32x16_bf16 v[144:159], a[188:191], a[156:159], v[144:159]
  ds_read_b128 a[172:175], v1 offset:56320
  v_mfma_f32_32x32x8_bf16 v[144:159], v[30:31], v[26:27], v[144:159]
  s_waitcnt lgkmcnt(4)
  v_mfma_f32_32x32x16_bf16 v[160:175], a[192:195], a[96:99], v[160:175]
  ds_read_b128 a[176:179], v1 offset:57344
  v_mfma_f32_32x32x16_bf16 v[176:191], a[196:199], a[96:99], v[176:191]
  ds_read_b128 a[180:183], v1 offset:61440
  v_mfma_f32_32x32x16_bf16 v[160:175], a[200:203], a[100:103], v[160:175]
  ds_read_b128 a[184:187], v1 offset:58368
  v_mfma_f32_32x32x16_bf16 v[176:191], a[204:207], a[100:103], v[176:191]
  ds_read_b128 a[188:191], v1 offset:62464
  s_waitcnt lgkmcnt(4)
  v_mfma_f32_32x32x16_bf16 v[160:175], a[160:163], a[104:107], v[160:175]
  ds_read_b128 a[192:195], v1 offset:59392
  v_mul_f32 v128, v24, v128
  v_mul_f32 v129, v24, v129
  v_mul_f32 v130, v24, v130
  v_mul_f32 v131, v24, v131
  v_mul_f32 v132, v24, v132
  v_mfma_f32_32x32x16_bf16 v[176:191], a[164:167], a[104:107], v[176:191]
  ds_read_b128 a[196:199], v1 offset:63488
  v_mul_f32 v133, v24, v133
  v_mul_f32 v134, v24, v134
  v_mul_f32 v135, v24, v135
  v_cvt_pk_bf16_f32 v52, v128, v129
  v_cvt_pk_bf16_f32 v53, v130, v131
  v_mfma_f32_32x32x16_bf16 v[160:175], a[168:171], a[108:111], v[160:175]
  ds_read_b128 a[200:203], v1 offset:60416
  v_cvt_pk_bf16_f32 v54, v132, v133
  v_cvt_pk_bf16_f32 v55, v134, v135
  v_mfma_f32_32x32x16_bf16 v[176:191], a[172:175], a[108:111], v[176:191]
  ds_read_b128 a[204:207], v1 offset:64512
  buffer_store_dwordx4 v[52:55], v1, s[4:7], s48 offen sc1
  v_mul_f32 v136, v24, v136
  v_mul_f32 v137, v24, v137
  v_mul_f32 v138, v24, v138
  s_waitcnt lgkmcnt(4)
  v_mfma_f32_32x32x16_bf16 v[160:175], a[176:179], a[112:115], v[160:175]
  ds_read_b128 a[160:163], v2
  v_mul_f32 v139, v24, v139
  v_mul_f32 v140, v24, v140
  v_mul_f32 v141, v24, v141
  v_mul_f32 v142, v24, v142
  v_mul_f32 v143, v24, v143
  v_mfma_f32_32x32x16_bf16 v[176:191], a[180:183], a[112:115], v[176:191]
  ds_read_b128 a[164:167], v2 offset:4096
  v_cvt_pk_bf16_f32 v56, v136, v137
  v_cvt_pk_bf16_f32 v57, v138, v139
  v_cvt_pk_bf16_f32 v58, v140, v141
  v_cvt_pk_bf16_f32 v59, v142, v143
  v_mfma_f32_32x32x16_bf16 v[160:175], a[184:187], a[116:119], v[160:175]
  ds_read_b128 a[168:171], v2 offset:1024
  buffer_store_dwordx4 v[56:59], v1, s[4:7], s48 offen offset:1024 sc1
  v_mul_f32 v144, v24, v144
  v_mul_f32 v145, v24, v145
  v_mul_f32 v146, v24, v146
  v_mul_f32 v147, v24, v147
  v_mfma_f32_32x32x16_bf16 v[176:191], a[188:191], a[116:119], v[176:191]
  ds_read_b128 a[172:175], v2 offset:5120
  v_mul_f32 v148, v24, v148
  v_mul_f32 v149, v24, v149
  v_mul_f32 v150, v24, v150
  v_mul_f32 v151, v24, v151
  s_waitcnt lgkmcnt(4)
  v_mfma_f32_32x32x16_bf16 v[160:175], a[192:195], a[120:123], v[160:175]
  ds_read_b128 a[176:179], v2 offset:2048
  v_cvt_pk_bf16_f32 v60, v144, v145
  v_cvt_pk_bf16_f32 v61, v146, v147
  v_cvt_pk_bf16_f32 v62, v148, v149
  v_cvt_pk_bf16_f32 v63, v150, v151
  v_mfma_f32_32x32x16_bf16 v[176:191], a[196:199], a[120:123], v[176:191]
  ds_read_b128 a[180:183], v2 offset:6144
  buffer_store_dwordx4 v[60:63], v1, s[4:7], s48 offen offset:2048 sc1
  v_mul_f32 v152, v24, v152
  v_mul_f32 v153, v24, v153
  v_mul_f32 v154, v24, v154
  v_mul_f32 v155, v24, v155
  v_mfma_f32_32x32x16_bf16 v[160:175], a[200:203], a[124:127], v[160:175]
  ds_read_b128 a[184:187], v2 offset:3072
  v_mul_f32 v156, v24, v156
  v_mul_f32 v157, v24, v157
  v_mul_f32 v158, v24, v158
  v_mul_f32 v159, v24, v159
  v_cvt_pk_bf16_f32 v64, v152, v153
  v_mfma_f32_32x32x16_bf16 v[176:191], a[204:207], a[124:127], v[176:191]
  ds_read_b128 a[188:191], v2 offset:7168
  v_cvt_pk_bf16_f32 v65, v154, v155
  v_cvt_pk_bf16_f32 v66, v156, v157
  v_cvt_pk_bf16_f32 v67, v158, v159
  s_waitcnt lgkmcnt(4)
  v_mfma_f32_32x32x16_bf16 v[160:175], a[160:163], a[128:131], v[160:175]
  ds_read_b128 a[192:195], v2 offset:8192
  buffer_store_dwordx4 v[64:67], v1, s[4:7], s48 offen offset:3072 sc1
  v_mfma_f32_32x32x16_bf16 v[176:191], a[164:167], a[128:131], v[176:191]
  ds_read_b128 a[196:199], v2 offset:12288
  v_mfma_f32_32x32x16_bf16 v[160:175], a[168:171], a[132:135], v[160:175]
  ds_read_b128 a[200:203], v2 offset:9216
  v_mfma_f32_32x32x16_bf16 v[176:191], a[172:175], a[132:135], v[176:191]
  ds_read_b128 a[204:207], v2 offset:13312
  s_waitcnt lgkmcnt(4)
  v_mfma_f32_32x32x16_bf16 v[160:175], a[176:179], a[136:139], v[160:175]
  ds_read_b128 a[160:163], v2 offset:10240
  v_mfma_f32_32x32x16_bf16 v[176:191], a[180:183], a[136:139], v[176:191]
  ds_read_b128 a[164:167], v2 offset:14336
  v_mfma_f32_32x32x16_bf16 v[160:175], a[184:187], a[140:143], v[160:175]
  ds_read_b128 a[168:171], v2 offset:11264
  v_mfma_f32_32x32x16_bf16 v[176:191], a[188:191], a[140:143], v[176:191]
  ds_read_b128 a[172:175], v2 offset:15360
  s_waitcnt lgkmcnt(4)
  v_mfma_f32_32x32x16_bf16 v[160:175], a[192:195], a[144:147], v[160:175]
  v_mfma_f32_32x32x16_bf16 v[176:191], a[196:199], a[144:147], v[176:191]
  v_mfma_f32_32x32x16_bf16 v[160:175], a[200:203], a[148:151], v[160:175]
  v_mfma_f32_32x32x16_bf16 v[176:191], a[204:207], a[148:151], v[176:191]
  s_waitcnt lgkmcnt(0)
  v_mfma_f32_32x32x16_bf16 v[160:175], a[160:163], a[152:155], v[160:175]
  v_mfma_f32_32x32x16_bf16 v[176:191], a[164:167], a[152:155], v[176:191]
  v_mfma_f32_32x32x16_bf16 v[160:175], a[168:171], a[156:159], v[160:175]
  v_mfma_f32_32x32x8_bf16 v[160:175], v[32:33], v[26:27], v[160:175]
  v_mfma_f32_32x32x16_bf16 v[176:191], a[172:175], a[156:159], v[176:191]
  v_mfma_f32_32x32x8_bf16 v[176:191], v[34:35], v[26:27], v[176:191]
  s_nop 9
  v_pk_mul_f32 v[160:161], v[160:161], v[24:25]
  v_pk_mul_f32 v[162:163], v[162:163], v[24:25]
  v_pk_mul_f32 v[164:165], v[164:165], v[24:25]
  v_pk_mul_f32 v[166:167], v[166:167], v[24:25]
  v_cvt_pk_bf16_f32 v52, v160, v161
  v_cvt_pk_bf16_f32 v53, v162, v163
  v_cvt_pk_bf16_f32 v54, v164, v165
  v_cvt_pk_bf16_f32 v55, v166, v167
  buffer_store_dwordx4 v[52:55], v1, s[4:7], s49 offen sc1
  v_pk_mul_f32 v[168:169], v[168:169], v[24:25]
  v_pk_mul_f32 v[170:171], v[170:171], v[24:25]
  v_pk_mul_f32 v[172:173], v[172:173], v[24:25]
  v_pk_mul_f32 v[174:175], v[174:175], v[24:25]
  v_cvt_pk_bf16_f32 v56, v168, v169
  v_cvt_pk_bf16_f32 v57, v170, v171
  v_cvt_pk_bf16_f32 v58, v172, v173
  v_cvt_pk_bf16_f32 v59, v174, v175
  buffer_store_dwordx4 v[56:59], v1, s[4:7], s49 offen offset:1024 sc1
  v_pk_mul_f32 v[176:177], v[176:177], v[24:25]
  v_pk_mul_f32 v[178:179], v[178:179], v[24:25]
  v_pk_mul_f32 v[180:181], v[180:181], v[24:25]
  v_pk_mul_f32 v[182:183], v[182:183], v[24:25]
  v_cvt_pk_bf16_f32 v60, v176, v177
  v_cvt_pk_bf16_f32 v61, v178, v179
  v_cvt_pk_bf16_f32 v62, v180, v181
  v_cvt_pk_bf16_f32 v63, v182, v183
  buffer_store_dwordx4 v[60:63], v1, s[4:7], s49 offen offset:2048 sc1
  v_pk_mul_f32 v[184:185], v[184:185], v[24:25]
  v_pk_mul_f32 v[186:187], v[186:187], v[24:25]
  v_pk_mul_f32 v[188:189], v[188:189], v[24:25]
  v_pk_mul_f32 v[190:191], v[190:191], v[24:25]
  v_cvt_pk_bf16_f32 v64, v184, v185
  v_cvt_pk_bf16_f32 v65, v186, v187
  v_cvt_pk_bf16_f32 v66, v188, v189
  v_cvt_pk_bf16_f32 v67, v190, v191
  buffer_store_dwordx4 v[64:67], v1, s[4:7], s49 offen offset:3072 sc1
  s_nop 1
  s_branch QKV_P_3
QKV_V_2:
  ds_read_b128 a[160:163], v2
  ds_read_b128 a[164:167], v2 offset:4096
  ds_read_b128 a[168:171], v2 offset:8192
  ds_read_b128 a[172:175], v2 offset:12288
  ds_read_b128 a[176:179], v2 offset:1024
  ds_read_b128 a[180:183], v2 offset:5120
  ds_read_b128 a[184:187], v2 offset:9216
  ds_read_b128 a[188:191], v2 offset:13312
  s_waitcnt lgkmcnt(4)
  s_waitcnt vmcnt(7)
  v_mfma_f32_32x32x16_bf16 v[128:143], a[0:3], a[160:163], 0
  ds_read_b128 a[192:195], v2 offset:2048
  s_add_u32 s42, s40, 8192
  buffer_load_dwordx4 a[32:35], v1, s[4:7], s42 offen sc1
  v_mfma_f32_32x32x16_bf16 v[144:159], a[0:3], a[164:167], 0
  ds_read_b128 a[196:199], v2 offset:6144
  buffer_load_dwordx2 v[16:17], v15, s[4:7], s41 offen sc1
  v_mfma_f32_32x32x16_bf16 v[160:175], a[0:3], a[168:171], 0
  ds_read_b128 a[200:203], v2 offset:10240
  s_add_u32 s43, s41, 16384
  buffer_load_dwordx2 v[18:19], v15, s[4:7], s43 offen sc1
  v_mfma_f32_32x32x16_bf16 v[176:191], a[0:3], a[172:175], 0
  ds_read_b128 a[204:207], v2 offset:14336
  s_waitcnt lgkmcnt(4)
  s_waitcnt vmcnt(9)
  v_mfma_f32_32x32x16_bf16 v[128:143], a[4:7], a[176:179], v[128:143]
  ds_read_b128 a[160:163], v2 offset:3072
  buffer_load_dwordx4 a[36:39], v1, s[4:7], s42 offen offset:1024 sc1
  v_mfma_f32_32x32x16_bf16 v[144:159], a[4:7], a[180:183], v[144:159]
  ds_read_b128 a[164:167], v2 offset:7168
  s_add_u32 s43, s41, 32768
  buffer_load_dwordx2 v[20:21], v15, s[4:7], s43 offen sc1
  v_mfma_f32_32x32x16_bf16 v[160:175], a[4:7], a[184:187], v[160:175]
  ds_read_b128 a[168:171], v2 offset:11264
  s_add_u32 s43, s41, 49152
  buffer_load_dwordx2 v[22:23], v15, s[4:7], s43 offen sc1
  v_mfma_f32_32x32x16_bf16 v[176:191], a[4:7], a[188:191], v[176:191]
  ds_read_b128 a[172:175], v2 offset:15360
  s_add_u32 m0, s26, 0
  s_add_u32 s32, s22, 20480
  buffer_load_dwordx4 v1, s[4:7], s32 offen offset:0 lds
  s_waitcnt lgkmcnt(4)
  s_waitcnt vmcnt(12)
  v_mfma_f32_32x32x16_bf16 v[128:143], a[8:11], a[192:195], v[128:143]
  ds_read_b128 a[176:179], v2 offset:16384
  buffer_load_dwordx4 a[40:43], v1, s[4:7], s42 offen offset:2048 sc1
  v_mfma_f32_32x32x16_bf16 v[144:159], a[8:11], a[196:199], v[144:159]
  ds_read_b128 a[180:183], v2 offset:20480
  buffer_load_dwordx4 v1, s[4:7], s32 offen offset:1024 lds
  v_mfma_f32_32x32x16_bf16 v[160:175], a[8:11], a[200:203], v[160:175]
  ds_read_b128 a[184:187], v2 offset:24576
  v_mfma_f32_32x32x16_bf16 v[176:191], a[8:11], a[204:207], v[176:191]
  ds_read_b128 a[188:191], v2 offset:28672
  s_waitcnt lgkmcnt(4)
  s_waitcnt vmcnt(13)
  v_mfma_f32_32x32x16_bf16 v[128:143], a[12:15], a[160:163], v[128:143]
  ds_read_b128 a[192:195], v2 offset:17408
  buffer_load_dwordx4 a[44:47], v1, s[4:7], s42 offen offset:3072 sc1
  v_mfma_f32_32x32x16_bf16 v[144:159], a[12:15], a[164:167], v[144:159]
  ds_read_b128 a[196:199], v2 offset:21504
  buffer_load_dwordx4 v1, s[4:7], s32 offen offset:2048 lds
  v_mfma_f32_32x32x16_bf16 v[160:175], a[12:15], a[168:171], v[160:175]
  ds_read_b128 a[200:203], v2 offset:25600
  v_mfma_f32_32x32x16_bf16 v[176:191], a[12:15], a[172:175], v[176:191]
  ds_read_b128 a[204:207], v2 offset:29696
  s_waitcnt lgkmcnt(4)
  s_waitcnt vmcnt(14)
  v_mfma_f32_32x32x16_bf16 v[128:143], a[16:19], a[176:179], v[128:143]
  ds_read_b128 a[160:163], v2 offset:18432
  s_add_u32 s42, s40, 12288
  buffer_load_dwordx4 a[48:51], v1, s[4:7], s42 offen sc1
  v_mfma_f32_32x32x16_bf16 v[144:159], a[16:19], a[180:183], v[144:159]
  ds_read_b128 a[164:167], v2 offset:22528
  buffer_load_dwordx4 v1, s[4:7], s32 offen offset:3072 lds
  v_mfma_f32_32x32x16_bf16 v[160:175], a[16:19], a[184:187], v[160:175]
  ds_read_b128 a[168:171], v2 offset:26624
  v_mfma_f32_32x32x16_bf16 v[176:191], a[16:19], a[188:191], v[176:191]
  ds_read_b128 a[172:175], v2 offset:30720
  s_waitcnt lgkmcnt(4)
  s_waitcnt vmcnt(15)
  v_mfma_f32_32x32x16_bf16 v[128:143], a[20:23], a[192:195], v[128:143]
  ds_read_b128 a[176:179], v2 offset:19456
  buffer_load_dwordx4 a[52:55], v1, s[4:7], s42 offen offset:1024 sc1
  v_mfma_f32_32x32x16_bf16 v[144:159], a[20:23], a[196:199], v[144:159]
  ds_read_b128 a[180:183], v2 offset:23552
  s_add_u32 m0, s26, 16384
  s_add_u32 s32, s70, 24576
  buffer_load_dwordx4 v1, s[4:7], s32 offen offset:0 lds
  v_mfma_f32_32x32x16_bf16 v[160:175], a[20:23], a[200:203], v[160:175]
  ds_read_b128 a[184:187], v2 offset:27648
  v_mfma_f32_32x32x16_bf16 v[176:191], a[20:23], a[204:207], v[176:191]
  ds_read_b128 a[188:191], v2 offset:31744
  s_waitcnt lgkmcnt(4)
  s_waitcnt vmcnt(16)
  v_mfma_f32_32x32x16_bf16 v[128:143], a[24:27], a[160:163], v[128:143]
  ds_read_b128 a[192:195], v2 offset:32768
  buffer_load_dwordx4 a[56:59], v1, s[4:7], s42 offen offset:2048 sc1
  v_mfma_f32_32x32x16_bf16 v[144:159], a[24:27], a[164:167], v[144:159]
  ds_read_b128 a[196:199], v2 offset:36864
  buffer_load_dwordx4 v1, s[4:7], s32 offen offset:1024 lds
  v_mfma_f32_32x32x16_bf16 v[160:175], a[24:27], a[168:171], v[160:175]
  ds_read_b128 a[200:203], v2 offset:40960
  v_mfma_f32_32x32x16_bf16 v[176:191], a[24:27], a[172:175], v[176:191]
  ds_read_b128 a[204:207], v2 offset:45056
  s_waitcnt lgkmcnt(4)
  s_waitcnt vmcnt(17)
  v_mfma_f32_32x32x16_bf16 v[128:143], a[28:31], a[176:179], v[128:143]
  ds_read_b128 a[160:163], v2 offset:33792
  buffer_load_dwordx4 a[60:63], v1, s[4:7], s42 offen offset:3072 sc1
  v_mfma_f32_32x32x16_bf16 v[144:159], a[28:31], a[180:183], v[144:159]
  ds_read_b128 a[164:167], v2 offset:37888
  buffer_load_dwordx4 v1, s[4:7], s32 offen offset:2048 lds
  v_mfma_f32_32x32x16_bf16 v[160:175], a[28:31], a[184:187], v[160:175]
  ds_read_b128 a[168:171], v2 offset:41984
  v_mfma_f32_32x32x16_bf16 v[176:191], a[28:31], a[188:191], v[176:191]
  ds_read_b128 a[172:175], v2 offset:46080
  s_waitcnt lgkmcnt(4)
  s_waitcnt vmcnt(18)
  v_mfma_f32_32x32x16_bf16 v[128:143], a[32:35], a[192:195], v[128:143]
  ds_read_b128 a[176:179], v2 offset:34816
  s_add_u32 s42, s40, 16384
  buffer_load_dwordx4 a[64:67], v1, s[4:7], s42 offen sc1
  s_waitcnt vmcnt(17)
  v_add_f32 v16, v16, v18
  v_add_f32 v17, v17, v19
  s_waitcnt vmcnt(14)
  v_add_f32 v20, v20, v22
  v_mfma_f32_32x32x16_bf16 v[144:159], a[32:35], a[196:199], v[144:159]
  ds_read_b128 a[180:183], v2 offset:38912
  buffer_load_dwordx4 v1, s[4:7], s32 offen offset:3072 lds
  v_mfma_f32_32x32x16_bf16 v[160:175], a[32:35], a[200:203], v[160:175]
  ds_read_b128 a[184:187], v2 offset:43008
  v_mfma_f32_32x32x16_bf16 v[176:191], a[32:35], a[204:207], v[176:191]
  ds_read_b128 a[188:191], v2 offset:47104
  s_waitcnt lgkmcnt(4)
  v_mfma_f32_32x32x16_bf16 v[128:143], a[36:39], a[160:163], v[128:143]
  ds_read_b128 a[192:195], v2 offset:35840
  buffer_load_dwordx4 a[68:71], v1, s[4:7], s42 offen offset:1024 sc1
  v_add_f32 v21, v21, v23
  v_add_f32 v16, v16, v20
  v_add_f32 v17, v17, v21
  v_mfma_f32_32x32x16_bf16 v[144:159], a[36:39], a[164:167], v[144:159]
  ds_read_b128 a[196:199], v2 offset:39936
  s_add_u32 m0, s26, 32768
  s_add_u32 s32, s70, 32768
  buffer_load_dwordx4 v1, s[4:7], s32 offen offset:0 lds
  v_mfma_f32_32x32x16_bf16 v[160:175], a[36:39], a[168:171], v[160:175]
  ds_read_b128 a[200:203], v2 offset:44032
  v_mfma_f32_32x32x16_bf16 v[176:191], a[36:39], a[172:175], v[176:191]
  ds_read_b128 a[204:207], v2 offset:48128
  s_waitcnt lgkmcnt(4)
  s_waitcnt vmcnt(15)
  v_mfma_f32_32x32x16_bf16 v[128:143], a[40:43], a[176:179], v[128:143]
  ds_read_b128 a[160:163], v2 offset:49152
  buffer_load_dwordx4 a[72:75], v1, s[4:7], s42 offen offset:2048 sc1
  v_mov_b32 v18, v16
  v_mov_b32 v19, v17
  s_nop 0
  v_permlane32_swap_b32 v16, v18
  v_mfma_f32_32x32x16_bf16 v[144:159], a[40:43], a[180:183], v[144:159]
  ds_read_b128 a[164:167], v2 offset:53248
  buffer_load_dwordx4 v1, s[4:7], s32 offen offset:1024 lds
  v_mfma_f32_32x32x16_bf16 v[160:175], a[40:43], a[184:187], v[160:175]
  ds_read_b128 a[168:171], v2 offset:57344
  v_mfma_f32_32x32x16_bf16 v[176:191], a[40:43], a[188:191], v[176:191]
  ds_read_b128 a[172:175], v2 offset:61440
  s_waitcnt lgkmcnt(4)
  s_waitcnt vmcnt(15)
  v_mfma_f32_32x32x16_bf16 v[128:143], a[44:47], a[192:195], v[128:143]
  ds_read_b128 a[176:179], v2 offset:50176
  buffer_load_dwordx4 a[76:79], v1, s[4:7], s42 offen offset:3072 sc1
  v_permlane32_swap_b32 v17, v19
  v_add_f32 v16, v16, v18
  v_add_f32 v17, v17, v19
  v_mfma_f32_32x32x16_bf16 v[144:159], a[44:47], a[196:199], v[144:159]
  ds_read_b128 a[180:183], v2 offset:54272
  v_mfma_f32_32x32x16_bf16 v[160:175], a[44:47], a[200:203], v[160:175]
  ds_read_b128 a[184:187], v2 offset:58368
  v_mfma_f32_32x32x16_bf16 v[176:191], a[44:47], a[204:207], v[176:191]
  ds_read_b128 a[188:191], v2 offset:62464
  s_waitcnt lgkmcnt(4)
  s_waitcnt vmcnt(14)
  v_mfma_f32_32x32x16_bf16 v[128:143], a[48:51], a[160:163], v[128:143]
  ds_read_b128 a[192:195], v2 offset:51200
  s_add_u32 s42, s40, 20480
  buffer_load_dwordx4 a[80:83], v1, s[4:7], s42 offen sc1
  v_mul_f32 v16, 0xbacccccd, v16
  v_mul_f32 v17, 0x3acccccd, v17
  v_fma_f32 v17, -v16, v16, v17
  v_mfma_f32_32x32x16_bf16 v[144:159], a[48:51], a[164:167], v[144:159]
  ds_read_b128 a[196:199], v2 offset:55296
  buffer_load_dwordx4 v1, s[4:7], s32 offen offset:2048 lds
  v_mfma_f32_32x32x16_bf16 v[160:175], a[48:51], a[168:171], v[160:175]
  ds_read_b128 a[200:203], v2 offset:59392
  v_mfma_f32_32x32x16_bf16 v[176:191], a[48:51], a[172:175], v[176:191]
  ds_read_b128 a[204:207], v2 offset:63488
  s_waitcnt lgkmcnt(4)
  s_waitcnt vmcnt(14)
  v_mfma_f32_32x32x16_bf16 v[128:143], a[52:55], a[176:179], v[128:143]
  ds_read_b128 a[160:163], v2 offset:52224
  buffer_load_dwordx4 a[84:87], v1, s[4:7], s42 offen offset:1024 sc1
  v_max_f32 v17, 0, v17
  v_add_f32 v17, 0x3727c5ac, v17
  v_rsq_f32 v24, v17
  v_mfma_f32_32x32x16_bf16 v[144:159], a[52:55], a[180:183], v[144:159]
  ds_read_b128 a[164:167], v2 offset:56320
  buffer_load_dwordx4 v1, s[4:7], s32 offen offset:3072 lds
  v_mfma_f32_32x32x16_bf16 v[160:175], a[52:55], a[184:187], v[160:175]
  ds_read_b128 a[168:171], v2 offset:60416
  v_mfma_f32_32x32x16_bf16 v[176:191], a[52:55], a[188:191], v[176:191]
  ds_read_b128 a[172:175], v2 offset:64512
  s_waitcnt lgkmcnt(4)
  s_waitcnt vmcnt(14)
  v_mfma_f32_32x32x16_bf16 v[128:143], a[56:59], a[192:195], v[128:143]
  ds_read_b128 a[176:179], v3
  buffer_load_dwordx4 a[88:91], v1, s[4:7], s42 offen offset:2048 sc1
  v_cvt_pk_bf16_f32 v26, v16, v16
  v_and_b32 v18, 0xffff0000, v26
  v_sub_f32 v18, v16, v18
  v_mfma_f32_32x32x16_bf16 v[144:159], a[56:59], a[196:199], v[144:159]
  ds_read_b128 a[180:183], v3 offset:4096
  s_add_u32 m0, s26, 49152
  s_add_u32 s32, s70, 106496
  buffer_load_dwordx4 v1, s[4:7], s32 offen offset:0 lds
  v_mfma_f32_32x32x16_bf16 v[160:175], a[56:59], a[200:203], v[160:175]
  ds_read_b128 a[184:187], v3 offset:8192
  v_mfma_f32_32x32x16_bf16 v[176:191], a[56:59], a[204:207], v[176:191]
  ds_read_b128 a[188:191], v3 offset:12288
  s_waitcnt lgkmcnt(4)
  s_waitcnt vmcnt(14)
  v_mfma_f32_32x32x16_bf16 v[128:143], a[60:63], a[160:163], v[128:143]
  ds_read_b128 a[192:195], v3 offset:1024
  buffer_load_dwordx4 a[92:95], v1, s[4:7], s42 offen offset:3072 sc1
  v_cvt_pk_bf16_f32 v27, v18, 0
  v_mfma_f32_32x32x16_bf16 v[144:159], a[60:63], a[164:167], v[144:159]
  ds_read_b128 a[196:199], v3 offset:5120
  buffer_load_dwordx4 v1, s[4:7], s32 offen offset:1024 lds
  v_mfma_f32_32x32x16_bf16 v[160:175], a[60:63], a[168:171], v[160:175]
  ds_read_b128 a[200:203], v3 offset:9216
  v_mfma_f32_32x32x16_bf16 v[176:191], a[60:63], a[172:175], v[176:191]
  ds_read_b128 a[204:207], v3 offset:13312
  s_waitcnt lgkmcnt(4)
  s_waitcnt vmcnt(14)
  v_mfma_f32_32x32x16_bf16 v[128:143], a[64:67], a[176:179], v[128:143]
  ds_read_b128 a[160:163], v3 offset:2048
  s_add_u32 s42, s40, 24576
  buffer_load_dwordx4 a[96:99], v1, s[4:7], s42 offen sc1
  v_mfma_f32_32x32x16_bf16 v[144:159], a[64:67], a[180:183], v[144:159]
  ds_read_b128 a[164:167], v3 offset:6144
  buffer_load_dwordx4 a[100:103], v1, s[4:7], s42 offen offset:1024 sc1
  v_mfma_f32_32x32x16_bf16 v[160:175], a[64:67], a[184:187], v[160:175]
  ds_read_b128 a[168:171], v3 offset:10240
  buffer_load_dwordx4 v1, s[4:7], s32 offen offset:2048 lds
  v_mfma_f32_32x32x16_bf16 v[176:191], a[64:67], a[188:191], v[176:191]
  ds_read_b128 a[172:175], v3 offset:14336
  s_waitcnt lgkmcnt(4)
  s_waitcnt vmcnt(15)
  v_mfma_f32_32x32x16_bf16 v[128:143], a[68:71], a[192:195], v[128:143]
  ds_read_b128 a[176:179], v3 offset:3072
  buffer_load_dwordx4 a[104:107], v1, s[4:7], s42 offen offset:2048 sc1
  v_mfma_f32_32x32x16_bf16 v[144:159], a[68:71], a[196:199], v[144:159]
  ds_read_b128 a[180:183], v3 offset:7168
  buffer_load_dwordx4 a[108:111], v1, s[4:7], s42 offen offset:3072 sc1
  v_mfma_f32_32x32x16_bf16 v[160:175], a[68:71], a[200:203], v[160:175]
  ds_read_b128 a[184:187], v3 offset:11264
  buffer_load_dwordx4 v1, s[4:7], s32 offen offset:3072 lds
  v_mfma_f32_32x32x16_bf16 v[176:191], a[68:71], a[204:207], v[176:191]
  ds_read_b128 a[188:191], v3 offset:15360
  s_waitcnt lgkmcnt(4)
  s_waitcnt vmcnt(16)
  v_mfma_f32_32x32x16_bf16 v[128:143], a[72:75], a[160:163], v[128:143]
  s_barrier
  ds_read_b128 a[192:195], v1
  s_add_u32 s42, s40, 28672
  buffer_load_dwordx4 a[112:115], v1, s[4:7], s42 offen sc1
  v_mfma_f32_32x32x16_bf16 v[144:159], a[72:75], a[164:167], v[144:159]
  ds_read_b128 a[196:199], v1 offset:4096
  buffer_load_dwordx4 a[116:119], v1, s[4:7], s42 offen offset:1024 sc1
  v_mfma_f32_32x32x16_bf16 v[160:175], a[72:75], a[168:171], v[160:175]
  ds_read_b128 a[200:203], v1 offset:8192
  v_mfma_f32_32x32x16_bf16 v[176:191], a[72:75], a[172:175], v[176:191]
  ds_read_b128 a[204:207], v1 offset:12288
  s_waitcnt lgkmcnt(4)
  s_waitcnt vmcnt(16)
  v_mfma_f32_32x32x16_bf16 v[128:143], a[76:79], a[176:179], v[128:143]
  ds_read_b128 a[160:163], v1 offset:1024
  buffer_load_dwordx4 a[120:123], v1, s[4:7], s42 offen offset:2048 sc1
  v_mfma_f32_32x32x16_bf16 v[144:159], a[76:79], a[180:183], v[144:159]
  ds_read_b128 a[164:167], v1 offset:5120
  buffer_load_dwordx4 a[124:127], v1, s[4:7], s42 offen offset:3072 sc1
  v_mfma_f32_32x32x16_bf16 v[160:175], a[76:79], a[184:187], v[160:175]
  ds_read_b128 a[168:171], v1 offset:9216
  v_mfma_f32_32x32x16_bf16 v[176:191], a[76:79], a[188:191], v[176:191]
  ds_read_b128 a[172:175], v1 offset:13312
  s_waitcnt lgkmcnt(4)
  s_waitcnt vmcnt(17)
  v_mfma_f32_32x32x16_bf16 v[128:143], a[80:83], a[192:195], v[128:143]
  ds_read_b128 a[176:179], v1 offset:2048
  s_add_u32 s42, s40, 32768
  buffer_load_dwordx4 a[128:131], v1, s[4:7], s42 offen sc1
  v_mfma_f32_32x32x16_bf16 v[144:159], a[80:83], a[196:199], v[144:159]
  ds_read_b128 a[180:183], v1 offset:6144
  buffer_load_dwordx4 a[132:135], v1, s[4:7], s42 offen offset:1024 sc1
  v_mfma_f32_32x32x16_bf16 v[160:175], a[80:83], a[200:203], v[160:175]
  ds_read_b128 a[184:187], v1 offset:10240
  v_mfma_f32_32x32x16_bf16 v[176:191], a[80:83], a[204:207], v[176:191]
  ds_read_b128 a[188:191], v1 offset:14336
  s_waitcnt lgkmcnt(4)
  s_waitcnt vmcnt(17)
  v_mfma_f32_32x32x16_bf16 v[128:143], a[84:87], a[160:163], v[128:143]
  ds_read_b128 a[192:195], v1 offset:3072
  buffer_load_dwordx4 a[136:139], v1, s[4:7], s42 offen offset:2048 sc1
  v_mfma_f32_32x32x16_bf16 v[144:159], a[84:87], a[164:167], v[144:159]
  ds_read_b128 a[196:199], v1 offset:7168
  buffer_load_dwordx4 a[140:143], v1, s[4:7], s42 offen offset:3072 sc1
  v_mfma_f32_32x32x16_bf16 v[160:175], a[84:87], a[168:171], v[160:175]
  ds_read_b128 a[200:203], v1 offset:11264
  v_mfma_f32_32x32x16_bf16 v[176:191], a[84:87], a[172:175], v[176:191]
  ds_read_b128 a[204:207], v1 offset:15360
  s_waitcnt lgkmcnt(4)
  s_waitcnt vmcnt(17)
  v_mfma_f32_32x32x16_bf16 v[128:143], a[88:91], a[176:179], v[128:143]
  s_barrier
  ds_read_b128 a[160:163], v1 offset:16384
  s_add_u32 s42, s40, 36864
  buffer_load_dwordx4 a[144:147], v1, s[4:7], s42 offen sc1
  v_mfma_f32_32x32x16_bf16 v[144:159], a[88:91], a[180:183], v[144:159]
  ds_read_b128 a[164:167], v1 offset:20480
  buffer_load_dwordx4 a[148:151], v1, s[4:7], s42 offen offset:1024 sc1
  v_mfma_f32_32x32x16_bf16 v[160:175], a[88:91], a[184:187], v[160:175]
  ds_read_b128 a[168:171], v1 offset:17408
  v_mfma_f32_32x32x16_bf16 v[176:191], a[88:91], a[188:191], v[176:191]
  ds_read_b128 a[172:175], v1 offset:21504
  s_waitcnt lgkmcnt(4)
  s_waitcnt vmcnt(17)
  v_mfma_f32_32x32x16_bf16 v[128:143], a[92:95], a[192:195], v[128:143]
  ds_read_b128 a[176:179], v1 offset:18432
  buffer_load_dwordx4 a[152:155], v1, s[4:7], s42 offen offset:2048 sc1
  v_mfma_f32_32x32x16_bf16 v[144:159], a[92:95], a[196:199], v[144:159]
  ds_read_b128 a[180:183], v1 offset:22528
  buffer_load_dwordx4 a[156:159], v1, s[4:7], s42 offen offset:3072 sc1
  v_mfma_f32_32x32x16_bf16 v[160:175], a[92:95], a[200:203], v[160:175]
  ds_read_b128 a[184:187], v1 offset:19456
  v_mfma_f32_32x32x16_bf16 v[176:191], a[92:95], a[204:207], v[176:191]
  ds_read_b128 a[188:191], v1 offset:23552
  s_waitcnt lgkmcnt(4)
  s_waitcnt vmcnt(17)
  v_mfma_f32_32x32x16_bf16 v[128:143], a[96:99], a[160:163], v[128:143]
  ds_read_b128 a[192:195], v1 offset:24576
  s_add_u32 m0, s26, 65536
  s_add_u32 s32, s70, 114688
  buffer_load_dwordx4 v1, s[4:7], s32 offen offset:0 lds
  v_mfma_f32_32x32x16_bf16 v[144:159], a[96:99], a[164:167], v[144:159]
  ds_read_b128 a[196:199], v1 offset:28672
  s_lshl_b32 s46, s18, 8
  s_add_u32 s46, s46, 153600
  v_lshl_add_u32 v12, v0, 2, s46
  ds_write_b32 v12, v24
  v_lshl_add_u32 v12, v5, 4, s46
  s_waitcnt vmcnt(17)
  v_mfma_f32_32x32x16_bf16 v[128:143], a[100:103], a[168:171], v[128:143]
  ds_read_b128 a[200:203], v1 offset:25600
  v_mfma_f32_32x32x16_bf16 v[144:159], a[100:103], a[172:175], v[144:159]
  ds_read_b128 a[204:207], v1 offset:29696
  s_waitcnt lgkmcnt(5)
  s_waitcnt vmcnt(15)
  v_mfma_f32_32x32x16_bf16 v[128:143], a[104:107], a[176:179], v[128:143]
  ds_read_b128 a[160:163], v1 offset:26624
  buffer_load_dwordx4 v1, s[4:7], s32 offen offset:1024 lds
  ds_read_b128 v[36:39], v12
  v_mfma_f32_32x32x16_bf16 v[144:159], a[104:107], a[180:183], v[144:159]
  ds_read_b128 a[164:167], v1 offset:30720
  ds_read_b128 v[40:43], v12 offset:32
  s_waitcnt vmcnt(15)
  v_mfma_f32_32x32x16_bf16 v[128:143], a[108:111], a[184:187], v[128:143]
  ds_read_b128 a[168:171], v1 offset:27648
  ds_read_b128 v[44:47], v12 offset:64
  v_mfma_f32_32x32x16_bf16 v[144:159], a[108:111], a[188:191], v[144:159]
  ds_read_b128 a[172:175], v1 offset:31744
  ds_read_b128 v[48:51], v12 offset:96
  s_waitcnt lgkmcnt(8)
  s_waitcnt vmcnt(13)
  v_mfma_f32_32x32x16_bf16 v[128:143], a[112:115], a[192:195], v[128:143]
  ds_read_b128 a[176:179], v1 offset:32768
  buffer_load_dwordx4 v1, s[4:7], s32 offen offset:2048 lds
  s_sub_u32 s49, s29, 10
  s_lshl_b32 s48, s49, 11
  s_add_u32 s48, s48, s45
  s_add_u32 s48, s48, s19
  s_add_u32 s48, s48, 5242880
  v_mul_u32_u24 v68, 10240, v5
  v_lshl_add_u32 v68, v4, 4, v68
  v_add_u32 v69, 20480, v68
  v_mfma_f32_32x32x16_bf16 v[144:159], a[112:115], a[196:199], v[144:159]
  ds_read_b128 a[180:183], v1 offset:36864
  s_waitcnt vmcnt(13)
  v_mfma_f32_32x32x16_bf16 v[128:143], a[116:119], a[200:203], v[128:143]
  ds_read_b128 a[184:187], v1 offset:33792
  v_mfma_f32_32x32x16_bf16 v[144:159], a[116:119], a[204:207], v[144:159]
  ds_read_b128 a[188:191], v1 offset:37888
  s_waitcnt lgkmcnt(5)
  s_waitcnt vmcnt(12)
  v_mfma_f32_32x32x16_bf16 v[128:143], a[120:123], a[160:163], v[128:143]
  ds_read_b128 a[192:195], v1 offset:34816
  buffer_load_dwordx4 v1, s[4:7], s32 offen offset:3072 lds
  v_mfma_f32_32x32x16_bf16 v[144:159], a[120:123], a[164:167], v[144:159]
  ds_read_b128 a[196:199], v1 offset:38912
  s_waitcnt vmcnt(12)
  v_mfma_f32_32x32x16_bf16 v[128:143], a[124:127], a[168:171], v[128:143]
  ds_read_b128 a[200:203], v1 offset:35840
  v_mfma_f32_32x32x16_bf16 v[144:159], a[124:127], a[172:175], v[144:159]
  ds_read_b128 a[204:207], v1 offset:39936
  s_waitcnt lgkmcnt(4)
  s_waitcnt vmcnt(11)
  v_mfma_f32_32x32x16_bf16 v[128:143], a[128:131], a[176:179], v[128:143]
  ds_read_b128 a[160:163], v1 offset:40960
  v_mfma_f32_32x32x16_bf16 v[144:159], a[128:131], a[180:183], v[144:159]
  ds_read_b128 a[164:167], v1 offset:45056
  s_waitcnt vmcnt(10)
  v_mfma_f32_32x32x16_bf16 v[128:143], a[132:135], a[184:187], v[128:143]
  ds_read_b128 a[168:171], v1 offset:41984
  v_mfma_f32_32x32x16_bf16 v[144:159], a[132:135], a[188:191], v[144:159]
  ds_read_b128 a[172:175], v1 offset:46080
  s_waitcnt lgkmcnt(4)
  s_waitcnt vmcnt(9)
  v_mfma_f32_32x32x16_bf16 v[128:143], a[136:139], a[192:195], v[128:143]
  ds_read_b128 a[176:179], v1 offset:43008
  v_mfma_f32_32x32x16_bf16 v[144:159], a[136:139], a[196:199], v[144:159]
  ds_read_b128 a[180:183], v1 offset:47104
  s_waitcnt vmcnt(8)
  v_mfma_f32_32x32x16_bf16 v[128:143], a[140:143], a[200:203], v[128:143]
  ds_read_b128 a[184:187], v1 offset:44032
  v_mfma_f32_32x32x16_bf16 v[144:159], a[140:143], a[204:207], v[144:159]
  ds_read_b128 a[188:191], v1 offset:48128
  s_waitcnt lgkmcnt(4)
  s_waitcnt vmcnt(7)
  v_mfma_f32_32x32x16_bf16 v[128:143], a[144:147], a[160:163], v[128:143]
  s_waitcnt vmcnt(0)
  s_barrier
  ds_read_b128 a[192:195], v1 offset:49152
  v_mfma_f32_32x32x16_bf16 v[144:159], a[144:147], a[164:167], v[144:159]
  ds_read_b128 a[196:199], v1 offset:53248
  v_mfma_f32_32x32x16_bf16 v[128:143], a[148:151], a[168:171], v[128:143]
  ds_read_b128 a[200:203], v1 offset:50176
  v_mfma_f32_32x32x16_bf16 v[144:159], a[148:151], a[172:175], v[144:159]
  ds_read_b128 a[204:207], v1 offset:54272
  s_waitcnt lgkmcnt(4)
  v_mfma_f32_32x32x16_bf16 v[128:143], a[152:155], a[176:179], v[128:143]
  ds_read_b128 a[160:163], v1 offset:51200
  v_mfma_f32_32x32x16_bf16 v[144:159], a[152:155], a[180:183], v[144:159]
  ds_read_b128 a[164:167], v1 offset:55296
  v_mfma_f32_32x32x16_bf16 v[128:143], a[156:159], a[184:187], v[128:143]
  ds_read_b128 a[168:171], v1 offset:52224
  v_mfma_f32_32x32x8_bf16 v[128:143], v[26:27], v[28:29], v[128:143]
  v_mfma_f32_32x32x16_bf16 v[144:159], a[156:159], a[188:191], v[144:159]
  ds_read_b128 a[172:175], v1 offset:56320
  v_mfma_f32_32x32x8_bf16 v[144:159], v[26:27], v[30:31], v[144:159]
  s_waitcnt lgkmcnt(4)
  v_mfma_f32_32x32x16_bf16 v[160:175], a[96:99], a[192:195], v[160:175]
  ds_read_b128 a[176:179], v1 offset:57344
  v_mfma_f32_32x32x16_bf16 v[176:191], a[96:99], a[196:199], v[176:191]
  ds_read_b128 a[180:183], v1 offset:61440
  v_mfma_f32_32x32x16_bf16 v[160:175], a[100:103], a[200:203], v[160:175]
  ds_read_b128 a[184:187], v1 offset:58368
  v_mfma_f32_32x32x16_bf16 v[176:191], a[100:103], a[204:207], v[176:191]
  ds_read_b128 a[188:191], v1 offset:62464
  s_waitcnt lgkmcnt(4)
  v_mfma_f32_32x32x16_bf16 v[160:175], a[104:107], a[160:163], v[160:175]
  ds_read_b128 a[192:195], v1 offset:59392
  v_mul_f32 v128, v36, v128
  v_mul_f32 v129, v37, v129
  v_mul_f32 v130, v38, v130
  v_mul_f32 v131, v39, v131
  v_mul_f32 v132, v40, v132
  v_mfma_f32_32x32x16_bf16 v[176:191], a[104:107], a[164:167], v[176:191]
  ds_read_b128 a[196:199], v1 offset:63488
  v_mul_f32 v133, v41, v133
  v_mul_f32 v134, v42, v134
  v_mul_f32 v135, v43, v135
  v_cvt_pk_bf16_f32 v52, v128, v129
  v_cvt_pk_bf16_f32 v53, v130, v131
  v_mfma_f32_32x32x16_bf16 v[160:175], a[108:111], a[168:171], v[160:175]
  ds_read_b128 a[200:203], v1 offset:60416
  v_cvt_pk_bf16_f32 v54, v132, v133
  v_cvt_pk_bf16_f32 v55, v134, v135
  v_mfma_f32_32x32x16_bf16 v[176:191], a[108:111], a[172:175], v[176:191]
  ds_read_b128 a[204:207], v1 offset:64512
  buffer_store_dwordx4 v[52:55], v68, s[4:7], s48 offen sc1
  v_mul_f32 v136, v44, v136
  v_mul_f32 v137, v45, v137
  v_mul_f32 v138, v46, v138
  s_waitcnt lgkmcnt(4)
  v_mfma_f32_32x32x16_bf16 v[160:175], a[112:115], a[176:179], v[160:175]
  ds_read_b128 a[160:163], v2
  v_mul_f32 v139, v47, v139
  v_mul_f32 v140, v48, v140
  v_mul_f32 v141, v49, v141
  v_mul_f32 v142, v50, v142
  v_mul_f32 v143, v51, v143
  v_mfma_f32_32x32x16_bf16 v[176:191], a[112:115], a[180:183], v[176:191]
  ds_read_b128 a[164:167], v2 offset:4096
  v_cvt_pk_bf16_f32 v56, v136, v137
  v_cvt_pk_bf16_f32 v57, v138, v139
  v_cvt_pk_bf16_f32 v58, v140, v141
  v_cvt_pk_bf16_f32 v59, v142, v143
  v_mfma_f32_32x32x16_bf16 v[160:175], a[116:119], a[184:187], v[160:175]
  ds_read_b128 a[168:171], v2 offset:1024
  buffer_store_dwordx4 v[56:59], v69, s[4:7], s48 offen sc1
  v_mul_f32 v144, v36, v144
  v_mul_f32 v145, v37, v145
  v_mul_f32 v146, v38, v146
  v_mul_f32 v147, v39, v147
  v_mfma_f32_32x32x16_bf16 v[176:191], a[116:119], a[188:191], v[176:191]
  ds_read_b128 a[172:175], v2 offset:5120
  v_mul_f32 v148, v40, v148
  v_mul_f32 v149, v41, v149
  v_mul_f32 v150, v42, v150
  v_mul_f32 v151, v43, v151
  s_waitcnt lgkmcnt(4)
  v_mfma_f32_32x32x16_bf16 v[160:175], a[120:123], a[192:195], v[160:175]
  ds_read_b128 a[176:179], v2 offset:2048
  v_cvt_pk_bf16_f32 v60, v144, v145
  v_cvt_pk_bf16_f32 v61, v146, v147
  v_cvt_pk_bf16_f32 v62, v148, v149
  v_cvt_pk_bf16_f32 v63, v150, v151
  v_mfma_f32_32x32x16_bf16 v[176:191], a[120:123], a[196:199], v[176:191]
  ds_read_b128 a[180:183], v2 offset:6144
  buffer_store_dwordx4 v[60:63], v68, s[4:7], s48 offen offset:512 sc1
  v_mul_f32 v152, v44, v152
  v_mul_f32 v153, v45, v153
  v_mul_f32 v154, v46, v154
  v_mul_f32 v155, v47, v155
  v_mfma_f32_32x32x16_bf16 v[160:175], a[124:127], a[200:203], v[160:175]
  ds_read_b128 a[184:187], v2 offset:3072
  v_mul_f32 v156, v48, v156
  v_mul_f32 v157, v49, v157
  v_mul_f32 v158, v50, v158
  v_mul_f32 v159, v51, v159
  v_cvt_pk_bf16_f32 v64, v152, v153
  v_mfma_f32_32x32x16_bf16 v[176:191], a[124:127], a[204:207], v[176:191]
  ds_read_b128 a[188:191], v2 offset:7168
  v_cvt_pk_bf16_f32 v65, v154, v155
  v_cvt_pk_bf16_f32 v66, v156, v157
  v_cvt_pk_bf16_f32 v67, v158, v159
  s_waitcnt lgkmcnt(4)
  v_mfma_f32_32x32x16_bf16 v[160:175], a[128:131], a[160:163], v[160:175]
  ds_read_b128 a[192:195], v2 offset:8192
  buffer_store_dwordx4 v[64:67], v69, s[4:7], s48 offen offset:512 sc1
  v_mfma_f32_32x32x16_bf16 v[176:191], a[128:131], a[164:167], v[176:191]
  ds_read_b128 a[196:199], v2 offset:12288
  v_mfma_f32_32x32x16_bf16 v[160:175], a[132:135], a[168:171], v[160:175]
  ds_read_b128 a[200:203], v2 offset:9216
  v_mfma_f32_32x32x16_bf16 v[176:191], a[132:135], a[172:175], v[176:191]
  ds_read_b128 a[204:207], v2 offset:13312
  s_waitcnt lgkmcnt(4)
  v_mfma_f32_32x32x16_bf16 v[160:175], a[136:139], a[176:179], v[160:175]
  ds_read_b128 a[160:163], v2 offset:10240
  v_mfma_f32_32x32x16_bf16 v[176:191], a[136:139], a[180:183], v[176:191]
  ds_read_b128 a[164:167], v2 offset:14336
  v_mfma_f32_32x32x16_bf16 v[160:175], a[140:143], a[184:187], v[160:175]
  ds_read_b128 a[168:171], v2 offset:11264
  v_mfma_f32_32x32x16_bf16 v[176:191], a[140:143], a[188:191], v[176:191]
  ds_read_b128 a[172:175], v2 offset:15360
  s_waitcnt lgkmcnt(4)
  v_mfma_f32_32x32x16_bf16 v[160:175], a[144:147], a[192:195], v[160:175]
  v_mfma_f32_32x32x16_bf16 v[176:191], a[144:147], a[196:199], v[176:191]
  v_mfma_f32_32x32x16_bf16 v[160:175], a[148:151], a[200:203], v[160:175]
  v_mfma_f32_32x32x16_bf16 v[176:191], a[148:151], a[204:207], v[176:191]
  s_waitcnt lgkmcnt(0)
  v_mfma_f32_32x32x16_bf16 v[160:175], a[152:155], a[160:163], v[160:175]
  v_mfma_f32_32x32x16_bf16 v[176:191], a[152:155], a[164:167], v[176:191]
  v_mfma_f32_32x32x16_bf16 v[160:175], a[156:159], a[168:171], v[160:175]
  v_mfma_f32_32x32x8_bf16 v[160:175], v[26:27], v[32:33], v[160:175]
  v_mfma_f32_32x32x16_bf16 v[176:191], a[156:159], a[172:175], v[176:191]
  v_mfma_f32_32x32x8_bf16 v[176:191], v[26:27], v[34:35], v[176:191]
  s_nop 9
  v_pk_mul_f32 v[160:161], v[160:161], v[36:37]
  v_pk_mul_f32 v[162:163], v[162:163], v[38:39]
  v_pk_mul_f32 v[164:165], v[164:165], v[40:41]
  v_pk_mul_f32 v[166:167], v[166:167], v[42:43]
  v_cvt_pk_bf16_f32 v52, v160, v161
  v_cvt_pk_bf16_f32 v53, v162, v163
  v_cvt_pk_bf16_f32 v54, v164, v165
  v_cvt_pk_bf16_f32 v55, v166, v167
  buffer_store_dwordx4 v[52:55], v68, s[4:7], s48 offen offset:1024 sc1
  v_pk_mul_f32 v[168:169], v[168:169], v[44:45]
  v_pk_mul_f32 v[170:171], v[170:171], v[46:47]
  v_pk_mul_f32 v[172:173], v[172:173], v[48:49]
  v_pk_mul_f32 v[174:175], v[174:175], v[50:51]
  v_cvt_pk_bf16_f32 v56, v168, v169
  v_cvt_pk_bf16_f32 v57, v170, v171
  v_cvt_pk_bf16_f32 v58, v172, v173
  v_cvt_pk_bf16_f32 v59, v174, v175
  buffer_store_dwordx4 v[56:59], v69, s[4:7], s48 offen offset:1024 sc1
  v_pk_mul_f32 v[176:177], v[176:177], v[36:37]
  v_pk_mul_f32 v[178:179], v[178:179], v[38:39]
  v_pk_mul_f32 v[180:181], v[180:181], v[40:41]
  v_pk_mul_f32 v[182:183], v[182:183], v[42:43]
  v_cvt_pk_bf16_f32 v60, v176, v177
  v_cvt_pk_bf16_f32 v61, v178, v179
  v_cvt_pk_bf16_f32 v62, v180, v181
  v_cvt_pk_bf16_f32 v63, v182, v183
  buffer_store_dwordx4 v[60:63], v68, s[4:7], s48 offen offset:1536 sc1
  v_pk_mul_f32 v[184:185], v[184:185], v[44:45]
  v_pk_mul_f32 v[186:187], v[186:187], v[46:47]
  v_pk_mul_f32 v[188:189], v[188:189], v[48:49]
  v_pk_mul_f32 v[190:191], v[190:191], v[50:51]
  v_cvt_pk_bf16_f32 v64, v184, v185
  v_cvt_pk_bf16_f32 v65, v186, v187
  v_cvt_pk_bf16_f32 v66, v188, v189
  v_cvt_pk_bf16_f32 v67, v190, v191
  buffer_store_dwordx4 v[64:67], v69, s[4:7], s48 offen offset:1536 sc1
  s_nop 1
  s_branch QKV_P_3
QKV_I_4:
  s_sub_u32 s36, s17, 30
  s_lshl_b32 s36, s36, 2
  s_add_u32 s36, s36, s18
  v_lshlrev_b32 v12, 7, v0
  s_mul_i32 s37, s36, 102400
  s_add_u32 s37, s37, 7245824
QKV_P_3:
  s_lshl_b32 s58, s20, 15
  s_lshl_b32 s59, s16, 12
  s_add_u32 s58, s58, s59
  s_add_u32 s58, s58, 16384
  s_lshl_b32 s59, s17, 7
  s_add_u32 s59, s59, s58
  v_mov_b32 v14, 1
  v_mov_b32 v15, 0
  s_waitcnt vmcnt(0) lgkmcnt(0)
  s_barrier
  s_cmp_lg_u32 s18, 1
  s_cbranch_scc1 QPUB_7
  s_mov_b64 exec, 1
  buffer_store_dword v14, v15, s[4:7], s59 offen sc1
  s_mov_b64 exec, -1
QPUB_7:
  s_cmp_lt_u32 s18, 2
  s_cbranch_scc1 QTB_8
  s_cmp_ge_u32 s17, 30
  s_cbranch_scc1 QTB_8
  s_mul_i32 s36, s29, 205
  s_lshr_b32 s36, s36, 10
  s_mul_i32 s37, s36, 5
  s_sub_u32 s37, s29, s37
  s_cmp_eq_u32 s36, 2
  s_cselect_b32 s38, 11, 13
  s_movk_i32 s39, 2048
  s_cselect_b32 s39, 10240, s39
  s_mul_i32 s36, s36, 2621440
  s_lshl_b32 s37, s37, s38
  s_add_u32 s36, s36, s37
  s_add_u32 s36, s36, s19
  s_add_u32 s36, s36, s45
  v_mul_u32_u24 v12, s39, v7
  v_lshl_add_u32 v12, v6, 7, v12
  buffer_load_dword v254, v12, s[4:7], s36 offen sc1
  s_sub_u32 s36, s36, 81920
  buffer_load_dword v254, v12, s[4:7], s36 offen sc1
QTB_8:
ATT_ENTRY:
  v_cmp_eq_u32 s[50:51], 20, v4
  v_cmp_eq_u32 vcc, 24, v4
  s_lshl_b32 s37, s18, 13
  s_or_b64 vcc, vcc, s[50:51]
  v_mov_b32 v26, 0x3f803f80
  v_cndmask_b32 v28, 0, v26, vcc
  v_add_u32 v27, s37, v1
  v_mov_b32 v29, v28
  v_mov_b32 v30, v28
  v_mov_b32 v31, v28
  ds_write_b128 v27, v[28:31] offset:24576
  ds_write_b128 v27, v[28:31] offset:25600
  ds_write_b128 v27, v[28:31] offset:26624
  ds_write_b128 v27, v[28:31] offset:27648
  ds_write_b128 v27, v[28:31] offset:28672
  ds_write_b128 v27, v[28:31] offset:29696
  ds_write_b128 v27, v[28:31] offset:30720
  ds_write_b128 v27, v[28:31] offset:31744
  s_lshl_b32 s36, s16, 3
  s_lshl_b32 s37, s18, 1
  s_add_u32 s36, s36, s37
  v_mov_b32 v16, 0x3f80
  v_mov_b32 v17, 0
  v_mov_b32 v18, 0x3f80
  v_mov_b32 v19, 0
  s_lshr_b32 s38, s17, 1
  s_mul_i32 s38, s38, 2560
  s_and_b32 s39, s17, 1
  s_mul_i32 s37, s39, 1536
  s_add_u32 s37, s37, s38
  v_add_u32 v32, s37, v1
  s_add_u32 s38, s38, 1024
  v_mul_u32_u24 v38, 40960, v5
  v_lshl_add_u32 v38, v4, 4, v38
  v_add_u32 v38, s38, v38
  v_add_u32 v38, 2621440, v38
  s_lshl_b32 s37, s39, 3
  s_add_u32 s38, s38, s37
  v_add_u32 v33, s38, v1
  v_and_b32 v26, 3, v4
  v_bfe_u32 v27, v4, 2, 1
  v_lshl_add_u32 v26, v27, 3, v26
  v_bfe_u32 v27, v4, 3, 1
  v_lshl_add_u32 v26, v27, 2, v26
  s_lshl_b32 s37, s39, 2
  v_add_u32 v26, s37, v26
  s_lshl_b32 s37, s39, 4
  v_subrev_u32 v27, s37, v4
  v_cmp_gt_u32 vcc, 16, v4
  s_nop 1
  v_cndmask_b32 v26, v27, v26, vcc
  s_mul_i32 s37, s17, 320
  s_add_u32 s37, s37, 5242880
  v_lshl_add_u32 v26, v26, 4, s37
  v_mul_u32_u24 v27, 10240, v5
  v_add_u32 v34, v26, v27
  v_add_u32 v35, 19456, v34
  v_add_u32 v37, 2621440, v32
  s_mov_b32 s54, 0x000fffff
  s_mov_b32 s55, 0x000fffff
  s_mov_b32 s56, -1
  s_mov_b32 s57, 0
  s_mul_i32 s40, s36, 40960
  s_add_u32 s41, s40, s19
  s_add_u32 s42, s41, 40960
  s_lshl_b32 s37, s16, 3
  s_lshl_b32 s38, s18, 2
  s_add_u32 s37, s37, s38
  s_sub_i32 s37, s37, 8
  s_max_i32 s37, s37, 0
  s_mul_i32 s86, s37, 40960
  s_add_u32 s86, s86, s19
  s_add_u32 s87, s86, 40960
  s_add_u32 s88, s86, 81920
  s_add_u32 s89, s86, 122880
  s_lshl_b32 s44, s18, 11
  s_lshl_b32 s45, s18, 13
  s_waitcnt lgkmcnt(0)
  s_cmp_eq_u32 s20, 0
  s_cbranch_scc1 ANP_11
  v_lshlrev_b32 v26, 2, v5
  v_sub_u32 v26, v4, v26
  v_mov_b32 v27, 0xf149f2ca
  v_cmp_gt_i32 s[50:51], 0, v26
  v_cmp_gt_i32 vcc, 1, v26
  s_nop 0
  v_cndmask_b32 v64, v27, 0, s[50:51]
  v_cndmask_b32 v80, 0, v27, s[50:51]
  v_cndmask_b32 v65, v27, 0, vcc
  v_cndmask_b32 v81, 0, v27, vcc
  v_cmp_gt_i32 s[50:51], 2, v26
  v_cmp_gt_i32 vcc, 3, v26
  s_nop 0
  v_cndmask_b32 v66, v27, 0, s[50:51]
  v_cndmask_b32 v82, 0, v27, s[50:51]
  v_cndmask_b32 v67, v27, 0, vcc
  v_cndmask_b32 v83, 0, v27, vcc
  v_cmp_gt_i32 s[50:51], 8, v26
  v_cmp_gt_i32 vcc, 9, v26
  s_nop 0
  v_cndmask_b32 v68, v27, 0, s[50:51]
  v_cndmask_b32 v84, 0, v27, s[50:51]
  v_cndmask_b32 v69, v27, 0, vcc
  v_cndmask_b32 v85, 0, v27, vcc
  v_cmp_gt_i32 s[50:51], 10, v26
  v_cmp_gt_i32 vcc, 11, v26
  s_nop 0
  v_cndmask_b32 v70, v27, 0, s[50:51]
  v_cndmask_b32 v86, 0, v27, s[50:51]
  v_cndmask_b32 v71, v27, 0, vcc
  v_cndmask_b32 v87, 0, v27, vcc
  v_cmp_gt_i32 s[50:51], 16, v26
  v_cmp_gt_i32 vcc, 17, v26
  s_nop 0
  v_cndmask_b32 v72, v27, 0, s[50:51]
  v_cndmask_b32 v88, 0, v27, s[50:51]
  v_cndmask_b32 v73, v27, 0, vcc
  v_cndmask_b32 v89, 0, v27, vcc
  v_cmp_gt_i32 s[50:51], 18, v26
  v_cmp_gt_i32 vcc, 19, v26
  s_nop 0
  v_cndmask_b32 v74, v27, 0, s[50:51]
  v_cndmask_b32 v90, 0, v27, s[50:51]
  v_cndmask_b32 v75, v27, 0, vcc
  v_cndmask_b32 v91, 0, v27, vcc
  v_cmp_gt_i32 s[50:51], 24, v26
  v_cmp_gt_i32 vcc, 25, v26
  s_nop 0
  v_cndmask_b32 v76, v27, 0, s[50:51]
  v_cndmask_b32 v92, 0, v27, s[50:51]
  v_cndmask_b32 v77, v27, 0, vcc
  v_cndmask_b32 v93, 0, v27, vcc
  v_cmp_gt_i32 s[50:51], 26, v26
  v_cmp_gt_i32 vcc, 27, v26
  s_nop 0
  v_cndmask_b32 v78, v27, 0, s[50:51]
  v_cndmask_b32 v94, 0, v27, s[50:51]
  v_cndmask_b32 v79, v27, 0, vcc
  v_cndmask_b32 v95, 0, v27, vcc
  v_mov_b32 v27, 0x3f80
  s_cmp_lt_i32 s36, 8
  s_mov_b32 s37, 0x3f800000
  s_cselect_b32 s37, 0x3f80f14a, s37
  v_accvgpr_write_b32 a40, s37
  v_accvgpr_write_b32 a41, v27
  s_cmp_lt_i32 s36, 7
  s_mov_b32 s37, 0x3f800000
  s_cselect_b32 s37, 0x3f80f14a, s37
  v_accvgpr_write_b32 a42, s37
  v_accvgpr_write_b32 a43, v27
  s_cmp_lt_i32 s36, 6
  s_mov_b32 s37, 0x3f800000
  s_cselect_b32 s37, 0x3f80f14a, s37
  v_accvgpr_write_b32 a44, s37
  v_accvgpr_write_b32 a45, v27
  s_cmp_lt_i32 s36, 5
  s_mov_b32 s37, 0x3f800000
  s_cselect_b32 s37, 0x3f80f14a, s37
  v_accvgpr_write_b32 a46, s37
  v_accvgpr_write_b32 a47, v27
  s_cmp_lt_i32 s36, 4
  s_mov_b32 s37, 0x3f800000
  s_cselect_b32 s37, 0x3f80f14a, s37
  v_accvgpr_write_b32 a48, s37
  v_accvgpr_write_b32 a49, v27
  s_cmp_lt_i32 s36, 3
  s_mov_b32 s37, 0x3f800000
  s_cselect_b32 s37, 0x3f80f14a, s37
  v_accvgpr_write_b32 a50, s37
  v_accvgpr_write_b32 a51, v27
  s_cmp_lt_i32 s36, 2
  s_mov_b32 s37, 0x3f800000
  s_cselect_b32 s37, 0x3f80f14a, s37
  v_accvgpr_write_b32 a52, s37
  v_accvgpr_write_b32 a53, v27
  s_cmp_lt_i32 s36, 1
  s_mov_b32 s37, 0x3f800000
  s_cselect_b32 s37, 0x3f80f14a, s37
  v_accvgpr_write_b32 a54, s37
  v_accvgpr_write_b32 a55, v27
  s_cmp_lt_i32 s36, 0
  s_mov_b32 s37, 0x3f800000
  s_cselect_b32 s37, 0x3f80f14a, s37
  v_accvgpr_write_b32 a56, s37
  v_accvgpr_write_b32 a57, v27
  s_cmp_lt_i32 s36, -1
  s_mov_b32 s37, 0x3f800000
  s_cselect_b32 s37, 0x3f80f14a, s37
  v_accvgpr_write_b32 a58, s37
  v_accvgpr_write_b32 a59, v27
  s_mov_b32 s46, s41
  v_cmp_gt_u32 s[52:53], 32, v0
  v_mov_b32 v39, 0
  s_lshl_b32 s91, s2, 2
  s_add_u32 s91, s91, s18
  s_mul_i32 s91, s91, 10240
  s_add_u32 s91, s91, 147456
  s_cmp_eq_u32 s20, 0
  s_cselect_b32 s37, 64, 0
  s_cselect_b32 s38, 16, 0
  v_lshlrev_b32 v26, 7, v0
  v_cmp_gt_u32 vcc, s37, v0
  s_nop 1
  v_cndmask_b32 v54, v8, v26, vcc
  v_add_u32 v26, 8192, v26
  v_cmp_gt_u32 vcc, s38, v0
  s_nop 1
  v_cndmask_b32 v55, v8, v26, vcc
  v_mul_u32_u24 v53, 107520, v5
  v_lshl_add_u32 v53, v4, 2, v53
  v_add_u32 v50, s44, v1
  s_lshl_b32 s37, s18, 10
  s_and_b32 s38, s17, 1
  s_lshl_b32 s38, s38, 3
  s_add_u32 s37, s37, s38
  v_add_u32 v51, s37, v1
  v_add_u32 v52, s26, v1
  v_cndmask_b32 v36, v8, v33, s[52:53]
  s_nop 2
  s_cmp_lg_u32 s18, 0
  s_cbranch_scc1 APOLLD_10
  v_mul_u32_u24 v13, 205, v4
  v_lshrrev_b32 v13, 10, v13
  v_mul_u32_u24 v13, 5, v13
  v_sub_u32 v13, v4, v13
  s_mul_i32 s90, s17, 20
  s_add_u32 s47, s90, 19
  s_lshr_b32 s90, s90, 7
  s_lshr_b32 s47, s47, 7
  v_cmp_eq_u32 s[48:49], s90, v13
  v_cmp_eq_u32 s[50:51], s47, v13
  s_nop 0
  s_or_b64 s[48:49], s[48:49], s[50:51]
  s_mov_b32 s48, 0x3fffffff
  s_and_b32 s49, s49, 1072725984
  s_cmp_eq_u32 s16, 0
  s_cselect_b32 s49, 0, s49
  s_mov_b64 vcc, s[48:49]
  v_xor_b32 v14, 1, v5
  v_lshlrev_b32 v14, 12, v14
  v_lshl_add_u32 v12, v4, 7, v14
  v_cndmask_b32 v12, v8, v12, vcc
  v_cndmask_b32 v13, 0, 1, vcc
  s_lshl_b32 s58, s16, 12
  s_add_u32 s58, s58, 45056
  s_mov_b32 s59, 0
APOLL_9:
  buffer_load_dword v14, v12, s[4:7], s58 offen sc1
  s_add_u32 s59, s59, 1
  s_waitcnt vmcnt(0)
  v_cmp_ne_u32 vcc, v14, v13
  s_cmp_ge_u32 s59, 60000
  s_cbranch_scc1 APOLLD_10
  s_nop 0
  s_cbranch_vccnz APOLL_9
APOLLD_10:
  s_barrier
ANP_11:
  s_add_u32 m0, s26, 0
  s_nop 0
  buffer_load_dwordx4 v37, s[4:7], s86 offen sc1 lds
  s_add_u32 m0, s26, 1024
  s_nop 0
  buffer_load_dwordx4 v37, s[4:7], s87 offen sc1 lds
  s_add_u32 m0, s26, 2048
  s_nop 0
  buffer_load_dwordx4 v37, s[4:7], s88 offen sc1 lds
  s_add_u32 m0, s26, 3072
  s_nop 0
  buffer_load_dwordx4 v37, s[4:7], s89 offen sc1 lds
  s_add_u32 m0, s44, 16384
  s_nop 0
  buffer_load_dwordx4 v38, s[4:7], s86 offen sc1 lds
  s_add_u32 m0, s44, 17408
  s_nop 0
  buffer_load_dwordx4 v38, s[4:7], s88 offen sc1 lds
  buffer_load_dwordx4 a[60:63], v32, s[4:7], s41 offen sc1
  buffer_load_dwordx4 a[64:67], v32, s[4:7], s42 offen sc1
  s_mov_b64 exec, s[56:57]
  buffer_load_dwordx2 v[16:17], v33, s[4:7], s41 offen sc1
  buffer_load_dwordx2 v[18:19], v33, s[4:7], s42 offen sc1
  s_mov_b64 exec, s[54:55]
  s_add_u32 m0, s45, 24576
  s_nop 0
  buffer_load_dwordx4 v34, s[4:7], s86 offen sc1 lds
  buffer_load_dwordx4 v35, s[4:7], s86 offen offset:1024 sc1 lds
  s_add_u32 m0, s45, 26624
  s_nop 0
  buffer_load_dwordx4 v34, s[4:7], s87 offen sc1 lds
  buffer_load_dwordx4 v35, s[4:7], s87 offen offset:1024 sc1 lds
  s_add_u32 m0, s45, 28672
  s_nop 0
  buffer_load_dwordx4 v34, s[4:7], s88 offen sc1 lds
  buffer_load_dwordx4 v35, s[4:7], s88 offen offset:1024 sc1 lds
  s_add_u32 m0, s45, 30720
  s_nop 0
  buffer_load_dwordx4 v34, s[4:7], s89 offen sc1 lds
  buffer_load_dwordx4 v35, s[4:7], s89 offen offset:1024 sc1 lds
  s_mov_b64 exec, -1
  s_cmp_lg_u32 s20, 0
  s_cbranch_scc1 AL0_12
  v_lshlrev_b32 v26, 2, v5
  v_sub_u32 v26, v4, v26
  v_mov_b32 v27, 0xf149f2ca
  v_cmp_gt_i32 s[50:51], 0, v26
  v_cmp_gt_i32 vcc, 1, v26
  s_nop 0
  v_cndmask_b32 v64, v27, 0, s[50:51]
  v_cndmask_b32 v80, 0, v27, s[50:51]
  v_cndmask_b32 v65, v27, 0, vcc
  v_cndmask_b32 v81, 0, v27, vcc
  v_cmp_gt_i32 s[50:51], 2, v26
  v_cmp_gt_i32 vcc, 3, v26
  s_nop 0
  v_cndmask_b32 v66, v27, 0, s[50:51]
  v_cndmask_b32 v82, 0, v27, s[50:51]
  v_cndmask_b32 v67, v27, 0, vcc
  v_cndmask_b32 v83, 0, v27, vcc
  v_cmp_gt_i32 s[50:51], 8, v26
  v_cmp_gt_i32 vcc, 9, v26
  s_nop 0
  v_cndmask_b32 v68, v27, 0, s[50:51]
  v_cndmask_b32 v84, 0, v27, s[50:51]
  v_cndmask_b32 v69, v27, 0, vcc
  v_cndmask_b32 v85, 0, v27, vcc
  v_cmp_gt_i32 s[50:51], 10, v26
  v_cmp_gt_i32 vcc, 11, v26
  s_nop 0
  v_cndmask_b32 v70, v27, 0, s[50:51]
  v_cndmask_b32 v86, 0, v27, s[50:51]
  v_cndmask_b32 v71, v27, 0, vcc
  v_cndmask_b32 v87, 0, v27, vcc
  v_cmp_gt_i32 s[50:51], 16, v26
  v_cmp_gt_i32 vcc, 17, v26
  s_nop 0
  v_cndmask_b32 v72, v27, 0, s[50:51]
  v_cndmask_b32 v88, 0, v27, s[50:51]
  v_cndmask_b32 v73, v27, 0, vcc
  v_cndmask_b32 v89, 0, v27, vcc
  v_cmp_gt_i32 s[50:51], 18, v26
  v_cmp_gt_i32 vcc, 19, v26
  s_nop 0
  v_cndmask_b32 v74, v27, 0, s[50:51]
  v_cndmask_b32 v90, 0, v27, s[50:51]
  v_cndmask_b32 v75, v27, 0, vcc
  v_cndmask_b32 v91, 0, v27, vcc
  v_cmp_gt_i32 s[50:51], 24, v26
  v_cmp_gt_i32 vcc, 25, v26
  s_nop 0
  v_cndmask_b32 v76, v27, 0, s[50:51]
  v_cndmask_b32 v92, 0, v27, s[50:51]
  v_cndmask_b32 v77, v27, 0, vcc
  v_cndmask_b32 v93, 0, v27, vcc
  v_cmp_gt_i32 s[50:51], 26, v26
  v_cmp_gt_i32 vcc, 27, v26
  s_nop 0
  v_cndmask_b32 v78, v27, 0, s[50:51]
  v_cndmask_b32 v94, 0, v27, s[50:51]
  v_cndmask_b32 v79, v27, 0, vcc
  v_cndmask_b32 v95, 0, v27, vcc
  v_mov_b32 v27, 0x3f80
  s_cmp_lt_i32 s36, 8
  s_mov_b32 s37, 0x3f800000
  s_cselect_b32 s37, 0x3f80f14a, s37
  v_accvgpr_write_b32 a40, s37
  v_accvgpr_write_b32 a41, v27
  s_cmp_lt_i32 s36, 7
  s_mov_b32 s37, 0x3f800000
  s_cselect_b32 s37, 0x3f80f14a, s37
  v_accvgpr_write_b32 a42, s37
  v_accvgpr_write_b32 a43, v27
  s_cmp_lt_i32 s36, 6
  s_mov_b32 s37, 0x3f800000
  s_cselect_b32 s37, 0x3f80f14a, s37
  v_accvgpr_write_b32 a44, s37
  v_accvgpr_write_b32 a45, v27
  s_cmp_lt_i32 s36, 5
  s_mov_b32 s37, 0x3f800000
  s_cselect_b32 s37, 0x3f80f14a, s37
  v_accvgpr_write_b32 a46, s37
  v_accvgpr_write_b32 a47, v27
  s_cmp_lt_i32 s36, 4
  s_mov_b32 s37, 0x3f800000
  s_cselect_b32 s37, 0x3f80f14a, s37
  v_accvgpr_write_b32 a48, s37
  v_accvgpr_write_b32 a49, v27
  s_cmp_lt_i32 s36, 3
  s_mov_b32 s37, 0x3f800000
  s_cselect_b32 s37, 0x3f80f14a, s37
  v_accvgpr_write_b32 a50, s37
  v_accvgpr_write_b32 a51, v27
  s_cmp_lt_i32 s36, 2
  s_mov_b32 s37, 0x3f800000
  s_cselect_b32 s37, 0x3f80f14a, s37
  v_accvgpr_write_b32 a52, s37
  v_accvgpr_write_b32 a53, v27
  s_cmp_lt_i32 s36, 1
  s_mov_b32 s37, 0x3f800000
  s_cselect_b32 s37, 0x3f80f14a, s37
  v_accvgpr_write_b32 a54, s37
  v_accvgpr_write_b32 a55, v27
  s_cmp_lt_i32 s36, 0
  s_mov_b32 s37, 0x3f800000
  s_cselect_b32 s37, 0x3f80f14a, s37
  v_accvgpr_write_b32 a56, s37
  v_accvgpr_write_b32 a57, v27
  s_cmp_lt_i32 s36, -1
  s_mov_b32 s37, 0x3f800000
  s_cselect_b32 s37, 0x3f80f14a, s37
  v_accvgpr_write_b32 a58, s37
  v_accvgpr_write_b32 a59, v27
  s_mov_b32 s46, s41
  v_cmp_gt_u32 s[52:53], 32, v0
  v_mov_b32 v39, 0
  s_lshl_b32 s91, s2, 2
  s_add_u32 s91, s91, s18
  s_mul_i32 s91, s91, 10240
  s_add_u32 s91, s91, 147456
  s_cmp_eq_u32 s20, 0
  s_cselect_b32 s37, 64, 0
  s_cselect_b32 s38, 16, 0
  v_lshlrev_b32 v26, 7, v0
  v_cmp_gt_u32 vcc, s37, v0
  s_nop 1
  v_cndmask_b32 v54, v8, v26, vcc
  v_add_u32 v26, 8192, v26
  v_cmp_gt_u32 vcc, s38, v0
  s_nop 1
  v_cndmask_b32 v55, v8, v26, vcc
  v_mul_u32_u24 v53, 107520, v5
  v_lshl_add_u32 v53, v4, 2, v53
  v_add_u32 v50, s44, v1
  s_lshl_b32 s37, s18, 10
  s_and_b32 s38, s17, 1
  s_lshl_b32 s38, s38, 3
  s_add_u32 s37, s37, s38
  v_add_u32 v51, s37, v1
  v_add_u32 v52, s26, v1
  v_cndmask_b32 v36, v8, v33, s[52:53]
  s_min_u32 s36, s17, 29
  s_cmp_ge_u32 s36, 15
  s_cselect_b32 s28, 1, 0
  s_cselect_b32 s29, 15, 0
  s_sub_u32 s29, s36, s29
  s_and_b32 s37, s18, 1
  s_mul_i32 s37, s37, 40960
  s_lshr_b32 s38, s18, 1
  s_lshl_b32 s38, s38, 12
  s_add_u32 s37, s37, s38
  s_mul_i32 s22, s29, 163840
  s_add_u32 s22, s22, 147456
  s_add_u32 s70, s22, s37
  s_mul_i32 s38, s18, 40960
  s_add_u32 s22, s22, s38
  v_add_u32 v2, 0x10000, v1
  v_add_u32 v3, 0x20000, v1
  v_and_b32 v6, 15, v0
  v_lshrrev_b32 v7, 4, v0
  s_bfe_u32 s47, s17, 0x20002
  s_and_b32 s48, s17, 3
  s_mul_i32 s49, s47, 28
  s_cmp_eq_u32 s47, 3
  s_cselect_b32 s38, 2, 0
  s_sub_u32 s49, s49, s38
  s_lshl_b32 s30, s48, 2
  s_add_u32 s30, s30, s49
  s_cmp_lt_u32 s47, 2
  s_cselect_b32 s38, 9, 7
  s_mul_i32 s48, s48, 3
  s_min_u32 s48, s48, s38
  s_add_u32 s71, s49, s48
  s_add_u32 s71, s71, 16
  s_add_u32 s38, s30, 60
  s_mul_i32 s39, s38, 40960
  s_add_u32 s39, s39, 147456
  s_mul_i32 s23, s18, 40960
  s_add_u32 s23, s23, s39
  s_add_u32 s27, s39, s37
  s_mul_i32 s31, s71, 40960
  s_add_u32 s31, s31, 2605056
  s_add_u32 s31, s31, s26
  s_mul_i32 s47, s18, 3
  s_add_u32 s47, s47, 0
  s_min_u32 s47, s47, 10
  s_lshl_b32 s48, s29, 2
  s_add_u32 s48, s48, s47
  s_add_u32 s49, s38, s47
  s_sub_u32 s49, s49, 4
  s_cmp_lt_u32 s47, 4
  s_cselect_b32 s48, s48, s49
  s_add_u32 s49, s71, s47
  s_add_u32 s49, s49, 52
  s_cmp_lt_u32 s47, 8
  s_cselect_b32 s48, s48, s49
  s_lshl_b32 s48, s48, 7
  s_add_u32 s75, s48, 7028736
  s_lshl_b32 s72, s47, 9
  s_mul_i32 s47, s18, 3
  s_add_u32 s47, s47, 1
  s_min_u32 s47, s47, 10
  s_lshl_b32 s48, s29, 2
  s_add_u32 s48, s48, s47
  s_add_u32 s49, s38, s47
  s_sub_u32 s49, s49, 4
  s_cmp_lt_u32 s47, 4
  s_cselect_b32 s48, s48, s49
  s_add_u32 s49, s71, s47
  s_add_u32 s49, s49, 52
  s_cmp_lt_u32 s47, 8
  s_cselect_b32 s48, s48, s49
  s_lshl_b32 s48, s48, 7
  s_add_u32 s76, s48, 7028736
  s_lshl_b32 s73, s47, 9
  s_mul_i32 s47, s18, 3
  s_add_u32 s47, s47, 2
  s_min_u32 s47, s47, 10
  s_lshl_b32 s48, s29, 2
  s_add_u32 s48, s48, s47
  s_add_u32 s49, s38, s47
  s_sub_u32 s49, s49, 4
  s_cmp_lt_u32 s47, 4
  s_cselect_b32 s48, s48, s49
  s_add_u32 s49, s71, s47
  s_add_u32 s49, s49, 52
  s_cmp_lt_u32 s47, 8
  s_cselect_b32 s48, s48, s49
  s_lshl_b32 s48, s48, 7
  s_add_u32 s77, s48, 7028736
  s_lshl_b32 s74, s47, 9
  s_and_b32 s39, s17, 7
  s_mul_i32 s35, s18, 5
  s_mul_i32 s24, s39, 20
  s_add_u32 s24, s24, s35
  s_mul_i32 s24, s24, 5120
  s_add_u32 s24, s24, 7245824
  s_mul_i32 s34, s18, 14
  s_cmp_eq_u32 s18, 3
  s_cselect_b32 s47, 1, 0
  s_sub_u32 s34, s34, s47
  s_mul_i32 s25, s39, 54
  s_add_u32 s25, s25, s34
  s_mul_i32 s25, s25, 5120
  s_add_u32 s25, s25, 8065024
  s_lshr_b32 s60, s17, 3
  s_lshl_b32 s61, s16, 3
  s_lshl_b32 s60, s60, 1
  s_add_u32 s61, s61, s60
  s_lshr_b32 s62, s18, 1
  s_add_u32 s62, s62, s61
  s_mul_i32 s63, s62, 40960
  s_and_b32 s60, s18, 1
  s_lshl_b32 s47, s60, 8
  s_add_u32 s63, s63, s47
  s_mul_i32 s47, s39, 5120
  s_add_u32 s63, s63, s47
  s_lshl_b32 s67, s62, 8
  s_lshl_b32 s47, s60, 7
  s_add_u32 s67, s67, s47
  s_lshl_b32 s47, s39, 14
  s_add_u32 s67, s67, s47
  s_add_u32 s67, s67, 15519744
  s_lshl_b32 s68, s62, 5
  s_lshl_b32 s47, s60, 4
  s_add_u32 s68, s68, s47
  s_mul_i32 s68, s68, 1280
  s_mul_i32 s47, s39, 160
  s_add_u32 s68, s68, s47
  v_lshlrev_b32 v9, 9, v7
  v_lshl_add_u32 v9, v6, 4, v9
  v_lshrrev_b32 v10, 1, v7
  v_lshlrev_b32 v10, 9, v10
  v_lshl_add_u32 v10, v6, 4, v10
  v_and_b32 v13, 1, v7
  v_lshl_add_u32 v10, v13, 3, v10
  v_add_u32 v10, 4096, v10
  v_lshlrev_b32 v11, 3, v0
  v_add_u32 v11, 147456, v11
  s_nop 2
  s_cmp_lg_u32 s18, 0
  s_cbranch_scc1 AL0_12
  s_mov_b32 s47, s17
  s_mov_b32 s48, 0
  s_cmp_lg_u32 s66, 0
  s_cbranch_scc1 CLOK_15
  s_waitcnt vmcnt(18)
CLP_14:
  v_readfirstlane_b32 s49, v60
  s_nop 1
  s_cmp_eq_u32 s49, 0
  s_cbranch_scc1 CLOK_15
  s_add_u32 s48, s48, 1
  s_cmp_ge_u32 s48, 40
  s_cbranch_scc1 CLOK_15
  s_add_u32 s47, s47, 1
  s_and_b32 s47, s47, 31
  s_lshl_b32 s49, s47, 2
  s_add_u32 s49, s49, s21
  s_add_u32 s49, s49, 12288
  v_mov_b32 v60, 1
  s_mov_b64 exec, 1
  buffer_atomic_add v60, v61, s[4:7], s49 offen sc0
  s_mov_b64 exec, -1
  s_waitcnt vmcnt(0)
  s_branch CLP_14
CLOK_15:
  v_mov_b32 v62, s47
  v_mov_b32 v63, 154624
  ds_write_b32 v63, v62
  s_waitcnt lgkmcnt(0)
AL0_12:
  s_waitcnt vmcnt(12)
  s_barrier
  s_cmp_lg_u32 s20, 0
  s_cbranch_scc1 AL2_16
  v_mov_b32 v63, 154624
  ds_read_b32 v62, v63
  s_waitcnt lgkmcnt(0)
  v_readfirstlane_b32 s47, v62
  s_mov_b32 s66, 1
  s_nop 1
  s_cmp_eq_u32 s47, s17
  s_cbranch_scc1 AL2_16
  s_mov_b32 s17, s47
  s_waitcnt vmcnt(0)
  s_barrier
  s_branch ATT_ENTRY
AL2_16:
  ds_read_b128 a[0:3], v50
  ds_read_b128 a[4:7], v50 offset:1024
  ds_read_b128 a[8:11], v50 offset:2048
  s_mov_b64 exec, s[56:57]
  ds_read_b64 a[40:41], v51 offset:16384
  ds_read_b64 a[42:43], v51 offset:16896
  ds_read_b64 a[44:45], v51 offset:17408
  ds_read_b64 a[46:47], v51 offset:17920
  ds_read_b64 a[48:49], v51 offset:18432
  ds_read_b64 a[50:51], v51 offset:18944
  ds_read_b64 a[52:53], v51 offset:19456
  ds_read_b64 a[54:55], v51 offset:19968
  ds_read_b64 a[56:57], v51 offset:20480
  ds_read_b64 a[58:59], v51 offset:20992
  s_mov_b64 exec, -1
  s_waitcnt vmcnt(11)
  s_waitcnt lgkmcnt(12)
  v_mfma_f32_32x32x16_bf16 v[96:111], a[0:3], a[60:63], v[64:79]
  s_waitcnt vmcnt(9)
  s_waitcnt lgkmcnt(9)
  v_mfma_f32_32x32x8_bf16 v[96:111], a[40:41], v[16:17], v[96:111]
  ds_read_b128 a[12:15], v50 offset:3072
  s_add_u32 s69, s63, s65
  buffer_load_dwordx4 v[40:43], v9, s[4:7], s69 offen sc1
  buffer_load_dwordx4 v[44:47], v9, s[4:7], s69 offen offset:2048 sc1
  buffer_load_dwordx2 v[48:49], v10, s[4:7], s69 offen sc1
  v_mfma_f32_32x32x16_bf16 v[112:127], a[4:7], a[60:63], 0
  ds_read_b128 a[16:19], v50 offset:4096
  s_nop 4
  v_max_f32 v24, v96, v97
  v_max_f32 v25, v98, v99
  v_max3_f32 v24, v24, v100, v101
  v_max3_f32 v25, v25, v102, v103
  v_max3_f32 v24, v24, v104, v105
  s_waitcnt lgkmcnt(10)
  v_mfma_f32_32x32x8_bf16 v[112:127], a[42:43], v[16:17], v[112:127]
  s_add_u32 m0, s26, 65536
  s_add_u32 s32, s23, 0
  buffer_load_dwordx4 v1, s[4:7], s32 offen offset:0 lds
  v_max3_f32 v25, v25, v106, v107
  v_max3_f32 v24, v24, v108, v109
  v_max3_f32 v25, v25, v110, v111
  v_mfma_f32_32x32x16_bf16 v[128:143], a[8:11], a[60:63], 0
  ds_read_b128 a[20:23], v50 offset:5120
  s_nop 3
  v_max3_f32 v24, v24, v112, v113
  v_max3_f32 v25, v25, v114, v115
  v_max3_f32 v24, v24, v116, v117
  v_max3_f32 v25, v25, v118, v119
  s_waitcnt lgkmcnt(10)
  v_mfma_f32_32x32x8_bf16 v[128:143], a[44:45], v[16:17], v[128:143]
  buffer_load_dword v254, v39, s[4:7], s67 offen sc1
  v_max3_f32 v24, v24, v120, v121
  v_max3_f32 v25, v25, v122, v123
  v_max3_f32 v24, v24, v124, v125
  v_max3_f32 v25, v25, v126, v127
  s_waitcnt lgkmcnt(2)
  v_mfma_f32_32x32x16_bf16 v[96:111], a[12:15], a[60:63], 0
  ds_read_b128 a[24:27], v50 offset:6144
  s_nop 3
  v_max3_f32 v24, v24, v128, v129
  v_max3_f32 v25, v25, v130, v131
  v_max3_f32 v24, v24, v132, v133
  v_max3_f32 v25, v25, v134, v135
  v_mfma_f32_32x32x8_bf16 v[96:111], a[46:47], v[16:17], v[96:111]
  buffer_load_dwordx4 a[92:95], v1, s[4:7], s24 offen
  v_max3_f32 v24, v24, v136, v137
  v_max3_f32 v25, v25, v138, v139
  v_max3_f32 v24, v24, v140, v141
  v_max3_f32 v25, v25, v142, v143
  s_waitcnt lgkmcnt(2)
  v_mfma_f32_32x32x16_bf16 v[112:127], a[16:19], a[60:63], 0
  ds_read_b128 a[28:31], v50 offset:7168
  s_nop 3
  v_max3_f32 v24, v24, v96, v97
  v_max3_f32 v25, v25, v98, v99
  v_max3_f32 v24, v24, v100, v101
  v_max3_f32 v25, v25, v102, v103
  v_mfma_f32_32x32x8_bf16 v[112:127], a[48:49], v[16:17], v[112:127]
  buffer_load_dwordx4 v1, s[4:7], s32 offen offset:1024 lds
  v_max3_f32 v24, v24, v104, v105
  v_max3_f32 v25, v25, v106, v107
  v_max3_f32 v24, v24, v108, v109
  v_max3_f32 v25, v25, v110, v111
  s_waitcnt lgkmcnt(2)
  v_mfma_f32_32x32x16_bf16 v[128:143], a[20:23], a[60:63], 0
  ds_read_b128 a[32:35], v50 offset:8192
  s_nop 3
  v_max3_f32 v24, v24, v112, v113
  v_max3_f32 v25, v25, v114, v115
  v_max3_f32 v24, v24, v116, v117
  v_max3_f32 v25, v25, v118, v119
  v_mfma_f32_32x32x8_bf16 v[128:143], a[50:51], v[16:17], v[128:143]
  buffer_load_dwordx4 a[96:99], v1, s[4:7], s24 offen offset:1024
  v_max3_f32 v24, v24, v120, v121
  v_max3_f32 v25, v25, v122, v123
  v_max3_f32 v24, v24, v124, v125
  v_max3_f32 v25, v25, v126, v127
  s_waitcnt lgkmcnt(2)
  v_mfma_f32_32x32x16_bf16 v[96:111], a[24:27], a[60:63], 0
  ds_read_b128 a[36:39], v50 offset:9216
  s_nop 3
  v_max3_f32 v24, v24, v128, v129
  v_max3_f32 v25, v25, v130, v131
  v_max3_f32 v24, v24, v132, v133
  v_max3_f32 v25, v25, v134, v135
  v_mfma_f32_32x32x8_bf16 v[96:111], a[52:53], v[16:17], v[96:111]
  buffer_load_dwordx4 a[100:103], v1, s[4:7], s24 offen offset:2048
  v_max3_f32 v24, v24, v136, v137
  v_max3_f32 v25, v25, v138, v139
  v_max3_f32 v24, v24, v140, v141
  v_max3_f32 v25, v25, v142, v143
  s_waitcnt lgkmcnt(2)
  v_mfma_f32_32x32x16_bf16 v[112:127], a[28:31], a[60:63], 0
  buffer_load_dwordx4 v1, s[4:7], s32 offen offset:2048 lds
  s_nop 3
  v_max3_f32 v24, v24, v96, v97
  v_max3_f32 v25, v25, v98, v99
  v_max3_f32 v24, v24, v100, v101
  v_max3_f32 v25, v25, v102, v103
  v_mfma_f32_32x32x8_bf16 v[112:127], a[54:55], v[16:17], v[112:127]
  v_max3_f32 v24, v24, v104, v105
  v_max3_f32 v25, v25, v106, v107
  v_max3_f32 v24, v24, v108, v109
  v_max3_f32 v25, v25, v110, v111
  s_waitcnt lgkmcnt(1)
  v_mfma_f32_32x32x16_bf16 v[128:143], a[32:35], a[60:63], v[80:95]
  buffer_load_dwordx4 a[104:107], v1, s[4:7], s24 offen offset:3072
  s_nop 4
  v_max3_f32 v24, v24, v112, v113
  v_max3_f32 v25, v25, v114, v115
  v_max3_f32 v24, v24, v116, v117
  v_max3_f32 v25, v25, v118, v119
  v_mfma_f32_32x32x8_bf16 v[128:143], a[56:57], v[16:17], v[128:143]
  v_max3_f32 v24, v24, v120, v121
  v_max3_f32 v25, v25, v122, v123
  v_max3_f32 v24, v24, v124, v125
  v_max3_f32 v25, v25, v126, v127
  v_mfma_f32_32x32x16_bf16 v[96:111], a[4:7], a[64:67], v[64:79]
  s_add_u32 s33, s24, 4096
  buffer_load_dwordx4 a[108:111], v1, s[4:7], s33 offen
  s_nop 4
  v_max3_f32 v24, v24, v128, v129
  v_max3_f32 v25, v25, v130, v131
  v_max3_f32 v24, v24, v132, v133
  s_waitcnt vmcnt(20)
  v_mfma_f32_32x32x8_bf16 v[96:111], a[42:43], v[18:19], v[96:111]
  v_max3_f32 v25, v25, v134, v135
  v_max3_f32 v24, v24, v136, v137
  v_max3_f32 v25, v25, v138, v139
  v_max3_f32 v24, v24, v140, v141
  v_max3_f32 v25, v25, v142, v143
  v_mfma_f32_32x32x16_bf16 v[112:127], a[8:11], a[64:67], 0
  buffer_load_dwordx4 v1, s[4:7], s32 offen offset:3072 lds
  v_max_f32 v24, v24, v25
  v_mov_b32 v25, v24
  s_nop 1
  v_permlane32_swap_b32 v24, v25
  v_max_f32 v24, v24, v25
  v_cvt_pk_bf16_f32 v26, 1.0, -v24
  v_mfma_f32_32x32x8_bf16 v[112:127], a[44:45], v[18:19], v[112:127]
  v_and_b32 v27, 0xffff0000, v26
  v_sub_f32 v27, -v24, v27
  v_cvt_pk_bf16_f32 v27, v27, 0
  v_cndmask_b32 v20, v26, v16, s[52:53]
  v_cndmask_b32 v21, v27, v17, s[52:53]
  v_mfma_f32_32x32x16_bf16 v[144:159], a[0:3], a[60:63], v[64:79]
  buffer_load_dwordx4 a[112:115], v1, s[4:7], s33 offen offset:1024
  v_max_f32 v24, v96, v97
  v_max_f32 v25, v98, v99
  v_max3_f32 v24, v24, v100, v101
  v_max3_f32 v25, v25, v102, v103
  v_mfma_f32_32x32x8_bf16 v[144:159], a[40:41], v[20:21], v[144:159]
  v_max3_f32 v24, v24, v104, v105
  v_max3_f32 v25, v25, v106, v107
  v_max3_f32 v24, v24, v108, v109
  v_max3_f32 v25, v25, v110, v111
  v_mfma_f32_32x32x16_bf16 v[160:175], a[4:7], a[60:63], 0
  buffer_load_dwordx4 a[116:119], v1, s[4:7], s33 offen offset:2048
  v_max3_f32 v24, v24, v112, v113
  v_max3_f32 v25, v25, v114, v115
  v_mfma_f32_32x32x8_bf16 v[160:175], a[42:43], v[20:21], v[160:175]
  v_max3_f32 v24, v24, v116, v117
  v_max3_f32 v25, v25, v118, v119
  v_mfma_f32_32x32x16_bf16 v[128:143], a[12:15], a[64:67], 0
  v_max3_f32 v24, v24, v120, v121
  v_max3_f32 v25, v25, v122, v123
  v_mfma_f32_32x32x8_bf16 v[128:143], a[46:47], v[18:19], v[128:143]
  v_max3_f32 v24, v24, v124, v125
  v_max3_f32 v25, v25, v126, v127
  s_waitcnt vmcnt(15)
  s_barrier
  v_mfma_f32_32x32x16_bf16 v[176:191], a[8:11], a[60:63], 0
  ds_read_b128 a[68:71], v52 offset:24576
  ds_read_b128 a[72:75], v52 offset:25600
  v_exp_f32 v144, v144
  s_nop 3
  v_max3_f32 v24, v24, v128, v129
  v_exp_f32 v145, v145
  v_exp_f32 v146, v146
  v_max3_f32 v25, v25, v130, v131
  v_exp_f32 v147, v147
  v_exp_f32 v148, v148
  v_mfma_f32_32x32x8_bf16 v[176:191], a[44:45], v[20:21], v[176:191]
  s_add_u32 m0, s26, 81920
  s_add_u32 s32, s23, 4096
  buffer_load_dwordx4 v1, s[4:7], s32 offen offset:0 lds
  v_max3_f32 v24, v24, v132, v133
  v_exp_f32 v149, v149
  v_exp_f32 v150, v150
  v_max3_f32 v25, v25, v134, v135
  v_exp_f32 v151, v151
  v_exp_f32 v152, v152
  v_max3_f32 v24, v24, v136, v137
  v_mfma_f32_32x32x16_bf16 v[96:111], a[16:19], a[64:67], 0
  buffer_load_dwordx4 a[120:123], v1, s[4:7], s33 offen offset:3072
  v_exp_f32 v153, v153
  v_exp_f32 v154, v154
  v_max3_f32 v25, v25, v138, v139
  v_exp_f32 v155, v155
  v_exp_f32 v156, v156
  v_max3_f32 v24, v24, v140, v141
  v_exp_f32 v157, v157
  v_exp_f32 v158, v158
  v_mfma_f32_32x32x8_bf16 v[96:111], a[48:49], v[18:19], v[96:111]
  s_add_u32 s33, s24, 8192
  buffer_load_dwordx4 a[124:127], v1, s[4:7], s33 offen
  v_max3_f32 v25, v25, v142, v143
  v_exp_f32 v159, v159
  v_cvt_pk_bf16_f32 v192, v144, v145
  v_cvt_pk_bf16_f32 v193, v146, v147
  v_cvt_pk_bf16_f32 v194, v148, v149
  v_cvt_pk_bf16_f32 v195, v150, v151
  v_cvt_pk_bf16_f32 v196, v152, v153
  v_cvt_pk_bf16_f32 v197, v154, v155
  v_cvt_pk_bf16_f32 v198, v156, v157
  v_cvt_pk_bf16_f32 v199, v158, v159
  v_mfma_f32_32x32x16_bf16 v[144:159], a[12:15], a[60:63], 0
  ds_read_b128 a[76:79], v52 offset:26624
  ds_read_b128 a[80:83], v52 offset:27648
  v_exp_f32 v160, v160
  v_max3_f32 v24, v24, v96, v97
  v_exp_f32 v161, v161
  v_exp_f32 v162, v162
  v_mfma_f32_32x32x8_bf16 v[144:159], a[46:47], v[20:21], v[144:159]
  buffer_load_dwordx4 v1, s[4:7], s32 offen offset:1024 lds
  v_max3_f32 v25, v25, v98, v99
  v_exp_f32 v163, v163
  v_exp_f32 v164, v164
  v_max3_f32 v24, v24, v100, v101
  v_exp_f32 v165, v165
  s_waitcnt lgkmcnt(3)
  v_mfma_f32_32x32x16_bf16 v[208:223], a[68:71], v[192:195], 0
  buffer_load_dwordx4 a[128:131], v1, s[4:7], s33 offen offset:1024
  v_exp_f32 v166, v166
  v_max3_f32 v25, v25, v102, v103
  v_exp_f32 v167, v167
  v_exp_f32 v168, v168
  v_max3_f32 v24, v24, v104, v105
  s_waitcnt lgkmcnt(2)
  v_mfma_f32_32x32x16_bf16 v[208:223], a[72:75], v[196:199], v[208:223]
  buffer_load_dwordx4 a[132:135], v1, s[4:7], s33 offen offset:2048
  v_exp_f32 v169, v169
  v_exp_f32 v170, v170
  v_max3_f32 v25, v25, v106, v107
  v_exp_f32 v171, v171
  v_exp_f32 v172, v172
  v_mfma_f32_32x32x16_bf16 v[112:127], a[20:23], a[64:67], 0
  v_max3_f32 v24, v24, v108, v109
  v_exp_f32 v173, v173
  v_exp_f32 v174, v174
  v_max3_f32 v25, v25, v110, v111
  v_exp_f32 v175, v175
  v_mfma_f32_32x32x8_bf16 v[112:127], a[50:51], v[18:19], v[112:127]
  v_cvt_pk_bf16_f32 v200, v160, v161
  v_cvt_pk_bf16_f32 v201, v162, v163
  v_cvt_pk_bf16_f32 v202, v164, v165
  v_cvt_pk_bf16_f32 v203, v166, v167
  v_cvt_pk_bf16_f32 v204, v168, v169
  v_cvt_pk_bf16_f32 v205, v170, v171
  v_cvt_pk_bf16_f32 v206, v172, v173
  v_cvt_pk_bf16_f32 v207, v174, v175
  v_mfma_f32_32x32x16_bf16 v[160:175], a[16:19], a[60:63], 0
  ds_read_b128 a[84:87], v52 offset:28672
  ds_read_b128 a[88:91], v52 offset:29696
  v_exp_f32 v176, v176
  v_max3_f32 v24, v24, v112, v113
  v_exp_f32 v177, v177
  v_exp_f32 v178, v178
  v_mfma_f32_32x32x8_bf16 v[160:175], a[48:49], v[20:21], v[160:175]
  buffer_load_dwordx4 v1, s[4:7], s32 offen offset:2048 lds
  v_max3_f32 v25, v25, v114, v115
  v_exp_f32 v179, v179
  v_exp_f32 v180, v180
  v_max3_f32 v24, v24, v116, v117
  v_exp_f32 v181, v181
  s_waitcnt lgkmcnt(3)
  v_mfma_f32_32x32x16_bf16 v[208:223], a[76:79], v[200:203], v[208:223]
  buffer_load_dwordx4 a[136:139], v1, s[4:7], s33 offen offset:3072
  v_exp_f32 v182, v182
  v_max3_f32 v25, v25, v118, v119
  v_exp_f32 v183, v183
  v_exp_f32 v184, v184
  v_max3_f32 v24, v24, v120, v121
  s_waitcnt lgkmcnt(2)
  v_mfma_f32_32x32x16_bf16 v[208:223], a[80:83], v[204:207], v[208:223]
  s_add_u32 s33, s24, 12288
  buffer_load_dwordx4 a[140:143], v1, s[4:7], s33 offen
  v_exp_f32 v185, v185
  v_exp_f32 v186, v186
  v_max3_f32 v25, v25, v122, v123
  v_exp_f32 v187, v187
  v_mfma_f32_32x32x16_bf16 v[128:143], a[24:27], a[64:67], 0
  v_exp_f32 v188, v188
  v_max3_f32 v24, v24, v124, v125
  v_exp_f32 v189, v189
  v_exp_f32 v190, v190
  v_max3_f32 v25, v25, v126, v127
  v_exp_f32 v191, v191
  v_mfma_f32_32x32x8_bf16 v[128:143], a[52:53], v[18:19], v[128:143]
  v_cvt_pk_bf16_f32 v192, v176, v177
  v_cvt_pk_bf16_f32 v193, v178, v179
  v_cvt_pk_bf16_f32 v194, v180, v181
  v_cvt_pk_bf16_f32 v195, v182, v183
  v_cvt_pk_bf16_f32 v196, v184, v185
  v_cvt_pk_bf16_f32 v197, v186, v187
  v_cvt_pk_bf16_f32 v198, v188, v189
  v_cvt_pk_bf16_f32 v199, v190, v191
  v_mfma_f32_32x32x16_bf16 v[176:191], a[20:23], a[60:63], 0
  ds_read_b128 a[68:71], v52 offset:30720
  ds_read_b128 a[72:75], v52 offset:31744
  v_exp_f32 v144, v144
  v_max3_f32 v24, v24, v128, v129
  v_exp_f32 v145, v145
  v_exp_f32 v146, v146
  v_mfma_f32_32x32x8_bf16 v[176:191], a[50:51], v[20:21], v[176:191]
  buffer_load_dwordx4 v1, s[4:7], s32 offen offset:3072 lds
  v_max3_f32 v25, v25, v130, v131
  v_exp_f32 v147, v147
  v_exp_f32 v148, v148
  v_max3_f32 v24, v24, v132, v133
  v_exp_f32 v149, v149
  s_waitcnt lgkmcnt(3)
  v_mfma_f32_32x32x16_bf16 v[208:223], a[84:87], v[192:195], v[208:223]
  buffer_load_dwordx4 a[144:147], v1, s[4:7], s33 offen offset:1024
  v_exp_f32 v150, v150
  v_max3_f32 v25, v25, v134, v135
  v_exp_f32 v151, v151
  v_exp_f32 v152, v152
  v_max3_f32 v24, v24, v136, v137
  s_waitcnt lgkmcnt(2)
  v_mfma_f32_32x32x16_bf16 v[208:223], a[88:91], v[196:199], v[208:223]
  buffer_load_dwordx4 a[148:151], v1, s[4:7], s33 offen offset:2048
  v_exp_f32 v153, v153
  v_exp_f32 v154, v154
  v_max3_f32 v25, v25, v138, v139
  v_exp_f32 v155, v155
  v_exp_f32 v156, v156
  v_mfma_f32_32x32x16_bf16 v[96:111], a[28:31], a[64:67], 0
  v_max3_f32 v24, v24, v140, v141
  v_exp_f32 v157, v157
  v_exp_f32 v158, v158
  v_max3_f32 v25, v25, v142, v143
  v_exp_f32 v159, v159
  v_mfma_f32_32x32x8_bf16 v[96:111], a[54:55], v[18:19], v[96:111]
  v_cvt_pk_bf16_f32 v200, v144, v145
  v_cvt_pk_bf16_f32 v201, v146, v147
  v_cvt_pk_bf16_f32 v202, v148, v149
  v_cvt_pk_bf16_f32 v203, v150, v151
  v_cvt_pk_bf16_f32 v204, v152, v153
  v_cvt_pk_bf16_f32 v205, v154, v155
  v_cvt_pk_bf16_f32 v206, v156, v157
  v_cvt_pk_bf16_f32 v207, v158, v159
  v_mfma_f32_32x32x16_bf16 v[144:159], a[24:27], a[60:63], 0
  ds_read_b128 a[76:79], v52 offset:32768
  ds_read_b128 a[80:83], v52 offset:33792
  v_exp_f32 v160, v160
  v_max3_f32 v24, v24, v96, v97
  v_exp_f32 v161, v161
  v_exp_f32 v162, v162
  v_max3_f32 v25, v25, v98, v99
  v_mfma_f32_32x32x8_bf16 v[144:159], a[52:53], v[20:21], v[144:159]
  s_add_u32 m0, s26, 98304
  s_add_u32 s32, s23, 8192
  buffer_load_dwordx4 v1, s[4:7], s32 offen offset:0 lds
  v_exp_f32 v163, v163
  v_exp_f32 v164, v164
  v_max3_f32 v24, v24, v100, v101
  v_exp_f32 v165, v165
  s_waitcnt lgkmcnt(3)
  v_mfma_f32_32x32x16_bf16 v[208:223], a[68:71], v[200:203], v[208:223]
  buffer_load_dwordx4 a[152:155], v1, s[4:7], s33 offen offset:3072
  v_exp_f32 v166, v166
  v_max3_f32 v25, v25, v102, v103
  v_exp_f32 v167, v167
  v_exp_f32 v168, v168
  s_waitcnt lgkmcnt(2)
  v_mfma_f32_32x32x16_bf16 v[208:223], a[72:75], v[204:207], v[208:223]
  s_add_u32 s33, s24, 16384
  buffer_load_dwordx4 a[156:159], v1, s[4:7], s33 offen
  v_max3_f32 v24, v24, v104, v105
  v_exp_f32 v169, v169
  v_exp_f32 v170, v170
  v_max3_f32 v25, v25, v106, v107
  v_exp_f32 v171, v171
  v_mfma_f32_32x32x16_bf16 v[112:127], a[32:35], a[64:67], 0
  v_exp_f32 v172, v172
  v_max3_f32 v24, v24, v108, v109
  v_exp_f32 v173, v173
  v_exp_f32 v174, v174
  v_max3_f32 v25, v25, v110, v111
  v_exp_f32 v175, v175
  v_mfma_f32_32x32x8_bf16 v[112:127], a[56:57], v[18:19], v[112:127]
  v_cvt_pk_bf16_f32 v192, v160, v161
  v_cvt_pk_bf16_f32 v193, v162, v163
  v_cvt_pk_bf16_f32 v194, v164, v165
  v_cvt_pk_bf16_f32 v195, v166, v167
  v_cvt_pk_bf16_f32 v196, v168, v169
  v_cvt_pk_bf16_f32 v197, v170, v171
  v_cvt_pk_bf16_f32 v198, v172, v173
  v_cvt_pk_bf16_f32 v199, v174, v175
  v_mfma_f32_32x32x16_bf16 v[160:175], a[28:31], a[60:63], 0
  ds_read_b128 a[84:87], v52 offset:34816
  ds_read_b128 a[88:91], v52 offset:35840
  v_exp_f32 v176, v176
  v_max3_f32 v24, v24, v112, v113
  v_exp_f32 v177, v177
  v_exp_f32 v178, v178
  v_mfma_f32_32x32x8_bf16 v[160:175], a[54:55], v[20:21], v[160:175]
  buffer_load_dwordx4 v1, s[4:7], s32 offen offset:1024 lds
  v_max3_f32 v25, v25, v114, v115
  v_exp_f32 v179, v179
  v_exp_f32 v180, v180
  v_max3_f32 v24, v24, v116, v117
  v_exp_f32 v181, v181
  s_waitcnt lgkmcnt(3)
  v_mfma_f32_32x32x16_bf16 v[208:223], a[76:79], v[192:195], v[208:223]
  buffer_load_dwordx4 a[160:163], v1, s[4:7], s33 offen offset:1024
  v_exp_f32 v182, v182
  v_max3_f32 v25, v25, v118, v119
  v_exp_f32 v183, v183
  v_exp_f32 v184, v184
  v_max3_f32 v24, v24, v120, v121
  s_waitcnt lgkmcnt(2)
  v_mfma_f32_32x32x16_bf16 v[208:223], a[80:83], v[196:199], v[208:223]
  buffer_load_dwordx4 a[164:167], v1, s[4:7], s33 offen offset:2048
  v_exp_f32 v185, v185
  v_exp_f32 v186, v186
  v_max3_f32 v25, v25, v122, v123
  v_exp_f32 v187, v187
  v_exp_f32 v188, v188
  v_mfma_f32_32x32x16_bf16 v[128:143], a[36:39], a[64:67], v[80:95]
  v_max3_f32 v24, v24, v124, v125
  v_exp_f32 v189, v189
  v_exp_f32 v190, v190
  v_max3_f32 v25, v25, v126, v127
  v_exp_f32 v191, v191
  v_mfma_f32_32x32x8_bf16 v[128:143], a[58:59], v[18:19], v[128:143]
  v_cvt_pk_bf16_f32 v200, v176, v177
  v_cvt_pk_bf16_f32 v201, v178, v179
  v_cvt_pk_bf16_f32 v202, v180, v181
  v_cvt_pk_bf16_f32 v203, v182, v183
  v_cvt_pk_bf16_f32 v204, v184, v185
  v_cvt_pk_bf16_f32 v205, v186, v187
  v_cvt_pk_bf16_f32 v206, v188, v189
  v_cvt_pk_bf16_f32 v207, v190, v191
  v_mfma_f32_32x32x16_bf16 v[176:191], a[32:35], a[60:63], v[80:95]
  ds_read_b128 a[68:71], v52 offset:36864
  ds_read_b128 a[72:75], v52 offset:37888
  v_exp_f32 v144, v144
  v_max3_f32 v24, v24, v128, v129
  v_exp_f32 v145, v145
  v_exp_f32 v146, v146
  v_max3_f32 v25, v25, v130, v131
  v_exp_f32 v147, v147
  v_exp_f32 v148, v148
  v_max3_f32 v24, v24, v132, v133
  v_exp_f32 v149, v149
  v_mfma_f32_32x32x8_bf16 v[176:191], a[56:57], v[20:21], v[176:191]
  buffer_load_dwordx4 a[168:171], v1, s[4:7], s33 offen offset:3072
  v_exp_f32 v150, v150
  v_max3_f32 v25, v25, v134, v135
  v_exp_f32 v151, v151
  v_exp_f32 v152, v152
  v_max3_f32 v24, v24, v136, v137
  v_exp_f32 v153, v153
  v_exp_f32 v154, v154
  v_max3_f32 v25, v25, v138, v139
  v_exp_f32 v155, v155
  s_waitcnt lgkmcnt(3)
  v_mfma_f32_32x32x16_bf16 v[208:223], a[84:87], v[200:203], v[208:223]
  buffer_load_dwordx4 v1, s[4:7], s32 offen offset:2048 lds
  v_exp_f32 v156, v156
  v_max3_f32 v24, v24, v140, v141
  v_exp_f32 v157, v157
  v_exp_f32 v158, v158
  v_max3_f32 v25, v25, v142, v143
  v_exp_f32 v159, v159
  v_cvt_pk_bf16_f32 v192, v144, v145
  v_cvt_pk_bf16_f32 v193, v146, v147
  v_cvt_pk_bf16_f32 v194, v148, v149
  v_cvt_pk_bf16_f32 v195, v150, v151
  s_waitcnt lgkmcnt(2)
  v_mfma_f32_32x32x16_bf16 v[208:223], a[88:91], v[204:207], v[208:223]
  s_add_u32 s33, s24, 20480
  buffer_load_dwordx4 a[172:175], v1, s[4:7], s33 offen
  v_cvt_pk_bf16_f32 v196, v152, v153
  v_cvt_pk_bf16_f32 v197, v154, v155
  v_cvt_pk_bf16_f32 v198, v156, v157
  v_cvt_pk_bf16_f32 v199, v158, v159
  v_max_f32 v24, v24, v25
  v_mov_b32 v25, v24
  s_nop 1
  v_permlane32_swap_b32 v24, v25
  v_max_f32 v24, v24, v25
  v_cvt_pk_bf16_f32 v26, 1.0, -v24
  v_and_b32 v27, 0xffff0000, v26
  v_sub_f32 v27, -v24, v27
  v_cvt_pk_bf16_f32 v27, v27, 0
  v_cndmask_b32 v22, v26, v18, s[52:53]
  v_cndmask_b32 v23, v27, v19, s[52:53]
  v_mfma_f32_32x32x16_bf16 v[144:159], a[4:7], a[64:67], v[64:79]
  ds_read_b128 a[76:79], v52 offset:38912
  ds_read_b128 a[80:83], v52 offset:39936
  v_exp_f32 v160, v160
  v_exp_f32 v161, v161
  v_exp_f32 v162, v162
  v_exp_f32 v163, v163
  v_exp_f32 v164, v164
  v_mfma_f32_32x32x8_bf16 v[144:159], a[42:43], v[22:23], v[144:159]
  buffer_load_dwordx4 a[176:179], v1, s[4:7], s33 offen offset:1024
  v_exp_f32 v165, v165
  v_exp_f32 v166, v166
  v_exp_f32 v167, v167
  v_exp_f32 v168, v168
  v_exp_f32 v169, v169
  s_waitcnt lgkmcnt(3)
  v_mfma_f32_32x32x16_bf16 v[208:223], a[68:71], v[192:195], v[208:223]
  buffer_load_dwordx4 v1, s[4:7], s32 offen offset:3072 lds
  v_exp_f32 v170, v170
  v_exp_f32 v171, v171
  v_exp_f32 v172, v172
  v_exp_f32 v173, v173
  v_exp_f32 v174, v174
  s_waitcnt lgkmcnt(2)
  v_mfma_f32_32x32x16_bf16 v[208:223], a[72:75], v[196:199], v[208:223]
  buffer_load_dwordx4 a[180:183], v1, s[4:7], s33 offen offset:2048
  v_exp_f32 v175, v175
  v_cvt_pk_bf16_f32 v200, v160, v161
  v_cvt_pk_bf16_f32 v201, v162, v163
  v_cvt_pk_bf16_f32 v202, v164, v165
  v_cvt_pk_bf16_f32 v203, v166, v167
  v_cvt_pk_bf16_f32 v204, v168, v169
  v_cvt_pk_bf16_f32 v205, v170, v171
  v_cvt_pk_bf16_f32 v206, v172, v173
  v_cvt_pk_bf16_f32 v207, v174, v175
  v_mfma_f32_32x32x16_bf16 v[160:175], a[8:11], a[64:67], 0
  ds_read_b128 a[84:87], v52 offset:40960
  ds_read_b128 a[88:91], v52 offset:41984
  v_exp_f32 v176, v176
  v_exp_f32 v177, v177
  v_exp_f32 v178, v178
  v_exp_f32 v179, v179
  v_exp_f32 v180, v180
  v_mfma_f32_32x32x8_bf16 v[160:175], a[44:45], v[22:23], v[160:175]
  buffer_load_dwordx4 a[184:187], v1, s[4:7], s33 offen offset:3072
  v_exp_f32 v181, v181
  v_exp_f32 v182, v182
  v_exp_f32 v183, v183
  v_exp_f32 v184, v184
  v_exp_f32 v185, v185
  v_exp_f32 v186, v186
  s_waitcnt lgkmcnt(3)
  v_mfma_f32_32x32x16_bf16 v[208:223], a[76:79], v[200:203], v[208:223]
  s_add_u32 m0, s26, 114688
  s_add_u32 s32, s23, 12288
  buffer_load_dwordx4 v1, s[4:7], s32 offen offset:0 lds
  v_exp_f32 v187, v187
  v_exp_f32 v188, v188
  v_exp_f32 v189, v189
  v_exp_f32 v190, v190
  s_waitcnt lgkmcnt(2)
  v_mfma_f32_32x32x16_bf16 v[208:223], a[80:83], v[204:207], v[208:223]
  s_add_u32 s33, s24, 24576
  buffer_load_dwordx4 a[188:191], v1, s[4:7], s33 offen
  v_exp_f32 v191, v191
  v_cvt_pk_bf16_f32 v192, v176, v177
  v_cvt_pk_bf16_f32 v193, v178, v179
  v_cvt_pk_bf16_f32 v194, v180, v181
  v_cvt_pk_bf16_f32 v195, v182, v183
  v_cvt_pk_bf16_f32 v196, v184, v185
  v_cvt_pk_bf16_f32 v197, v186, v187
  v_cvt_pk_bf16_f32 v198, v188, v189
  v_cvt_pk_bf16_f32 v199, v190, v191
  v_mfma_f32_32x32x16_bf16 v[176:191], a[12:15], a[64:67], 0
  ds_read_b128 a[68:71], v52 offset:26624
  ds_read_b128 a[72:75], v52 offset:27648
  v_exp_f32 v144, v144
  v_exp_f32 v145, v145
  v_exp_f32 v146, v146
  v_exp_f32 v147, v147
  v_exp_f32 v148, v148
  v_mfma_f32_32x32x8_bf16 v[176:191], a[46:47], v[22:23], v[176:191]
  buffer_load_dwordx4 a[208:211], v1, s[4:7], s25 offen
  v_exp_f32 v149, v149
  v_exp_f32 v150, v150
  v_exp_f32 v151, v151
  v_exp_f32 v152, v152
  v_exp_f32 v153, v153
  s_waitcnt lgkmcnt(3)
  v_mfma_f32_32x32x16_bf16 v[208:223], a[84:87], v[192:195], v[208:223]
  buffer_load_dwordx4 v1, s[4:7], s32 offen offset:1024 lds
  v_exp_f32 v154, v154
  v_exp_f32 v155, v155
  v_exp_f32 v156, v156
  v_exp_f32 v157, v157
  v_exp_f32 v158, v158
  s_waitcnt lgkmcnt(2)
  v_mfma_f32_32x32x16_bf16 v[208:223], a[88:91], v[196:199], v[208:223]
  buffer_load_dwordx4 a[212:215], v1, s[4:7], s25 offen offset:1024
  v_exp_f32 v159, v159
  v_cvt_pk_bf16_f32 v200, v144, v145
  v_cvt_pk_bf16_f32 v201, v146, v147
  v_cvt_pk_bf16_f32 v202, v148, v149
  v_cvt_pk_bf16_f32 v203, v150, v151
  v_cvt_pk_bf16_f32 v204, v152, v153
  v_cvt_pk_bf16_f32 v205, v154, v155
  v_cvt_pk_bf16_f32 v206, v156, v157
  v_cvt_pk_bf16_f32 v207, v158, v159
  v_mfma_f32_32x32x16_bf16 v[144:159], a[16:19], a[64:67], 0
  ds_read_b128 a[76:79], v52 offset:28672
  ds_read_b128 a[80:83], v52 offset:29696
  v_exp_f32 v160, v160
  v_exp_f32 v161, v161
  v_exp_f32 v162, v162
  v_exp_f32 v163, v163
  v_exp_f32 v164, v164
  v_mfma_f32_32x32x8_bf16 v[144:159], a[48:49], v[22:23], v[144:159]
  buffer_load_dwordx4 a[216:219], v1, s[4:7], s25 offen offset:2048
  v_exp_f32 v165, v165
  v_exp_f32 v166, v166
  v_exp_f32 v167, v167
  v_exp_f32 v168, v168
  v_exp_f32 v169, v169
  s_waitcnt lgkmcnt(3)
  v_mfma_f32_32x32x16_bf16 v[224:239], a[68:71], v[200:203], 0
  buffer_load_dwordx4 v1, s[4:7], s32 offen offset:2048 lds
  v_exp_f32 v170, v170
  v_exp_f32 v171, v171
  v_exp_f32 v172, v172
  v_exp_f32 v173, v173
  v_exp_f32 v174, v174
  s_waitcnt lgkmcnt(2)
  v_mfma_f32_32x32x16_bf16 v[224:239], a[72:75], v[204:207], v[224:239]
  buffer_load_dwordx4 a[220:223], v1, s[4:7], s25 offen offset:3072
  v_exp_f32 v175, v175
  v_cvt_pk_bf16_f32 v192, v160, v161
  v_cvt_pk_bf16_f32 v193, v162, v163
  v_cvt_pk_bf16_f32 v194, v164, v165
  v_cvt_pk_bf16_f32 v195, v166, v167
  v_cvt_pk_bf16_f32 v196, v168, v169
  v_cvt_pk_bf16_f32 v197, v170, v171
  v_cvt_pk_bf16_f32 v198, v172, v173
  v_cvt_pk_bf16_f32 v199, v174, v175
  v_mfma_f32_32x32x16_bf16 v[160:175], a[20:23], a[64:67], 0
  ds_read_b128 a[84:87], v52 offset:30720
  ds_read_b128 a[88:91], v52 offset:31744
  v_exp_f32 v176, v176
  v_exp_f32 v177, v177
  v_exp_f32 v178, v178
  v_exp_f32 v179, v179
  v_cndmask_b32 v28, v216, v220, s[52:53]
  v_rcp_f32 v28, v28
  s_nop 0
  v_mul_f32 v208, v28, v208
  v_mul_f32 v209, v28, v209
  v_mul_f32 v210, v28, v210
  v_mul_f32 v211, v28, v211
  v_mul_f32 v212, v28, v212
  v_mfma_f32_32x32x8_bf16 v[160:175], a[50:51], v[22:23], v[160:175]
  s_add_u32 s33, s25, 4096
  buffer_load_dwordx4 a[224:227], v1, s[4:7], s33 offen
  v_mul_f32 v213, v28, v213
  v_mul_f32 v214, v28, v214
  v_mul_f32 v215, v28, v215
  v_mul_f32 v216, v28, v216
  v_mul_f32 v217, v28, v217
  v_mul_f32 v218, v28, v218
  v_mul_f32 v219, v28, v219
  v_cvt_pk_bf16_f32 v240, v208, v209
  v_cvt_pk_bf16_f32 v241, v210, v211
  v_cvt_pk_bf16_f32 v242, v212, v213
  v_cvt_pk_bf16_f32 v243, v214, v215
  v_cvt_pk_bf16_f32 v244, v216, v217
  v_cvt_pk_bf16_f32 v245, v218, v219
  s_waitcnt lgkmcnt(3)
  v_mfma_f32_32x32x16_bf16 v[224:239], a[76:79], v[192:195], v[224:239]
  buffer_store_dwordx4 v[240:243], v32, s[4:7], s46 offen
  buffer_store_dwordx2 v[244:245], v36, s[4:7], s46 offen
  buffer_load_dwordx4 v1, s[4:7], s32 offen offset:3072 lds
  v_exp_f32 v180, v180
  v_exp_f32 v181, v181
  v_exp_f32 v182, v182
  v_exp_f32 v183, v183
  v_exp_f32 v184, v184
  v_exp_f32 v185, v185
  v_exp_f32 v186, v186
  v_exp_f32 v187, v187
  s_waitcnt lgkmcnt(2)
  v_mfma_f32_32x32x16_bf16 v[224:239], a[80:83], v[196:199], v[224:239]
  buffer_load_dwordx4 a[228:231], v1, s[4:7], s33 offen offset:1024
  v_exp_f32 v188, v188
  v_exp_f32 v189, v189
  v_exp_f32 v190, v190
  v_exp_f32 v191, v191
  v_cvt_pk_bf16_f32 v200, v176, v177
  v_cvt_pk_bf16_f32 v201, v178, v179
  v_cvt_pk_bf16_f32 v202, v180, v181
  v_cvt_pk_bf16_f32 v203, v182, v183
  v_cvt_pk_bf16_f32 v204, v184, v185
  v_cvt_pk_bf16_f32 v205, v186, v187
  v_cvt_pk_bf16_f32 v206, v188, v189
  v_cvt_pk_bf16_f32 v207, v190, v191
  v_mfma_f32_32x32x16_bf16 v[176:191], a[24:27], a[64:67], 0
  ds_read_b128 a[68:71], v52 offset:32768
  ds_read_b128 a[72:75], v52 offset:33792
  v_exp_f32 v144, v144
  v_exp_f32 v145, v145
  v_exp_f32 v146, v146
  v_exp_f32 v147, v147
  v_exp_f32 v148, v148
  v_mfma_f32_32x32x8_bf16 v[176:191], a[52:53], v[22:23], v[176:191]
  buffer_load_dwordx4 a[232:235], v1, s[4:7], s33 offen offset:2048
  v_exp_f32 v149, v149
  v_exp_f32 v150, v150
  v_exp_f32 v151, v151
  v_exp_f32 v152, v152
  v_exp_f32 v153, v153
  v_exp_f32 v154, v154
  s_waitcnt lgkmcnt(3)
  v_mfma_f32_32x32x16_bf16 v[224:239], a[84:87], v[200:203], v[224:239]
  s_add_u32 m0, s26, 131072
  s_add_u32 s32, s23, 16384
  buffer_load_dwordx4 v1, s[4:7], s32 offen offset:0 lds
  v_exp_f32 v155, v155
  v_exp_f32 v156, v156
  v_exp_f32 v157, v157
  v_exp_f32 v158, v158
  s_waitcnt lgkmcnt(2)
  v_mfma_f32_32x32x16_bf16 v[224:239], a[88:91], v[204:207], v[224:239]
  buffer_load_dwordx4 a[236:239], v1, s[4:7], s33 offen offset:3072
  v_exp_f32 v159, v159
  v_cvt_pk_bf16_f32 v192, v144, v145
  v_cvt_pk_bf16_f32 v193, v146, v147
  v_cvt_pk_bf16_f32 v194, v148, v149
  v_cvt_pk_bf16_f32 v195, v150, v151
  v_cvt_pk_bf16_f32 v196, v152, v153
  v_cvt_pk_bf16_f32 v197, v154, v155
  v_cvt_pk_bf16_f32 v198, v156, v157
  v_cvt_pk_bf16_f32 v199, v158, v159
  v_mfma_f32_32x32x16_bf16 v[144:159], a[28:31], a[64:67], 0
  ds_read_b128 a[76:79], v52 offset:34816
  ds_read_b128 a[80:83], v52 offset:35840
  v_exp_f32 v160, v160
  v_exp_f32 v161, v161
  v_exp_f32 v162, v162
  v_exp_f32 v163, v163
  v_exp_f32 v164, v164
  v_mfma_f32_32x32x8_bf16 v[144:159], a[54:55], v[22:23], v[144:159]
  s_add_u32 s33, s25, 8192
  buffer_load_dwordx4 a[240:243], v1, s[4:7], s33 offen
  v_exp_f32 v165, v165
  v_exp_f32 v166, v166
  v_exp_f32 v167, v167
  v_exp_f32 v168, v168
  v_exp_f32 v169, v169
  s_waitcnt lgkmcnt(3)
  v_mfma_f32_32x32x16_bf16 v[224:239], a[68:71], v[192:195], v[224:239]
  buffer_load_dwordx4 v1, s[4:7], s32 offen offset:1024 lds
  v_exp_f32 v170, v170
  v_exp_f32 v171, v171
  v_exp_f32 v172, v172
  v_exp_f32 v173, v173
  v_exp_f32 v174, v174
  s_waitcnt lgkmcnt(2)
  v_mfma_f32_32x32x16_bf16 v[224:239], a[72:75], v[196:199], v[224:239]
  buffer_load_dwordx4 a[244:247], v1, s[4:7], s33 offen offset:1024
  v_exp_f32 v175, v175
  v_cvt_pk_bf16_f32 v200, v160, v161
  v_cvt_pk_bf16_f32 v201, v162, v163
  v_cvt_pk_bf16_f32 v202, v164, v165
  v_cvt_pk_bf16_f32 v203, v166, v167
  v_cvt_pk_bf16_f32 v204, v168, v169
  v_cvt_pk_bf16_f32 v205, v170, v171
  v_cvt_pk_bf16_f32 v206, v172, v173
  v_cvt_pk_bf16_f32 v207, v174, v175
  v_mfma_f32_32x32x16_bf16 v[160:175], a[32:35], a[64:67], 0
  ds_read_b128 a[84:87], v52 offset:36864
  ds_read_b128 a[88:91], v52 offset:37888
  v_exp_f32 v176, v176
  v_exp_f32 v177, v177
  v_exp_f32 v178, v178
  v_exp_f32 v179, v179
  v_exp_f32 v180, v180
  v_mfma_f32_32x32x8_bf16 v[160:175], a[56:57], v[22:23], v[160:175]
  buffer_load_dwordx4 a[248:251], v1, s[4:7], s33 offen offset:2048
  v_exp_f32 v181, v181
  v_exp_f32 v182, v182
  v_exp_f32 v183, v183
  v_exp_f32 v184, v184
  v_exp_f32 v185, v185
  s_waitcnt lgkmcnt(3)
  v_mfma_f32_32x32x16_bf16 v[224:239], a[76:79], v[200:203], v[224:239]
  buffer_load_dwordx4 v1, s[4:7], s32 offen offset:2048 lds
  v_exp_f32 v186, v186
  v_exp_f32 v187, v187
  v_exp_f32 v188, v188
  v_exp_f32 v189, v189
  v_exp_f32 v190, v190
  s_waitcnt lgkmcnt(2)
  v_mfma_f32_32x32x16_bf16 v[224:239], a[80:83], v[204:207], v[224:239]
  buffer_load_dwordx4 a[252:255], v1, s[4:7], s33 offen offset:3072
  v_exp_f32 v191, v191
  v_cvt_pk_bf16_f32 v192, v176, v177
  v_cvt_pk_bf16_f32 v193, v178, v179
  v_cvt_pk_bf16_f32 v194, v180, v181
  v_cvt_pk_bf16_f32 v195, v182, v183
  v_cvt_pk_bf16_f32 v196, v184, v185
  v_cvt_pk_bf16_f32 v197, v186, v187
  v_cvt_pk_bf16_f32 v198, v188, v189
  v_cvt_pk_bf16_f32 v199, v190, v191
  v_mfma_f32_32x32x16_bf16 v[176:191], a[36:39], a[64:67], v[80:95]
  ds_read_b128 a[68:71], v52 offset:38912
  ds_read_b128 a[72:75], v52 offset:39936
  v_exp_f32 v144, v144
  v_exp_f32 v145, v145
  v_exp_f32 v146, v146
  v_exp_f32 v147, v147
  v_exp_f32 v148, v148
  v_exp_f32 v149, v149
  v_exp_f32 v150, v150
  v_mfma_f32_32x32x8_bf16 v[176:191], a[58:59], v[22:23], v[176:191]
  buffer_load_dword a192, v53, s[4:7], s75 offen
  s_add_u32 s69, s75, 21504
  buffer_load_dword a193, v53, s[4:7], s69 offen
  s_add_u32 s69, s75, 43008
  buffer_load_dword a194, v53, s[4:7], s69 offen
  s_add_u32 s69, s75, 64512
  buffer_load_dword a195, v53, s[4:7], s69 offen
  s_add_u32 s69, s75, 86016
  buffer_load_dword a196, v53, s[4:7], s69 offen
  v_exp_f32 v151, v151
  v_exp_f32 v152, v152
  v_exp_f32 v153, v153
  s_waitcnt lgkmcnt(3)
  v_mfma_f32_32x32x16_bf16 v[224:239], a[84:87], v[192:195], v[224:239]
  buffer_load_dwordx4 v1, s[4:7], s32 offen offset:3072 lds
  v_exp_f32 v154, v154
  v_exp_f32 v155, v155
  v_exp_f32 v156, v156
  v_exp_f32 v157, v157
  v_exp_f32 v158, v158
  v_exp_f32 v159, v159
  v_cvt_pk_bf16_f32 v200, v144, v145
  v_cvt_pk_bf16_f32 v201, v146, v147
  s_waitcnt lgkmcnt(2)
  v_mfma_f32_32x32x16_bf16 v[224:239], a[88:91], v[196:199], v[224:239]
  buffer_load_dword a197, v53, s[4:7], s76 offen
  s_add_u32 s69, s76, 21504
  buffer_load_dword a198, v53, s[4:7], s69 offen
  s_add_u32 s69, s76, 43008
  buffer_load_dword a199, v53, s[4:7], s69 offen
  s_add_u32 s69, s76, 64512
  buffer_load_dword a200, v53, s[4:7], s69 offen
  s_add_u32 s69, s76, 86016
  buffer_load_dword a201, v53, s[4:7], s69 offen
  v_cvt_pk_bf16_f32 v202, v148, v149
  v_cvt_pk_bf16_f32 v203, v150, v151
  v_cvt_pk_bf16_f32 v204, v152, v153
  v_cvt_pk_bf16_f32 v205, v154, v155
  v_cvt_pk_bf16_f32 v206, v156, v157
  v_cvt_pk_bf16_f32 v207, v158, v159
  s_waitcnt lgkmcnt(1)
  v_mfma_f32_32x32x16_bf16 v[224:239], a[68:71], v[200:203], v[224:239]
  ds_read_b128 a[76:79], v52 offset:40960
  ds_read_b128 a[80:83], v52 offset:41984
  v_exp_f32 v160, v160
  v_exp_f32 v161, v161
  v_exp_f32 v162, v162
  v_exp_f32 v163, v163
  v_exp_f32 v164, v164
  v_exp_f32 v165, v165
  v_exp_f32 v166, v166
  v_exp_f32 v167, v167
  v_exp_f32 v168, v168
  v_exp_f32 v169, v169
  v_exp_f32 v170, v170
  v_exp_f32 v171, v171
  v_exp_f32 v172, v172
  v_exp_f32 v173, v173
  s_waitcnt lgkmcnt(2)
  v_mfma_f32_32x32x16_bf16 v[224:239], a[72:75], v[204:207], v[224:239]
  buffer_load_dword a202, v53, s[4:7], s77 offen
  s_add_u32 s69, s77, 21504
  buffer_load_dword a203, v53, s[4:7], s69 offen
  s_add_u32 s69, s77, 43008
  buffer_load_dword a204, v53, s[4:7], s69 offen
  s_add_u32 s69, s77, 64512
  buffer_load_dword a205, v53, s[4:7], s69 offen
  s_add_u32 s69, s77, 86016
  buffer_load_dword a206, v53, s[4:7], s69 offen
  v_exp_f32 v174, v174
  v_exp_f32 v175, v175
  v_cvt_pk_bf16_f32 v192, v160, v161
  v_cvt_pk_bf16_f32 v193, v162, v163
  v_cvt_pk_bf16_f32 v194, v164, v165
  v_cvt_pk_bf16_f32 v195, v166, v167
  v_cvt_pk_bf16_f32 v196, v168, v169
  v_cvt_pk_bf16_f32 v197, v170, v171
  v_cvt_pk_bf16_f32 v198, v172, v173
  v_cvt_pk_bf16_f32 v199, v174, v175
  s_add_u32 s58, s21, 2048
  s_lshl_b32 s59, s17, 2
  s_add_u32 s58, s58, s59
  s_add_u32 s58, s58, s18
  v_mov_b32 v14, 1
  v_mov_b32 v15, 0
  s_waitcnt lgkmcnt(1)
  v_mfma_f32_32x32x16_bf16 v[224:239], a[76:79], v[192:195], v[224:239]
  ds_read_b128 a[84:87], v52 offset:43008
  ds_read_b128 a[88:91], v52 offset:44032
  v_exp_f32 v176, v176
  v_exp_f32 v177, v177
  v_exp_f32 v178, v178
  v_exp_f32 v179, v179
  v_exp_f32 v180, v180
  v_exp_f32 v181, v181
  v_exp_f32 v182, v182
  v_exp_f32 v183, v183
  v_exp_f32 v184, v184
  v_exp_f32 v185, v185
  s_waitcnt lgkmcnt(2)
  v_mfma_f32_32x32x16_bf16 v[224:239], a[80:83], v[196:199], v[224:239]
  v_exp_f32 v186, v186
  v_exp_f32 v187, v187
  v_exp_f32 v188, v188
  v_exp_f32 v189, v189
  v_exp_f32 v190, v190
  v_exp_f32 v191, v191
  v_cvt_pk_bf16_f32 v200, v176, v177
  v_cvt_pk_bf16_f32 v201, v178, v179
  v_cvt_pk_bf16_f32 v202, v180, v181
  v_cvt_pk_bf16_f32 v203, v182, v183
  v_cvt_pk_bf16_f32 v204, v184, v185
  v_cvt_pk_bf16_f32 v205, v186, v187
  v_cvt_pk_bf16_f32 v206, v188, v189
  v_cvt_pk_bf16_f32 v207, v190, v191
  s_waitcnt lgkmcnt(1)
  v_mfma_f32_32x32x16_bf16 v[224:239], a[84:87], v[200:203], v[224:239]
  s_waitcnt lgkmcnt(0)
  v_mfma_f32_32x32x16_bf16 v[224:239], a[88:91], v[204:207], v[224:239]
  s_nop 11
  v_cndmask_b32 v28, v232, v236, s[52:53]
  v_rcp_f32 v28, v28
  s_nop 0
  v_mov_b32 v29, v28
  v_pk_mul_f32 v[224:225], v[224:225], v[28:29]
  v_pk_mul_f32 v[226:227], v[226:227], v[28:29]
  v_pk_mul_f32 v[228:229], v[228:229], v[28:29]
  v_pk_mul_f32 v[230:231], v[230:231], v[28:29]
  v_pk_mul_f32 v[232:233], v[232:233], v[28:29]
  v_pk_mul_f32 v[234:235], v[234:235], v[28:29]
  v_cvt_pk_bf16_f32 v246, v224, v225
  v_cvt_pk_bf16_f32 v247, v226, v227
  v_cvt_pk_bf16_f32 v248, v228, v229
  v_cvt_pk_bf16_f32 v249, v230, v231
  v_cvt_pk_bf16_f32 v250, v232, v233
  v_cvt_pk_bf16_f32 v251, v234, v235
  s_add_u32 s46, s46, 40960
  buffer_store_dwordx4 v[246:249], v32, s[4:7], s46 offen
  buffer_store_dwordx2 v[250:251], v36, s[4:7], s46 offen
  s_waitcnt vmcnt(0) lgkmcnt(0)
  s_mov_b64 exec, 1
  buffer_store_byte v14, v15, s[4:7], s58 offen
  s_mov_b64 exec, -1
  s_barrier
  s_cmp_lg_u32 s20, 0
  s_cbranch_scc1 AUGB_17
  v_accvgpr_read_b32 v64, a192
  v_accvgpr_read_b32 v65, a193
  v_accvgpr_read_b32 v66, a194
  v_accvgpr_read_b32 v67, a195
  v_accvgpr_read_b32 v68, a196
  v_accvgpr_read_b32 v69, a197
  v_accvgpr_read_b32 v70, a198
  v_accvgpr_read_b32 v71, a199
  v_accvgpr_read_b32 v72, a200
  v_accvgpr_read_b32 v73, a201
  v_accvgpr_read_b32 v74, a202
  v_accvgpr_read_b32 v75, a203
  v_accvgpr_read_b32 v76, a204
  v_accvgpr_read_b32 v77, a205
  v_accvgpr_read_b32 v78, a206
  v_add_f32 v64, v64, v65
  v_add_f32 v66, v66, v67
  v_add_f32 v64, v64, v68
  v_mov_b32 v65, 0
  v_add_f32 v64, v64, v66
  v_add_f32 v69, v69, v70
  v_add_f32 v71, v71, v72
  v_add_f32 v69, v69, v73
  v_mov_b32 v70, 0
  v_add_f32 v69, v69, v71
  v_add_f32 v74, v74, v75
  v_add_f32 v76, v76, v77
  v_add_f32 v74, v74, v78
  v_mov_b32 v75, 0
  v_add_f32 v74, v74, v76
  v_permlane32_swap_b32 v64, v65
  v_permlane32_swap_b32 v69, v70
  v_permlane32_swap_b32 v74, v75
  v_add_f32 v64, v64, v65
  v_cvt_pk_bf16_f32 v66, v64, v64
  v_and_b32 v67, 0xffff0000, v66
  v_sub_f32 v67, v64, v67
  v_cvt_pk_bf16_f32 v80, v64, v67
  v_and_b32 v81, 0xffff, v66
  v_add_u32 v13, s72, v11
  ds_write_b64 v13, v[80:81]
  v_add_f32 v69, v69, v70
  v_cvt_pk_bf16_f32 v71, v69, v69
  v_and_b32 v72, 0xffff0000, v71
  v_sub_f32 v72, v69, v72
  v_cvt_pk_bf16_f32 v82, v69, v72
  v_and_b32 v83, 0xffff, v71
  v_add_u32 v13, s73, v11
  ds_write_b64 v13, v[82:83]
  v_add_f32 v74, v74, v75
  v_cvt_pk_bf16_f32 v76, v74, v74
  v_and_b32 v77, 0xffff0000, v76
  v_sub_f32 v77, v74, v77
  v_cvt_pk_bf16_f32 v84, v74, v77
  v_and_b32 v85, 0xffff, v76
  v_add_u32 v13, s74, v11
  ds_write_b64 v13, v[84:85]
  s_waitcnt lgkmcnt(0)
  s_nop 0
AUGB_17:
  s_add_u32 s36, s18, 0
  s_and_b32 s36, s36, 3
  s_lshr_b32 s37, s36, 1
  s_add_u32 s37, s37, s61
  s_mul_i32 s37, s37, 40960
  s_and_b32 s36, s36, 1
  s_lshl_b32 s36, s36, 8
  s_add_u32 s37, s37, s36
  s_lshl_b32 s36, s35, 11
  s_add_u32 s37, s37, s36
  s_add_u32 s40, s37, s19
  s_add_u32 s36, s18, 1
  s_and_b32 s36, s36, 3
  s_lshr_b32 s37, s36, 1
  s_add_u32 s37, s37, s61
  s_mul_i32 s37, s37, 40960
  s_and_b32 s36, s36, 1
  s_lshl_b32 s36, s36, 8
  s_add_u32 s37, s37, s36
  s_lshl_b32 s36, s35, 11
  s_add_u32 s37, s37, s36
  s_add_u32 s41, s37, s19
  s_add_u32 s36, s18, 2
  s_and_b32 s36, s36, 3
  s_lshr_b32 s37, s36, 1
  s_add_u32 s37, s37, s61
  s_mul_i32 s37, s37, 40960
  s_and_b32 s36, s36, 1
  s_lshl_b32 s36, s36, 8
  s_add_u32 s37, s37, s36
  s_lshl_b32 s36, s35, 11
  s_add_u32 s37, s37, s36
  s_add_u32 s42, s37, s19
  s_add_u32 s36, s18, 3
  s_and_b32 s36, s36, 3
  s_lshr_b32 s37, s36, 1
  s_add_u32 s37, s37, s61
  s_mul_i32 s37, s37, 40960
  s_and_b32 s36, s36, 1
  s_lshl_b32 s36, s36, 8
  s_add_u32 s37, s37, s36
  s_lshl_b32 s36, s35, 11
  s_add_u32 s37, s37, s36
  s_add_u32 s43, s37, s19
  s_lshr_b32 s38, s17, 3
  s_lshl_b32 s36, s18, 3
  s_lshl_b32 s39, s38, 3
  s_lshl_b32 s39, 1, s39
  v_subrev_u32 v13, s36, v0
  v_cmp_gt_u32 vcc, 8, v13
  v_mov_b32 v14, s39
  s_nop 0
  v_cndmask_b32 v13, 0, v14, vcc
  v_lshlrev_b32 v128, 16, v40
  v_and_b32 v129, 0xffff0000, v40
  v_lshlrev_b32 v130, 16, v41
  v_and_b32 v131, 0xffff0000, v41
  v_lshlrev_b32 v132, 16, v42
  v_and_b32 v133, 0xffff0000, v42
  v_lshlrev_b32 v134, 16, v43
  v_and_b32 v135, 0xffff0000, v43
  v_lshlrev_b32 v136, 16, v44
  v_and_b32 v137, 0xffff0000, v44
  v_lshlrev_b32 v138, 16, v45
  v_and_b32 v139, 0xffff0000, v45
  v_lshlrev_b32 v140, 16, v46
  v_and_b32 v141, 0xffff0000, v46
  v_lshlrev_b32 v142, 16, v47
  v_and_b32 v143, 0xffff0000, v47
  v_lshlrev_b32 v144, 16, v48
  v_and_b32 v145, 0xffff0000, v48
  v_lshlrev_b32 v146, 16, v49
  v_and_b32 v147, 0xffff0000, v49
  s_add_u32 s36, s18, 1
  s_and_b32 s36, s36, 3
  s_mul_i32 s36, s36, 15360
  s_add_u32 s36, s36, 0
  v_add_u32 v237, s36, v1
  s_add_u32 s36, s18, 2
  s_and_b32 s36, s36, 3
  s_mul_i32 s36, s36, 15360
  s_add_u32 s36, s36, 5120
  v_add_u32 v238, s36, v1
  s_add_u32 s36, s18, 3
  s_and_b32 s36, s36, 3
  s_mul_i32 s36, s36, 15360
  s_add_u32 s36, s36, 10240
  v_add_u32 v239, s36, v1
  s_mul_i32 s36, s18, 15360
  v_add_u32 v236, s36, v1
  s_add_u32 s48, s63, s65
  v_mov_b32 v240, v9
  v_add_u32 v241, 2048, v9
  v_mov_b32 v242, v10
  v_lshlrev_b32 v243, 3, v6
  v_cmp_gt_u32 s[54:55], 16, v0
  s_nop 0
  s_nop 0
  v_cndmask_b32 v243, v8, v243, s[54:55]
  v_lshlrev_b32 v12, 2, v4
  s_add_u32 s58, s21, 2048
  s_mov_b32 s59, 0
  s_nop 0
POLL_18:
  buffer_load_dword v14, v12, s[4:7], s58 offen sc1
  s_add_u32 s59, s59, 1
  s_waitcnt vmcnt(0)
  v_and_b32 v14, v14, v13
  v_cmp_ne_u32 vcc, v14, v13
  s_cmp_ge_u32 s59, 60000
  s_cbranch_scc1 POLLD_19
  s_nop 0
  s_cbranch_vccnz POLL_18
POLLD_19:
  buffer_load_dwordx4 a[0:3], v9, s[4:7], s41 offen sc1
  buffer_load_dwordx4 a[4:7], v9, s[4:7], s41 offen offset:2048 sc1
  s_add_u32 s45, s41, 4096
  buffer_load_dwordx4 a[8:11], v9, s[4:7], s45 offen sc1
  buffer_load_dwordx4 a[12:15], v9, s[4:7], s45 offen offset:2048 sc1
  s_add_u32 s45, s41, 8192
  buffer_load_dwordx4 a[16:19], v9, s[4:7], s45 offen sc1
  buffer_load_dwordx4 a[20:23], v9, s[4:7], s42 offen sc1
  buffer_load_dwordx4 a[24:27], v9, s[4:7], s42 offen offset:2048 sc1
  s_add_u32 s46, s42, 4096
  buffer_load_dwordx4 a[28:31], v9, s[4:7], s46 offen sc1
  s_waitcnt vmcnt(7)
  v_mfma_f32_16x16x32_bf16 v[148:151], a[92:95], a[0:3], 0
  buffer_load_dwordx4 a[32:35], v9, s[4:7], s46 offen offset:2048 sc1
  v_mfma_f32_16x16x32_bf16 v[152:155], a[96:99], a[0:3], 0
  v_mfma_f32_16x16x32_bf16 v[156:159], a[100:103], a[0:3], 0
  v_mfma_f32_16x16x32_bf16 v[160:163], a[104:107], a[0:3], 0
  v_mfma_f32_16x16x32_bf16 v[164:167], a[108:111], a[0:3], 0
  s_waitcnt vmcnt(7)
  v_mfma_f32_16x16x32_bf16 v[148:151], a[112:115], a[4:7], v[148:151]
  s_add_u32 s46, s42, 8192
  buffer_load_dwordx4 a[36:39], v9, s[4:7], s46 offen sc1
  v_mfma_f32_16x16x32_bf16 v[152:155], a[116:119], a[4:7], v[152:155]
  buffer_load_dwordx4 a[40:43], v9, s[4:7], s43 offen sc1
  v_mfma_f32_16x16x32_bf16 v[156:159], a[120:123], a[4:7], v[156:159]
  v_mfma_f32_16x16x32_bf16 v[160:163], a[124:127], a[4:7], v[160:163]
  v_mfma_f32_16x16x32_bf16 v[164:167], a[128:131], a[4:7], v[164:167]
  s_waitcnt vmcnt(8)
  v_mfma_f32_16x16x32_bf16 v[148:151], a[132:135], a[8:11], v[148:151]
  buffer_load_dwordx4 a[44:47], v9, s[4:7], s43 offen offset:2048 sc1
  v_mfma_f32_16x16x32_bf16 v[152:155], a[136:139], a[8:11], v[152:155]
  v_mfma_f32_16x16x32_bf16 v[156:159], a[140:143], a[8:11], v[156:159]
  v_mfma_f32_16x16x32_bf16 v[160:163], a[144:147], a[8:11], v[160:163]
  v_mfma_f32_16x16x32_bf16 v[164:167], a[148:151], a[8:11], v[164:167]
  s_waitcnt vmcnt(8)
  v_mfma_f32_16x16x32_bf16 v[148:151], a[152:155], a[12:15], v[148:151]
  s_add_u32 s47, s43, 4096
  buffer_load_dwordx4 a[48:51], v9, s[4:7], s47 offen sc1
  v_mfma_f32_16x16x32_bf16 v[152:155], a[156:159], a[12:15], v[152:155]
  buffer_load_dwordx4 a[52:55], v9, s[4:7], s47 offen offset:2048 sc1
  v_mfma_f32_16x16x32_bf16 v[156:159], a[160:163], a[12:15], v[156:159]
  v_mfma_f32_16x16x32_bf16 v[160:163], a[164:167], a[12:15], v[160:163]
  v_mfma_f32_16x16x32_bf16 v[164:167], a[168:171], a[12:15], v[164:167]
  s_waitcnt vmcnt(9)
  v_mfma_f32_16x16x32_bf16 v[148:151], a[172:175], a[16:19], v[148:151]
  s_add_u32 s47, s43, 8192
  buffer_load_dwordx4 a[56:59], v9, s[4:7], s47 offen sc1
  v_mfma_f32_16x16x32_bf16 v[152:155], a[176:179], a[16:19], v[152:155]
  v_mfma_f32_16x16x32_bf16 v[156:159], a[180:183], a[16:19], v[156:159]
  v_mfma_f32_16x16x32_bf16 v[160:163], a[184:187], a[16:19], v[160:163]
  v_mfma_f32_16x16x32_bf16 v[164:167], a[188:191], a[16:19], v[164:167]
  s_waitcnt vmcnt(9)
  v_mfma_f32_16x16x32_bf16 v[168:171], a[92:95], a[20:23], 0
  buffer_load_dwordx4 a[60:63], v9, s[4:7], s40 offen sc1
  ds_write_b128 v237, v[148:151]
  v_mfma_f32_16x16x32_bf16 v[172:175], a[96:99], a[20:23], 0
  buffer_load_dwordx4 a[64:67], v9, s[4:7], s40 offen offset:2048 sc1
  v_mfma_f32_16x16x32_bf16 v[176:179], a[100:103], a[20:23], 0
  v_mfma_f32_16x16x32_bf16 v[180:183], a[104:107], a[20:23], 0
  ds_write_b128 v237, v[152:155] offset:1024
  v_mfma_f32_16x16x32_bf16 v[184:187], a[108:111], a[20:23], 0
  s_waitcnt vmcnt(10)
  v_mfma_f32_16x16x32_bf16 v[168:171], a[112:115], a[24:27], v[168:171]
  s_add_u32 s44, s40, 4096
  buffer_load_dwordx4 a[68:71], v9, s[4:7], s44 offen sc1
  v_mfma_f32_16x16x32_bf16 v[172:175], a[116:119], a[24:27], v[172:175]
  ds_write_b128 v237, v[156:159] offset:2048
  v_mfma_f32_16x16x32_bf16 v[176:179], a[120:123], a[24:27], v[176:179]
  v_mfma_f32_16x16x32_bf16 v[180:183], a[124:127], a[24:27], v[180:183]
  v_mfma_f32_16x16x32_bf16 v[184:187], a[128:131], a[24:27], v[184:187]
  ds_write_b128 v237, v[160:163] offset:3072
  s_waitcnt vmcnt(10)
  v_mfma_f32_16x16x32_bf16 v[168:171], a[132:135], a[28:31], v[168:171]
  buffer_load_dwordx4 a[72:75], v9, s[4:7], s44 offen offset:2048 sc1
  v_mfma_f32_16x16x32_bf16 v[172:175], a[136:139], a[28:31], v[172:175]
  s_add_u32 s44, s40, 8192
  buffer_load_dwordx4 a[76:79], v9, s[4:7], s44 offen sc1
  v_mfma_f32_16x16x32_bf16 v[176:179], a[140:143], a[28:31], v[176:179]
  ds_write_b128 v237, v[164:167] offset:4096
  v_mfma_f32_16x16x32_bf16 v[180:183], a[144:147], a[28:31], v[180:183]
  v_mfma_f32_16x16x32_bf16 v[184:187], a[148:151], a[28:31], v[184:187]
  s_waitcnt vmcnt(11)
  v_mfma_f32_16x16x32_bf16 v[168:171], a[152:155], a[32:35], v[168:171]
  s_add_u32 s33, s25, 12288
  buffer_load_dwordx4 v[16:19], v1, s[4:7], s33 offen
  s_add_u32 s58, s21, 3072
  v_mfma_f32_16x16x32_bf16 v[172:175], a[156:159], a[32:35], v[172:175]
  s_lshl_b32 s59, s17, 2
  s_add_u32 s58, s58, s59
  v_mfma_f32_16x16x32_bf16 v[176:179], a[160:163], a[32:35], v[176:179]
  s_add_u32 s58, s58, s18
  v_mov_b32 v14, 1
  v_mfma_f32_16x16x32_bf16 v[180:183], a[164:167], a[32:35], v[180:183]
  v_mov_b32 v15, 0
  s_mov_b32 s37, 0x3f803f80
  v_mfma_f32_16x16x32_bf16 v[184:187], a[168:171], a[32:35], v[184:187]
  v_mov_b32 v244, 0
  v_mov_b32 v245, 0
  s_waitcnt vmcnt(11)
  v_mfma_f32_16x16x32_bf16 v[168:171], a[172:175], a[36:39], v[168:171]
  buffer_load_dwordx4 v[20:23], v1, s[4:7], s33 offen offset:1024
  v_mov_b32 v246, 0
  v_mfma_f32_16x16x32_bf16 v[172:175], a[176:179], a[36:39], v[172:175]
  buffer_load_dwordx4 v[24:27], v1, s[4:7], s33 offen offset:2048
  v_mov_b32 v247, 0
  v_mfma_f32_16x16x32_bf16 v[176:179], a[180:183], a[36:39], v[176:179]
  v_mfma_f32_16x16x32_bf16 v[180:183], a[184:187], a[36:39], v[180:183]
  v_mfma_f32_16x16x32_bf16 v[184:187], a[188:191], a[36:39], v[184:187]
  s_waitcnt vmcnt(12)
  v_mfma_f32_16x16x32_bf16 v[188:191], a[92:95], a[40:43], 0
  buffer_load_dwordx4 v[28:31], v1, s[4:7], s33 offen offset:3072
  ds_write_b128 v238, v[168:171]
  v_mfma_f32_16x16x32_bf16 v[192:195], a[96:99], a[40:43], 0
  v_mfma_f32_16x16x32_bf16 v[196:199], a[100:103], a[40:43], 0
  v_mfma_f32_16x16x32_bf16 v[200:203], a[104:107], a[40:43], 0
  ds_write_b128 v238, v[172:175] offset:1024
  v_mfma_f32_16x16x32_bf16 v[204:207], a[108:111], a[40:43], 0
  s_waitcnt vmcnt(12)
  v_mfma_f32_16x16x32_bf16 v[188:191], a[112:115], a[44:47], v[188:191]
  s_add_u32 s33, s25, 16384
  buffer_load_dwordx4 v[32:35], v1, s[4:7], s33 offen
  v_mfma_f32_16x16x32_bf16 v[192:195], a[116:119], a[44:47], v[192:195]
  buffer_load_dwordx4 v[36:39], v1, s[4:7], s33 offen offset:1024
  ds_write_b128 v238, v[176:179] offset:2048
  v_mfma_f32_16x16x32_bf16 v[196:199], a[120:123], a[44:47], v[196:199]
  v_mfma_f32_16x16x32_bf16 v[200:203], a[124:127], a[44:47], v[200:203]
  v_mfma_f32_16x16x32_bf16 v[204:207], a[128:131], a[44:47], v[204:207]
  ds_write_b128 v238, v[180:183] offset:3072
  s_waitcnt vmcnt(13)
  v_mfma_f32_16x16x32_bf16 v[188:191], a[132:135], a[48:51], v[188:191]
  buffer_load_dwordx4 v[40:43], v1, s[4:7], s33 offen offset:2048
  v_mfma_f32_16x16x32_bf16 v[192:195], a[136:139], a[48:51], v[192:195]
  v_mfma_f32_16x16x32_bf16 v[196:199], a[140:143], a[48:51], v[196:199]
  ds_write_b128 v238, v[184:187] offset:4096
  v_mfma_f32_16x16x32_bf16 v[200:203], a[144:147], a[48:51], v[200:203]
  v_mfma_f32_16x16x32_bf16 v[204:207], a[148:151], a[48:51], v[204:207]
  s_waitcnt vmcnt(13)
  v_mfma_f32_16x16x32_bf16 v[188:191], a[152:155], a[52:55], v[188:191]
  buffer_load_dwordx4 v[44:47], v1, s[4:7], s33 offen offset:3072
  s_waitcnt lgkmcnt(0)
  s_barrier
  v_mfma_f32_16x16x32_bf16 v[192:195], a[156:159], a[52:55], v[192:195]
  s_add_u32 s33, s25, 20480
  buffer_load_dwordx4 v[48:51], v1, s[4:7], s33 offen
  ds_read_b128 v[148:151], v236
  v_mfma_f32_16x16x32_bf16 v[196:199], a[160:163], a[52:55], v[196:199]
  ds_read_b128 v[152:155], v236 offset:1024
  ds_read_b128 v[156:159], v236 offset:2048
  v_mfma_f32_16x16x32_bf16 v[200:203], a[164:167], a[52:55], v[200:203]
  ds_read_b128 v[160:163], v236 offset:3072
  ds_read_b128 v[164:167], v236 offset:4096
  v_mfma_f32_16x16x32_bf16 v[204:207], a[168:171], a[52:55], v[204:207]
  ds_read_b128 v[168:171], v236 offset:5120
  ds_read_b128 v[172:175], v236 offset:6144
  s_waitcnt vmcnt(14)
  v_mfma_f32_16x16x32_bf16 v[188:191], a[172:175], a[56:59], v[188:191]
  buffer_load_dwordx4 v[52:55], v1, s[4:7], s33 offen offset:1024
  ds_read_b128 v[176:179], v236 offset:7168
  v_mfma_f32_16x16x32_bf16 v[192:195], a[176:179], a[56:59], v[192:195]
  ds_read_b128 v[180:183], v236 offset:8192
  ds_read_b128 v[184:187], v236 offset:9216
  v_mfma_f32_16x16x32_bf16 v[196:199], a[180:183], a[56:59], v[196:199]
  v_mfma_f32_16x16x32_bf16 v[200:203], a[184:187], a[56:59], v[200:203]
  v_mfma_f32_16x16x32_bf16 v[204:207], a[188:191], a[56:59], v[204:207]
  s_waitcnt vmcnt(14)
  v_mfma_f32_16x16x32_bf16 v[128:131], a[92:95], a[60:63], v[128:131]
  buffer_load_dwordx4 v[56:59], v1, s[4:7], s33 offen offset:2048
  ds_write_b128 v239, v[188:191]
  v_mfma_f32_16x16x32_bf16 v[132:135], a[96:99], a[60:63], v[132:135]
  buffer_load_dwordx4 v[60:63], v1, s[4:7], s33 offen offset:3072
  v_mfma_f32_16x16x32_bf16 v[136:139], a[100:103], a[60:63], v[136:139]
  v_mfma_f32_16x16x32_bf16 v[140:143], a[104:107], a[60:63], v[140:143]
  ds_write_b128 v239, v[192:195] offset:1024
  v_mfma_f32_16x16x32_bf16 v[144:147], a[108:111], a[60:63], v[144:147]
  s_waitcnt vmcnt(15)
  v_mfma_f32_16x16x32_bf16 v[128:131], a[112:115], a[64:67], v[128:131]
  s_add_u32 s33, s25, 24576
  buffer_load_dwordx4 v[64:67], v1, s[4:7], s33 offen
  v_mfma_f32_16x16x32_bf16 v[132:135], a[116:119], a[64:67], v[132:135]
  ds_write_b128 v239, v[196:199] offset:2048
  v_mfma_f32_16x16x32_bf16 v[136:139], a[120:123], a[64:67], v[136:139]
  v_mfma_f32_16x16x32_bf16 v[140:143], a[124:127], a[64:67], v[140:143]
  v_mfma_f32_16x16x32_bf16 v[144:147], a[128:131], a[64:67], v[144:147]
  ds_write_b128 v239, v[200:203] offset:3072
  s_waitcnt vmcnt(15)
  v_mfma_f32_16x16x32_bf16 v[128:131], a[132:135], a[68:71], v[128:131]
  buffer_load_dwordx4 v[68:71], v1, s[4:7], s33 offen offset:1024
  v_mfma_f32_16x16x32_bf16 v[132:135], a[136:139], a[68:71], v[132:135]
  buffer_load_dwordx4 v[72:75], v1, s[4:7], s33 offen offset:2048
  v_mfma_f32_16x16x32_bf16 v[136:139], a[140:143], a[68:71], v[136:139]
  ds_write_b128 v239, v[204:207] offset:4096
  s_waitcnt lgkmcnt(9)
  v_add_f32 v148, v148, v168
  v_mfma_f32_16x16x32_bf16 v[140:143], a[144:147], a[68:71], v[140:143]
  v_add_f32 v149, v149, v169
  v_add_f32 v150, v150, v170
  v_mfma_f32_16x16x32_bf16 v[144:147], a[148:151], a[68:71], v[144:147]
  v_add_f32 v151, v151, v171
  s_waitcnt lgkmcnt(8)
  v_add_f32 v152, v152, v172
  s_waitcnt vmcnt(16)
  v_mfma_f32_16x16x32_bf16 v[128:131], a[152:155], a[72:75], v[128:131]
  buffer_load_dwordx4 v[76:79], v1, s[4:7], s33 offen offset:3072
  v_add_f32 v153, v153, v173
  v_mfma_f32_16x16x32_bf16 v[132:135], a[156:159], a[72:75], v[132:135]
  v_add_f32 v154, v154, v174
  v_add_f32 v155, v155, v175
  v_mfma_f32_16x16x32_bf16 v[136:139], a[160:163], a[72:75], v[136:139]
  s_waitcnt lgkmcnt(7)
  v_add_f32 v156, v156, v176
  v_add_f32 v157, v157, v177
  v_mfma_f32_16x16x32_bf16 v[140:143], a[164:167], a[72:75], v[140:143]
  s_waitcnt lgkmcnt(0)
  s_barrier
  ds_read_b128 v[188:191], v236 offset:10240
  v_mfma_f32_16x16x32_bf16 v[144:147], a[168:171], a[72:75], v[144:147]
  ds_read_b128 v[192:195], v236 offset:11264
  ds_read_b128 v[196:199], v236 offset:12288
  s_waitcnt vmcnt(16)
  v_mfma_f32_16x16x32_bf16 v[128:131], a[172:175], a[76:79], v[128:131]
  ds_read_b128 v[200:203], v236 offset:13312
  ds_read_b128 v[204:207], v236 offset:14336
  v_mfma_f32_16x16x32_bf16 v[132:135], a[176:179], a[76:79], v[132:135]
  v_add_f32 v158, v158, v178
  v_add_f32 v159, v159, v179
  v_mfma_f32_16x16x32_bf16 v[136:139], a[180:183], a[76:79], v[136:139]
  v_add_f32 v160, v160, v180
  v_add_f32 v161, v161, v181
  v_mfma_f32_16x16x32_bf16 v[140:143], a[184:187], a[76:79], v[140:143]
  v_add_f32 v162, v162, v182
  v_add_f32 v163, v163, v183
  v_mfma_f32_16x16x32_bf16 v[144:147], a[188:191], a[76:79], v[144:147]
  v_add_f32 v164, v164, v184
  v_add_f32 v165, v165, v185
  v_add_f32 v166, v166, v186
  v_add_f32 v167, v167, v187
  s_waitcnt lgkmcnt(4)
  v_pk_add_f32 v[148:149], v[148:149], v[188:189]
  v_pk_add_f32 v[150:151], v[150:151], v[190:191]
  s_waitcnt lgkmcnt(3)
  v_pk_add_f32 v[152:153], v[152:153], v[192:193]
  v_pk_add_f32 v[154:155], v[154:155], v[194:195]
  s_waitcnt lgkmcnt(2)
  v_pk_add_f32 v[156:157], v[156:157], v[196:197]
  v_pk_add_f32 v[158:159], v[158:159], v[198:199]
  s_waitcnt lgkmcnt(1)
  v_pk_add_f32 v[160:161], v[160:161], v[200:201]
  v_pk_add_f32 v[162:163], v[162:163], v[202:203]
  s_waitcnt lgkmcnt(0)
  v_pk_add_f32 v[164:165], v[164:165], v[204:205]
  v_pk_add_f32 v[166:167], v[166:167], v[206:207]
  v_pk_add_f32 v[128:129], v[128:129], v[148:149]
  v_pk_add_f32 v[130:131], v[130:131], v[150:151]
  v_pk_add_f32 v[132:133], v[132:133], v[152:153]
  v_pk_add_f32 v[134:135], v[134:135], v[154:155]
  v_pk_add_f32 v[136:137], v[136:137], v[156:157]
  v_pk_add_f32 v[138:139], v[138:139], v[158:159]
  v_pk_add_f32 v[140:141], v[140:141], v[160:161]
  v_pk_add_f32 v[142:143], v[142:143], v[162:163]
  v_pk_add_f32 v[144:145], v[144:145], v[164:165]
  v_pk_add_f32 v[146:147], v[146:147], v[166:167]
  v_cvt_pk_bf16_f32 v224, v128, v129
  v_cvt_pk_bf16_f32 v225, v130, v131
  v_cvt_pk_bf16_f32 v226, v132, v133
  v_cvt_pk_bf16_f32 v227, v134, v135
  buffer_store_dwordx4 v[224:227], v240, s[4:7], s48 offen
  v_cvt_pk_bf16_f32 v228, v136, v137
  v_cvt_pk_bf16_f32 v229, v138, v139
  v_cvt_pk_bf16_f32 v230, v140, v141
  v_cvt_pk_bf16_f32 v231, v142, v143
  buffer_store_dwordx4 v[228:231], v241, s[4:7], s48 offen
  v_cvt_pk_bf16_f32 v232, v144, v145
  v_cvt_pk_bf16_f32 v233, v146, v147
  buffer_store_dwordx2 v[232:233], v242, s[4:7], s48 offen
  v_dot2_f32_bf16 v244, v224, s37, v244
  v_dot2_f32_bf16 v245, v224, v224, v245
  v_dot2_f32_bf16 v246, v225, s37, v246
  v_dot2_f32_bf16 v247, v225, v225, v247
  v_dot2_f32_bf16 v244, v226, s37, v244
  v_dot2_f32_bf16 v245, v226, v226, v245
  v_dot2_f32_bf16 v246, v227, s37, v246
  v_dot2_f32_bf16 v247, v227, v227, v247
  v_dot2_f32_bf16 v244, v228, s37, v244
  v_dot2_f32_bf16 v245, v228, v228, v245
  v_dot2_f32_bf16 v246, v229, s37, v246
  v_dot2_f32_bf16 v247, v229, v229, v247
  v_dot2_f32_bf16 v244, v230, s37, v244
  v_dot2_f32_bf16 v245, v230, v230, v245
  v_dot2_f32_bf16 v246, v231, s37, v246
  v_dot2_f32_bf16 v247, v231, v231, v247
  v_dot2_f32_bf16 v244, v232, s37, v244
  v_dot2_f32_bf16 v245, v232, v232, v245
  v_dot2_f32_bf16 v246, v233, s37, v246
  v_dot2_f32_bf16 v247, v233, v233, v247
  s_nop 2
  v_pk_add_f32 v[244:245], v[244:245], v[246:247]
  v_mov_b32 v246, v244
  v_mov_b32 v247, v245
  s_nop 0
  v_permlane16_swap_b32 v244, v246
  v_permlane16_swap_b32 v245, v247
  v_pk_add_f32 v[244:245], v[244:245], v[246:247]
  v_mov_b32 v246, v244
  v_mov_b32 v247, v245
  s_nop 0
  v_permlane32_swap_b32 v244, v246
  v_permlane32_swap_b32 v245, v247
  v_pk_add_f32 v[244:245], v[244:245], v[246:247]
  buffer_store_dwordx2 v[244:245], v243, s[4:7], s67 offen
  s_waitcnt vmcnt(0) lgkmcnt(0)
  s_mov_b64 exec, 1
  buffer_store_byte v14, v15, s[4:7], s58 offen
  s_mov_b64 exec, -1
  s_barrier
  s_lshr_b32 s45, s17, 4
  s_lshl_b32 s36, s45, 1
  s_lshr_b32 s37, s18, 1
  s_add_u32 s36, s36, s37
  s_and_b32 s37, s18, 1
  s_lshl_b32 s37, s37, 4
  s_lshl_b32 s37, 0x0101, s37
  v_lshrrev_b32 v13, 3, v0
  v_cmp_eq_u32 vcc, s36, v13
  v_mov_b32 v14, s37
  s_nop 0
  v_cndmask_b32 v13, 0, v14, vcc
  s_lshl_b32 s44, s16, 3
  s_lshl_b32 s36, s45, 2
  s_add_u32 s44, s44, s36
  s_add_u32 s44, s44, s18
  s_mul_i32 s40, s44, 40960
  s_add_u32 s40, s40, s65
  s_lshl_b32 s41, s44, 8
  s_add_u32 s41, s41, 15519744
  s_mul_i32 s46, s44, 110592
  s_lshl_b32 s47, s30, 10
  s_add_u32 s46, s46, s47
  s_add_u32 s46, s46, s19
  s_add_u32 s46, s46, 7864320
  s_sub_u32 s50, s46, s47
  s_lshl_b32 s47, s71, 10
  s_add_u32 s50, s50, s47
  s_add_u32 s47, s46, 4096
  v_lshlrev_b32 v15, 16, v5
  v_lshl_add_u32 v15, v4, 3, v15
  ds_read_b64 v[98:99], v11 offset:2048
  ds_read_b64 v[100:101], v11 offset:2560
  ds_read_b64 v[102:103], v11 offset:3072
  ds_read_b64 v[104:105], v11 offset:3584
  ds_read_b64 v[106:107], v11 offset:4096
  ds_read_b64 v[108:109], v11 offset:4608
  ds_read_b64 v[110:111], v11 offset:5120
  v_lshlrev_b32 v12, 2, v4
  s_add_u32 s58, s21, 3072
  s_mov_b32 s59, 0
  s_nop 0
POLL_20:
  buffer_load_dword v14, v12, s[4:7], s58 offen sc1
  s_add_u32 s59, s59, 1
  s_waitcnt vmcnt(0)
  v_and_b32 v14, v14, v13
  v_cmp_ne_u32 vcc, v14, v13
  s_cmp_ge_u32 s59, 60000
  s_cbranch_scc1 POLLD_21
  s_nop 0
  s_cbranch_vccnz POLL_20
POLLD_21:
  buffer_load_dwordx4 a[0:3], v1, s[4:7], s40 offen sc1
  buffer_load_dwordx4 a[4:7], v1, s[4:7], s40 offen offset:1024 sc1
  buffer_load_dwordx4 a[8:11], v1, s[4:7], s40 offen offset:2048 sc1
  buffer_load_dwordx4 a[12:15], v1, s[4:7], s40 offen offset:3072 sc1
  s_add_u32 s42, s40, 4096
  buffer_load_dwordx4 a[16:19], v1, s[4:7], s42 offen sc1
  buffer_load_dwordx4 a[20:23], v1, s[4:7], s42 offen offset:1024 sc1
  buffer_load_dwordx4 a[24:27], v1, s[4:7], s42 offen offset:2048 sc1
  buffer_load_dwordx4 a[28:31], v1, s[4:7], s42 offen offset:3072 sc1
  ds_read_b128 a[160:163], v2
  ds_read_b128 a[164:167], v2 offset:4096
  ds_read_b128 a[168:171], v2 offset:8192
  ds_read_b128 a[172:175], v2 offset:12288
  ds_read_b128 a[176:179], v2 offset:1024
  ds_read_b128 a[180:183], v2 offset:5120
  ds_read_b128 a[184:187], v2 offset:9216
  ds_read_b128 a[188:191], v2 offset:13312
  s_waitcnt lgkmcnt(4)
  s_waitcnt vmcnt(7)
  v_mfma_f32_32x32x16_bf16 v[128:143], a[160:163], a[0:3], 0
  ds_read_b128 a[192:195], v2 offset:2048
  s_add_u32 s42, s40, 8192
  buffer_load_dwordx4 a[32:35], v1, s[4:7], s42 offen sc1
  v_mfma_f32_32x32x16_bf16 v[144:159], a[164:167], a[0:3], 0
  ds_read_b128 a[196:199], v2 offset:6144
  buffer_load_dwordx2 v[80:81], v15, s[4:7], s41 offen sc1
  v_mfma_f32_32x32x16_bf16 v[160:175], a[168:171], a[0:3], 0
  ds_read_b128 a[200:203], v2 offset:10240
  s_add_u32 s43, s41, 16384
  buffer_load_dwordx2 v[82:83], v15, s[4:7], s43 offen sc1
  v_mfma_f32_32x32x16_bf16 v[176:191], a[172:175], a[0:3], 0
  ds_read_b128 a[204:207], v2 offset:14336
  s_waitcnt lgkmcnt(4)
  s_waitcnt vmcnt(9)
  v_mfma_f32_32x32x16_bf16 v[128:143], a[176:179], a[4:7], v[128:143]
  ds_read_b128 a[160:163], v2 offset:3072
  buffer_load_dwordx4 a[36:39], v1, s[4:7], s42 offen offset:1024 sc1
  v_mfma_f32_32x32x16_bf16 v[144:159], a[180:183], a[4:7], v[144:159]
  ds_read_b128 a[164:167], v2 offset:7168
  s_add_u32 s43, s41, 32768
  buffer_load_dwordx2 v[84:85], v15, s[4:7], s43 offen sc1
  v_mfma_f32_32x32x16_bf16 v[160:175], a[184:187], a[4:7], v[160:175]
  ds_read_b128 a[168:171], v2 offset:11264
  s_add_u32 s43, s41, 49152
  buffer_load_dwordx2 v[86:87], v15, s[4:7], s43 offen sc1
  v_mfma_f32_32x32x16_bf16 v[176:191], a[188:191], a[4:7], v[176:191]
  ds_read_b128 a[172:175], v2 offset:15360
  s_add_u32 m0, s26, 0
  s_add_u32 s32, s23, 20480
  buffer_load_dwordx4 v1, s[4:7], s32 offen offset:0 lds
  s_waitcnt lgkmcnt(4)
  s_waitcnt vmcnt(12)
  v_mfma_f32_32x32x16_bf16 v[128:143], a[192:195], a[8:11], v[128:143]
  ds_read_b128 a[176:179], v2 offset:16384
  buffer_load_dwordx4 a[40:43], v1, s[4:7], s42 offen offset:2048 sc1
  v_mfma_f32_32x32x16_bf16 v[144:159], a[196:199], a[8:11], v[144:159]
  ds_read_b128 a[180:183], v2 offset:20480
  buffer_load_dwordx4 v1, s[4:7], s32 offen offset:1024 lds
  v_mfma_f32_32x32x16_bf16 v[160:175], a[200:203], a[8:11], v[160:175]
  ds_read_b128 a[184:187], v2 offset:24576
  v_mfma_f32_32x32x16_bf16 v[176:191], a[204:207], a[8:11], v[176:191]
  ds_read_b128 a[188:191], v2 offset:28672
  s_waitcnt lgkmcnt(4)
  s_waitcnt vmcnt(13)
  v_mfma_f32_32x32x16_bf16 v[128:143], a[160:163], a[12:15], v[128:143]
  ds_read_b128 a[192:195], v2 offset:17408
  buffer_load_dwordx4 a[44:47], v1, s[4:7], s42 offen offset:3072 sc1
  v_mfma_f32_32x32x16_bf16 v[144:159], a[164:167], a[12:15], v[144:159]
  ds_read_b128 a[196:199], v2 offset:21504
  buffer_load_dwordx4 v1, s[4:7], s32 offen offset:2048 lds
  v_mfma_f32_32x32x16_bf16 v[160:175], a[168:171], a[12:15], v[160:175]
  ds_read_b128 a[200:203], v2 offset:25600
  v_mfma_f32_32x32x16_bf16 v[176:191], a[172:175], a[12:15], v[176:191]
  ds_read_b128 a[204:207], v2 offset:29696
  s_waitcnt lgkmcnt(4)
  s_waitcnt vmcnt(14)
  v_mfma_f32_32x32x16_bf16 v[128:143], a[176:179], a[16:19], v[128:143]
  ds_read_b128 a[160:163], v2 offset:18432
  s_add_u32 s42, s40, 12288
  buffer_load_dwordx4 a[48:51], v1, s[4:7], s42 offen sc1
  v_mfma_f32_32x32x16_bf16 v[144:159], a[180:183], a[16:19], v[144:159]
  ds_read_b128 a[164:167], v2 offset:22528
  buffer_load_dwordx4 v1, s[4:7], s32 offen offset:3072 lds
  v_mfma_f32_32x32x16_bf16 v[160:175], a[184:187], a[16:19], v[160:175]
  ds_read_b128 a[168:171], v2 offset:26624
  v_mfma_f32_32x32x16_bf16 v[176:191], a[188:191], a[16:19], v[176:191]
  ds_read_b128 a[172:175], v2 offset:30720
  s_waitcnt lgkmcnt(4)
  s_waitcnt vmcnt(15)
  v_mfma_f32_32x32x16_bf16 v[128:143], a[192:195], a[20:23], v[128:143]
  ds_read_b128 a[176:179], v2 offset:19456
  buffer_load_dwordx4 a[52:55], v1, s[4:7], s42 offen offset:1024 sc1
  v_mfma_f32_32x32x16_bf16 v[144:159], a[196:199], a[20:23], v[144:159]
  ds_read_b128 a[180:183], v2 offset:23552
  s_add_u32 m0, s26, 16384
  s_add_u32 s32, s27, 24576
  buffer_load_dwordx4 v1, s[4:7], s32 offen offset:0 lds
  v_mfma_f32_32x32x16_bf16 v[160:175], a[200:203], a[20:23], v[160:175]
  ds_read_b128 a[184:187], v2 offset:27648
  v_mfma_f32_32x32x16_bf16 v[176:191], a[204:207], a[20:23], v[176:191]
  ds_read_b128 a[188:191], v2 offset:31744
  s_waitcnt lgkmcnt(4)
  s_waitcnt vmcnt(16)
  v_mfma_f32_32x32x16_bf16 v[128:143], a[160:163], a[24:27], v[128:143]
  ds_read_b128 a[192:195], v2 offset:32768
  buffer_load_dwordx4 a[56:59], v1, s[4:7], s42 offen offset:2048 sc1
  v_mfma_f32_32x32x16_bf16 v[144:159], a[164:167], a[24:27], v[144:159]
  ds_read_b128 a[196:199], v2 offset:36864
  buffer_load_dwordx4 v1, s[4:7], s32 offen offset:1024 lds
  v_mfma_f32_32x32x16_bf16 v[160:175], a[168:171], a[24:27], v[160:175]
  ds_read_b128 a[200:203], v2 offset:40960
  v_mfma_f32_32x32x16_bf16 v[176:191], a[172:175], a[24:27], v[176:191]
  ds_read_b128 a[204:207], v2 offset:45056
  s_waitcnt lgkmcnt(4)
  s_waitcnt vmcnt(17)
  v_mfma_f32_32x32x16_bf16 v[128:143], a[176:179], a[28:31], v[128:143]
  ds_read_b128 a[160:163], v2 offset:33792
  buffer_load_dwordx4 a[60:63], v1, s[4:7], s42 offen offset:3072 sc1
  v_mfma_f32_32x32x16_bf16 v[144:159], a[180:183], a[28:31], v[144:159]
  ds_read_b128 a[164:167], v2 offset:37888
  buffer_load_dwordx4 v1, s[4:7], s32 offen offset:2048 lds
  v_mfma_f32_32x32x16_bf16 v[160:175], a[184:187], a[28:31], v[160:175]
  ds_read_b128 a[168:171], v2 offset:41984
  v_mfma_f32_32x32x16_bf16 v[176:191], a[188:191], a[28:31], v[176:191]
  ds_read_b128 a[172:175], v2 offset:46080
  s_waitcnt lgkmcnt(4)
  s_waitcnt vmcnt(18)
  v_mfma_f32_32x32x16_bf16 v[128:143], a[192:195], a[32:35], v[128:143]
  ds_read_b128 a[176:179], v2 offset:34816
  s_add_u32 s42, s40, 16384
  buffer_load_dwordx4 a[64:67], v1, s[4:7], s42 offen sc1
  s_waitcnt vmcnt(17)
  v_add_f32 v80, v80, v82
  v_add_f32 v81, v81, v83
  s_waitcnt vmcnt(14)
  v_add_f32 v84, v84, v86
  v_mfma_f32_32x32x16_bf16 v[144:159], a[196:199], a[32:35], v[144:159]
  ds_read_b128 a[180:183], v2 offset:38912
  buffer_load_dwordx4 v1, s[4:7], s32 offen offset:3072 lds
  v_add_f32 v85, v85, v87
  v_mfma_f32_32x32x16_bf16 v[160:175], a[200:203], a[32:35], v[160:175]
  ds_read_b128 a[184:187], v2 offset:43008
  v_mfma_f32_32x32x16_bf16 v[176:191], a[204:207], a[32:35], v[176:191]
  ds_read_b128 a[188:191], v2 offset:47104
  s_waitcnt lgkmcnt(4)
  v_mfma_f32_32x32x16_bf16 v[128:143], a[160:163], a[36:39], v[128:143]
  ds_read_b128 a[192:195], v2 offset:35840
  buffer_load_dwordx4 a[68:71], v1, s[4:7], s42 offen offset:1024 sc1
  v_add_f32 v80, v80, v84
  v_add_f32 v81, v81, v85
  v_mov_b32 v82, v80
  v_mov_b32 v83, v81
  v_mfma_f32_32x32x16_bf16 v[144:159], a[164:167], a[36:39], v[144:159]
  ds_read_b128 a[196:199], v2 offset:39936
  s_add_u32 m0, s26, 32768
  s_add_u32 s32, s27, 32768
  buffer_load_dwordx4 v1, s[4:7], s32 offen offset:0 lds
  v_mfma_f32_32x32x16_bf16 v[160:175], a[168:171], a[36:39], v[160:175]
  ds_read_b128 a[200:203], v2 offset:44032
  v_mfma_f32_32x32x16_bf16 v[176:191], a[172:175], a[36:39], v[176:191]
  ds_read_b128 a[204:207], v2 offset:48128
  s_waitcnt lgkmcnt(4)
  s_waitcnt vmcnt(15)
  v_mfma_f32_32x32x16_bf16 v[128:143], a[176:179], a[40:43], v[128:143]
  ds_read_b128 a[160:163], v2 offset:49152
  buffer_load_dwordx4 a[72:75], v1, s[4:7], s42 offen offset:2048 sc1
  v_permlane32_swap_b32 v80, v82
  v_permlane32_swap_b32 v81, v83
  v_add_f32 v80, v80, v82
  v_add_f32 v81, v81, v83
  v_mfma_f32_32x32x16_bf16 v[144:159], a[180:183], a[40:43], v[144:159]
  ds_read_b128 a[164:167], v2 offset:53248
  buffer_load_dwordx4 v1, s[4:7], s32 offen offset:1024 lds
  v_mfma_f32_32x32x16_bf16 v[160:175], a[184:187], a[40:43], v[160:175]
  ds_read_b128 a[168:171], v2 offset:57344
  v_mfma_f32_32x32x16_bf16 v[176:191], a[188:191], a[40:43], v[176:191]
  ds_read_b128 a[172:175], v2 offset:61440
  s_waitcnt lgkmcnt(4)
  s_waitcnt vmcnt(15)
  v_mfma_f32_32x32x16_bf16 v[128:143], a[192:195], a[44:47], v[128:143]
  ds_read_b128 a[176:179], v2 offset:50176
  buffer_load_dwordx4 a[76:79], v1, s[4:7], s42 offen offset:3072 sc1
  v_mul_f32 v80, 0xbacccccd, v80
  v_mul_f32 v81, 0x3acccccd, v81
  v_fma_f32 v81, -v80, v80, v81
  v_max_f32 v81, 0, v81
  v_mfma_f32_32x32x16_bf16 v[144:159], a[196:199], a[44:47], v[144:159]
  ds_read_b128 a[180:183], v2 offset:54272
  v_mfma_f32_32x32x16_bf16 v[160:175], a[200:203], a[44:47], v[160:175]
  ds_read_b128 a[184:187], v2 offset:58368
  v_mfma_f32_32x32x16_bf16 v[176:191], a[204:207], a[44:47], v[176:191]
  ds_read_b128 a[188:191], v2 offset:62464
  s_waitcnt lgkmcnt(4)
  s_waitcnt vmcnt(14)
  v_mfma_f32_32x32x16_bf16 v[128:143], a[160:163], a[48:51], v[128:143]
  ds_read_b128 a[192:195], v2 offset:51200
  s_add_u32 s42, s40, 20480
  buffer_load_dwordx4 a[80:83], v1, s[4:7], s42 offen sc1
  v_add_f32 v81, 0x3727c5ac, v81
  v_rsq_f32 v88, v81
  v_mfma_f32_32x32x16_bf16 v[144:159], a[164:167], a[48:51], v[144:159]
  ds_read_b128 a[196:199], v2 offset:55296
  buffer_load_dwordx4 v1, s[4:7], s32 offen offset:2048 lds
  v_cvt_pk_bf16_f32 v96, v80, v80
  v_and_b32 v82, 0xffff0000, v96
  v_mfma_f32_32x32x16_bf16 v[160:175], a[168:171], a[48:51], v[160:175]
  ds_read_b128 a[200:203], v2 offset:59392
  v_mfma_f32_32x32x16_bf16 v[176:191], a[172:175], a[48:51], v[176:191]
  ds_read_b128 a[204:207], v2 offset:63488
  s_waitcnt lgkmcnt(4)
  s_waitcnt vmcnt(14)
  v_mfma_f32_32x32x16_bf16 v[128:143], a[176:179], a[52:55], v[128:143]
  ds_read_b128 a[160:163], v2 offset:52224
  buffer_load_dwordx4 a[84:87], v1, s[4:7], s42 offen offset:1024 sc1
  v_sub_f32 v82, v80, v82
  v_cvt_pk_bf16_f32 v97, v82, 0
  v_mul_f32 v90, 0xc0135761, v88
  v_mul_f32 v92, v88, v88
  v_mfma_f32_32x32x16_bf16 v[144:159], a[180:183], a[52:55], v[144:159]
  ds_read_b128 a[164:167], v2 offset:56320
  buffer_load_dwordx4 v1, s[4:7], s32 offen offset:3072 lds
  v_mfma_f32_32x32x16_bf16 v[160:175], a[184:187], a[52:55], v[160:175]
  ds_read_b128 a[168:171], v2 offset:60416
  v_mfma_f32_32x32x16_bf16 v[176:191], a[188:191], a[52:55], v[176:191]
  ds_read_b128 a[172:175], v2 offset:64512
  s_waitcnt lgkmcnt(4)
  s_waitcnt vmcnt(14)
  v_mfma_f32_32x32x16_bf16 v[128:143], a[192:195], a[56:59], v[128:143]
  ds_read_b128 a[176:179], v3
  buffer_load_dwordx4 a[88:91], v1, s[4:7], s42 offen offset:2048 sc1
  v_mul_f32 v92, v92, v88
  v_mul_f32 v92, 0xbdd2d3e8, v92
  v_mov_b32 v91, v90
  v_mov_b32 v93, v92
  v_mfma_f32_32x32x16_bf16 v[144:159], a[196:199], a[56:59], v[144:159]
  ds_read_b128 a[180:183], v3 offset:4096
  s_add_u32 m0, s26, 49152
  s_add_u32 s32, s27, 106496
  buffer_load_dwordx4 v1, s[4:7], s32 offen offset:0 lds
  v_mfma_f32_32x32x16_bf16 v[160:175], a[200:203], a[56:59], v[160:175]
  ds_read_b128 a[184:187], v3 offset:8192
  v_mfma_f32_32x32x16_bf16 v[176:191], a[204:207], a[56:59], v[176:191]
  ds_read_b128 a[188:191], v3 offset:12288
  s_waitcnt lgkmcnt(4)
  s_waitcnt vmcnt(14)
  v_mfma_f32_32x32x16_bf16 v[128:143], a[160:163], a[60:63], v[128:143]
  ds_read_b128 a[192:195], v3 offset:1024
  buffer_load_dwordx4 a[92:95], v1, s[4:7], s42 offen offset:3072 sc1
  v_mov_b32 v94, v81
  v_mov_b32 v95, v81
  v_mfma_f32_32x32x16_bf16 v[144:159], a[164:167], a[60:63], v[144:159]
  ds_read_b128 a[196:199], v3 offset:5120
  buffer_load_dwordx4 v1, s[4:7], s32 offen offset:1024 lds
  v_mfma_f32_32x32x16_bf16 v[160:175], a[168:171], a[60:63], v[160:175]
  ds_read_b128 a[200:203], v3 offset:9216
  v_mfma_f32_32x32x16_bf16 v[176:191], a[172:175], a[60:63], v[176:191]
  ds_read_b128 a[204:207], v3 offset:13312
  s_waitcnt lgkmcnt(4)
  s_waitcnt vmcnt(14)
  v_mfma_f32_32x32x16_bf16 v[128:143], a[176:179], a[64:67], v[128:143]
  ds_read_b128 a[160:163], v3 offset:2048
  s_add_u32 s42, s40, 24576
  buffer_load_dwordx4 a[96:99], v1, s[4:7], s42 offen sc1
  v_mfma_f32_32x32x16_bf16 v[144:159], a[180:183], a[64:67], v[144:159]
  ds_read_b128 a[164:167], v3 offset:6144
  buffer_load_dwordx4 a[100:103], v1, s[4:7], s42 offen offset:1024 sc1
  v_mfma_f32_32x32x16_bf16 v[160:175], a[184:187], a[64:67], v[160:175]
  ds_read_b128 a[168:171], v3 offset:10240
  buffer_load_dwordx4 v1, s[4:7], s32 offen offset:2048 lds
  v_mfma_f32_32x32x16_bf16 v[176:191], a[188:191], a[64:67], v[176:191]
  ds_read_b128 a[172:175], v3 offset:14336
  s_waitcnt lgkmcnt(4)
  s_waitcnt vmcnt(15)
  v_mfma_f32_32x32x16_bf16 v[128:143], a[192:195], a[68:71], v[128:143]
  ds_read_b128 a[176:179], v3 offset:3072
  buffer_load_dwordx4 a[104:107], v1, s[4:7], s42 offen offset:2048 sc1
  v_mfma_f32_32x32x16_bf16 v[144:159], a[196:199], a[68:71], v[144:159]
  ds_read_b128 a[180:183], v3 offset:7168
  buffer_load_dwordx4 a[108:111], v1, s[4:7], s42 offen offset:3072 sc1
  v_mfma_f32_32x32x16_bf16 v[160:175], a[200:203], a[68:71], v[160:175]
  ds_read_b128 a[184:187], v3 offset:11264
  buffer_load_dwordx4 v1, s[4:7], s32 offen offset:3072 lds
  v_mfma_f32_32x32x16_bf16 v[176:191], a[204:207], a[68:71], v[176:191]
  ds_read_b128 a[188:191], v3 offset:15360
  s_waitcnt lgkmcnt(4)
  s_waitcnt vmcnt(16)
  v_mfma_f32_32x32x16_bf16 v[128:143], a[160:163], a[72:75], v[128:143]
  s_barrier
  ds_read_b128 a[192:195], v1
  s_add_u32 s42, s40, 28672
  buffer_load_dwordx4 a[112:115], v1, s[4:7], s42 offen sc1
  v_mfma_f32_32x32x16_bf16 v[144:159], a[164:167], a[72:75], v[144:159]
  ds_read_b128 a[196:199], v1 offset:4096
  buffer_load_dwordx4 a[116:119], v1, s[4:7], s42 offen offset:1024 sc1
  v_mfma_f32_32x32x16_bf16 v[160:175], a[168:171], a[72:75], v[160:175]
  ds_read_b128 a[200:203], v1 offset:8192
  v_mfma_f32_32x32x16_bf16 v[176:191], a[172:175], a[72:75], v[176:191]
  ds_read_b128 a[204:207], v1 offset:12288
  s_waitcnt lgkmcnt(4)
  s_waitcnt vmcnt(16)
  v_mfma_f32_32x32x16_bf16 v[128:143], a[176:179], a[76:79], v[128:143]
  ds_read_b128 a[160:163], v1 offset:1024
  buffer_load_dwordx4 a[120:123], v1, s[4:7], s42 offen offset:2048 sc1
  v_mfma_f32_32x32x16_bf16 v[144:159], a[180:183], a[76:79], v[144:159]
  ds_read_b128 a[164:167], v1 offset:5120
  buffer_load_dwordx4 a[124:127], v1, s[4:7], s42 offen offset:3072 sc1
  v_mfma_f32_32x32x16_bf16 v[160:175], a[184:187], a[76:79], v[160:175]
  ds_read_b128 a[168:171], v1 offset:9216
  s_add_u32 m0, s26, 65536
  s_add_u32 s32, s27, 114688
  buffer_load_dwordx4 v1, s[4:7], s32 offen offset:0 lds
  v_mfma_f32_32x32x16_bf16 v[176:191], a[188:191], a[76:79], v[176:191]
  ds_read_b128 a[172:175], v1 offset:13312
  s_waitcnt lgkmcnt(4)
  s_waitcnt vmcnt(18)
  v_mfma_f32_32x32x16_bf16 v[128:143], a[192:195], a[80:83], v[128:143]
  ds_read_b128 a[176:179], v1 offset:2048
  s_add_u32 s42, s40, 32768
  buffer_load_dwordx4 a[128:131], v1, s[4:7], s42 offen sc1
  v_mfma_f32_32x32x16_bf16 v[144:159], a[196:199], a[80:83], v[144:159]
  ds_read_b128 a[180:183], v1 offset:6144
  buffer_load_dwordx4 a[132:135], v1, s[4:7], s42 offen offset:1024 sc1
  v_mfma_f32_32x32x16_bf16 v[160:175], a[200:203], a[80:83], v[160:175]
  ds_read_b128 a[184:187], v1 offset:10240
  buffer_load_dwordx4 v1, s[4:7], s32 offen offset:1024 lds
  v_mfma_f32_32x32x16_bf16 v[176:191], a[204:207], a[80:83], v[176:191]
  ds_read_b128 a[188:191], v1 offset:14336
  s_waitcnt lgkmcnt(4)
  s_waitcnt vmcnt(19)
  v_mfma_f32_32x32x16_bf16 v[128:143], a[160:163], a[84:87], v[128:143]
  ds_read_b128 a[192:195], v1 offset:3072
  buffer_load_dwordx4 a[136:139], v1, s[4:7], s42 offen offset:2048 sc1
  v_mfma_f32_32x32x16_bf16 v[144:159], a[164:167], a[84:87], v[144:159]
  ds_read_b128 a[196:199], v1 offset:7168
  buffer_load_dwordx4 a[140:143], v1, s[4:7], s42 offen offset:3072 sc1
  v_mfma_f32_32x32x16_bf16 v[160:175], a[168:171], a[84:87], v[160:175]
  ds_read_b128 a[200:203], v1 offset:11264
  buffer_load_dwordx4 v1, s[4:7], s32 offen offset:2048 lds
  v_mfma_f32_32x32x16_bf16 v[176:191], a[172:175], a[84:87], v[176:191]
  ds_read_b128 a[204:207], v1 offset:15360
  s_waitcnt lgkmcnt(4)
  s_waitcnt vmcnt(20)
  v_mfma_f32_32x32x16_bf16 v[128:143], a[176:179], a[88:91], v[128:143]
  s_barrier
  ds_read_b128 a[160:163], v1 offset:16384
  s_add_u32 s42, s40, 36864
  buffer_load_dwordx4 a[144:147], v1, s[4:7], s42 offen sc1
  v_mfma_f32_32x32x16_bf16 v[144:159], a[180:183], a[88:91], v[144:159]
  ds_read_b128 a[164:167], v1 offset:20480
  buffer_load_dwordx4 a[148:151], v1, s[4:7], s42 offen offset:1024 sc1
  v_mfma_f32_32x32x16_bf16 v[160:175], a[184:187], a[88:91], v[160:175]
  ds_read_b128 a[168:171], v1 offset:17408
  buffer_load_dwordx4 v1, s[4:7], s32 offen offset:3072 lds
  v_mfma_f32_32x32x16_bf16 v[176:191], a[188:191], a[88:91], v[176:191]
  ds_read_b128 a[172:175], v1 offset:21504
  s_waitcnt lgkmcnt(4)
  s_waitcnt vmcnt(21)
  v_mfma_f32_32x32x16_bf16 v[128:143], a[192:195], a[92:95], v[128:143]
  ds_read_b128 a[176:179], v1 offset:18432
  buffer_load_dwordx4 a[152:155], v1, s[4:7], s42 offen offset:2048 sc1
  v_mfma_f32_32x32x16_bf16 v[144:159], a[196:199], a[92:95], v[144:159]
  ds_read_b128 a[180:183], v1 offset:22528
  buffer_load_dwordx4 a[156:159], v1, s[4:7], s42 offen offset:3072 sc1
  v_mfma_f32_32x32x16_bf16 v[160:175], a[200:203], a[92:95], v[160:175]
  ds_read_b128 a[184:187], v1 offset:19456
  s_add_u32 m0, s26, 81920
  s_add_u32 s32, s31, 0
  buffer_load_dwordx4 v1, s[4:7], s32 offen offset:0 lds
  v_mfma_f32_32x32x16_bf16 v[176:191], a[204:207], a[92:95], v[176:191]
  ds_read_b128 a[188:191], v1 offset:23552
  s_waitcnt lgkmcnt(4)
  s_waitcnt vmcnt(22)
  v_mfma_f32_32x32x16_bf16 v[128:143], a[160:163], a[96:99], v[128:143]
  ds_read_b128 a[192:195], v1 offset:24576
  buffer_load_dwordx4 v1, s[4:7], s32 offen offset:1024 lds
  s_add_u32 s49, s19, 7864320
  s_add_u32 s36, s18, 0
  s_and_b32 s36, s36, 3
  s_lshr_b32 s37, s36, 1
  v_mfma_f32_32x32x16_bf16 v[144:159], a[164:167], a[96:99], v[144:159]
  ds_read_b128 a[196:199], v1 offset:28672
  s_add_u32 s37, s37, s61
  s_mul_i32 s37, s37, 110592
  s_and_b32 s36, s36, 1
  s_lshl_b32 s36, s36, 8
  s_add_u32 s37, s37, s36
  s_waitcnt vmcnt(22)
  v_mfma_f32_32x32x16_bf16 v[128:143], a[168:171], a[100:103], v[128:143]
  ds_read_b128 a[200:203], v1 offset:25600
  s_lshl_b32 s36, s34, 11
  s_add_u32 s37, s37, s36
  s_add_u32 s86, s37, s49
  s_add_u32 s36, s18, 1
  s_and_b32 s36, s36, 3
  v_mfma_f32_32x32x16_bf16 v[144:159], a[172:175], a[100:103], v[144:159]
  ds_read_b128 a[204:207], v1 offset:29696
  s_lshr_b32 s37, s36, 1
  s_add_u32 s37, s37, s61
  s_mul_i32 s37, s37, 110592
  s_and_b32 s36, s36, 1
  s_waitcnt lgkmcnt(4)
  s_waitcnt vmcnt(20)
  v_mfma_f32_32x32x16_bf16 v[128:143], a[176:179], a[104:107], v[128:143]
  ds_read_b128 a[160:163], v1 offset:26624
  buffer_load_dwordx4 v1, s[4:7], s32 offen offset:2048 lds
  s_lshl_b32 s36, s36, 8
  s_add_u32 s37, s37, s36
  s_lshl_b32 s36, s34, 11
  s_add_u32 s37, s37, s36
  v_mfma_f32_32x32x16_bf16 v[144:159], a[180:183], a[104:107], v[144:159]
  ds_read_b128 a[164:167], v1 offset:30720
  s_add_u32 s87, s37, s49
  s_add_u32 s36, s18, 2
  s_and_b32 s36, s36, 3
  s_lshr_b32 s37, s36, 1
  s_add_u32 s37, s37, s61
  s_waitcnt vmcnt(20)
  v_mfma_f32_32x32x16_bf16 v[128:143], a[184:187], a[108:111], v[128:143]
  ds_read_b128 a[168:171], v1 offset:27648
  s_mul_i32 s37, s37, 110592
  s_and_b32 s36, s36, 1
  s_lshl_b32 s36, s36, 8
  s_add_u32 s37, s37, s36
  s_lshl_b32 s36, s34, 11
  v_mfma_f32_32x32x16_bf16 v[144:159], a[188:191], a[108:111], v[144:159]
  ds_read_b128 a[172:175], v1 offset:31744
  s_add_u32 s37, s37, s36
  s_add_u32 s88, s37, s49
  s_add_u32 s36, s18, 3
  s_and_b32 s36, s36, 3
  s_waitcnt lgkmcnt(4)
  s_waitcnt vmcnt(18)
  v_mfma_f32_32x32x16_bf16 v[128:143], a[192:195], a[112:115], v[128:143]
  ds_read_b128 a[176:179], v1 offset:32768
  buffer_load_dwordx4 v1, s[4:7], s32 offen offset:3072 lds
  s_lshr_b32 s37, s36, 1
  s_add_u32 s37, s37, s61
  s_mul_i32 s37, s37, 110592
  s_and_b32 s36, s36, 1
  v_mfma_f32_32x32x16_bf16 v[144:159], a[196:199], a[112:115], v[144:159]
  ds_read_b128 a[180:183], v1 offset:36864
  s_lshl_b32 s36, s36, 8
  s_add_u32 s37, s37, s36
  s_lshl_b32 s36, s34, 11
  s_add_u32 s37, s37, s36
  s_add_u32 s89, s37, s49
  s_waitcnt vmcnt(18)
  v_mfma_f32_32x32x16_bf16 v[128:143], a[200:203], a[116:119], v[128:143]
  ds_read_b128 a[184:187], v1 offset:33792
  s_lshr_b32 s38, s17, 3
  s_lshl_b32 s36, s18, 4
  s_lshr_b32 s39, s38, 1
  s_lshl_b32 s39, s39, 6
  s_add_u32 s36, s36, s39
  v_mfma_f32_32x32x16_bf16 v[144:159], a[204:207], a[116:119], v[144:159]
  ds_read_b128 a[188:191], v1 offset:37888
  s_add_u32 s36, s36, s21
  s_and_b32 s39, s38, 1
  s_lshl_b32 s39, s39, 4
  s_lshl_b32 s51, 0x0101, s39
  s_waitcnt lgkmcnt(4)
  s_waitcnt vmcnt(17)
  v_mfma_f32_32x32x16_bf16 v[128:143], a[160:163], a[120:123], v[128:143]
  ds_read_b128 a[192:195], v1 offset:34816
  s_add_u32 m0, s26, 98304
  s_add_u32 s32, s31, 16384
  buffer_load_dwordx4 v1, s[4:7], s32 offen offset:0 lds
  s_add_u32 s95, s36, 4096
  s_add_u32 s94, s36, 1024
  v_mfma_f32_32x32x16_bf16 v[144:159], a[164:167], a[120:123], v[144:159]
  ds_read_b128 a[196:199], v1 offset:38912
  s_add_u32 s58, s21, 4096
  s_lshl_b32 s59, s17, 2
  s_add_u32 s58, s58, s59
  s_add_u32 s58, s58, s18
  v_mov_b32 v14, 1
  s_waitcnt vmcnt(17)
  v_mfma_f32_32x32x16_bf16 v[128:143], a[168:171], a[124:127], v[128:143]
  ds_read_b128 a[200:203], v1 offset:35840
  v_mov_b32 v15, 0
  v_mfma_f32_32x32x16_bf16 v[144:159], a[172:175], a[124:127], v[144:159]
  ds_read_b128 a[204:207], v1 offset:39936
  s_waitcnt lgkmcnt(4)
  s_waitcnt vmcnt(15)
  v_mfma_f32_32x32x16_bf16 v[128:143], a[176:179], a[128:131], v[128:143]
  ds_read_b128 a[160:163], v1 offset:40960
  buffer_load_dwordx4 v1, s[4:7], s32 offen offset:1024 lds
  v_mfma_f32_32x32x16_bf16 v[144:159], a[180:183], a[128:131], v[144:159]
  ds_read_b128 a[164:167], v1 offset:45056
  s_waitcnt vmcnt(15)
  v_mfma_f32_32x32x16_bf16 v[128:143], a[184:187], a[132:135], v[128:143]
  ds_read_b128 a[168:171], v1 offset:41984
  v_mfma_f32_32x32x16_bf16 v[144:159], a[188:191], a[132:135], v[144:159]
  ds_read_b128 a[172:175], v1 offset:46080
  s_waitcnt lgkmcnt(4)
  s_waitcnt vmcnt(13)
  v_mfma_f32_32x32x16_bf16 v[128:143], a[192:195], a[136:139], v[128:143]
  ds_read_b128 a[176:179], v1 offset:43008
  buffer_load_dwordx4 v1, s[4:7], s32 offen offset:2048 lds
  v_mfma_f32_32x32x16_bf16 v[144:159], a[196:199], a[136:139], v[144:159]
  ds_read_b128 a[180:183], v1 offset:47104
  s_waitcnt vmcnt(13)
  v_mfma_f32_32x32x16_bf16 v[128:143], a[200:203], a[140:143], v[128:143]
  ds_read_b128 a[184:187], v1 offset:44032
  v_mfma_f32_32x32x16_bf16 v[144:159], a[204:207], a[140:143], v[144:159]
  ds_read_b128 a[188:191], v1 offset:48128
  s_waitcnt lgkmcnt(4)
  s_waitcnt vmcnt(11)
  v_mfma_f32_32x32x16_bf16 v[128:143], a[160:163], a[144:147], v[128:143]
  s_waitcnt vmcnt(9)
  s_barrier
  ds_read_b128 a[192:195], v1 offset:49152
  buffer_load_dwordx4 v1, s[4:7], s32 offen offset:3072 lds
  v_mfma_f32_32x32x16_bf16 v[144:159], a[164:167], a[144:147], v[144:159]
  ds_read_b128 a[196:199], v1 offset:53248
  v_mfma_f32_32x32x16_bf16 v[128:143], a[168:171], a[148:151], v[128:143]
  ds_read_b128 a[200:203], v1 offset:50176
  v_mfma_f32_32x32x16_bf16 v[144:159], a[172:175], a[148:151], v[144:159]
  ds_read_b128 a[204:207], v1 offset:54272
  s_waitcnt lgkmcnt(4)
  s_waitcnt vmcnt(9)
  v_mfma_f32_32x32x16_bf16 v[128:143], a[176:179], a[152:155], v[128:143]
  ds_read_b128 a[160:163], v1 offset:51200
  s_add_u32 m0, s26, 114688
  s_add_u32 s32, s31, 32768
  buffer_load_dwordx4 v1, s[4:7], s32 offen offset:0 lds
  v_mfma_f32_32x32x16_bf16 v[144:159], a[180:183], a[152:155], v[144:159]
  ds_read_b128 a[164:167], v1 offset:55296
  s_waitcnt vmcnt(9)
  v_mfma_f32_32x32x16_bf16 v[128:143], a[184:187], a[156:159], v[128:143]
  ds_read_b128 a[168:171], v1 offset:52224
  v_mfma_f32_32x32x8_bf16 v[128:143], v[98:99], v[96:97], v[128:143]
  v_mfma_f32_32x32x16_bf16 v[144:159], a[188:191], a[156:159], v[144:159]
  ds_read_b128 a[172:175], v1 offset:56320
  v_mfma_f32_32x32x8_bf16 v[144:159], v[100:101], v[96:97], v[144:159]
  s_waitcnt lgkmcnt(4)
  v_mfma_f32_32x32x16_bf16 v[160:175], a[192:195], a[96:99], v[160:175]
  ds_read_b128 a[176:179], v1 offset:57344
  buffer_load_dwordx4 v1, s[4:7], s32 offen offset:1024 lds
  v_mfma_f32_32x32x16_bf16 v[176:191], a[196:199], a[96:99], v[176:191]
  ds_read_b128 a[180:183], v1 offset:61440
  v_mfma_f32_32x32x16_bf16 v[160:175], a[200:203], a[100:103], v[160:175]
  ds_read_b128 a[184:187], v1 offset:58368
  v_mfma_f32_32x32x16_bf16 v[176:191], a[204:207], a[100:103], v[176:191]
  ds_read_b128 a[188:191], v1 offset:62464
  s_waitcnt lgkmcnt(4)
  v_mfma_f32_32x32x16_bf16 v[160:175], a[160:163], a[104:107], v[160:175]
  ds_read_b128 a[192:195], v1 offset:59392
  buffer_load_dwordx4 v1, s[4:7], s32 offen offset:2048 lds
  v_mul_f32 v112, v128, v128
  v_mul_f32 v113, v129, v129
  v_mul_f32 v114, v130, v130
  v_mul_f32 v115, v131, v131
  v_mfma_f32_32x32x16_bf16 v[176:191], a[164:167], a[104:107], v[176:191]
  ds_read_b128 a[196:199], v1 offset:63488
  v_mul_f32 v116, v132, v132
  v_mul_f32 v117, v133, v133
  v_mul_f32 v118, v134, v134
  v_mul_f32 v119, v135, v135
  v_fma_f32 v112, v112, v92, v90
  v_mfma_f32_32x32x16_bf16 v[160:175], a[168:171], a[108:111], v[160:175]
  ds_read_b128 a[200:203], v1 offset:60416
  v_fma_f32 v113, v113, v92, v90
  v_fma_f32 v114, v114, v92, v90
  v_fma_f32 v115, v115, v92, v90
  v_fma_f32 v116, v116, v92, v90
  v_fma_f32 v117, v117, v92, v90
  v_mfma_f32_32x32x16_bf16 v[176:191], a[172:175], a[108:111], v[176:191]
  ds_read_b128 a[204:207], v1 offset:64512
  v_fma_f32 v118, v118, v92, v90
  v_fma_f32 v119, v119, v92, v90
  v_mul_f32 v112, v112, v128
  v_mul_f32 v113, v113, v129
  s_waitcnt lgkmcnt(4)
  v_mfma_f32_32x32x16_bf16 v[160:175], a[176:179], a[112:115], v[160:175]
  ds_read_b128 a[160:163], v2
  buffer_load_dwordx4 v1, s[4:7], s32 offen offset:3072 lds
  v_mul_f32 v114, v114, v130
  v_mul_f32 v115, v115, v131
  v_mul_f32 v116, v116, v132
  v_mul_f32 v117, v117, v133
  v_mfma_f32_32x32x16_bf16 v[176:191], a[180:183], a[112:115], v[176:191]
  ds_read_b128 a[164:167], v2 offset:4096
  v_mul_f32 v118, v118, v134
  v_mul_f32 v119, v119, v135
  v_exp_f32 v112, v112
  v_mfma_f32_32x32x16_bf16 v[160:175], a[184:187], a[116:119], v[160:175]
  ds_read_b128 a[168:171], v2 offset:1024
  v_exp_f32 v113, v113
  v_exp_f32 v114, v114
  v_mfma_f32_32x32x16_bf16 v[176:191], a[188:191], a[116:119], v[176:191]
  ds_read_b128 a[172:175], v2 offset:5120
  v_exp_f32 v115, v115
  v_exp_f32 v116, v116
  s_waitcnt lgkmcnt(4)
  v_mfma_f32_32x32x16_bf16 v[160:175], a[192:195], a[120:123], v[160:175]
  ds_read_b128 a[176:179], v2 offset:2048
  s_add_u32 m0, s26, 131072
  s_add_u32 s32, s31, 49152
  buffer_load_dwordx4 v1, s[4:7], s32 offen offset:0 lds
  v_exp_f32 v117, v117
  v_mfma_f32_32x32x16_bf16 v[176:191], a[196:199], a[120:123], v[176:191]
  ds_read_b128 a[180:183], v2 offset:6144
  v_exp_f32 v118, v118
  v_exp_f32 v119, v119
  v_mul_f32 v128, v128, v136
  v_mfma_f32_32x32x16_bf16 v[160:175], a[200:203], a[124:127], v[160:175]
  ds_read_b128 a[184:187], v2 offset:3072
  v_mul_f32 v129, v129, v137
  v_mul_f32 v130, v130, v138
  v_mul_f32 v131, v131, v139
  v_mul_f32 v132, v132, v140
  v_mul_f32 v133, v133, v141
  v_mfma_f32_32x32x16_bf16 v[176:191], a[204:207], a[124:127], v[176:191]
  ds_read_b128 a[188:191], v2 offset:7168
  v_mul_f32 v134, v134, v142
  v_mul_f32 v135, v135, v143
  v_fma_f32 v112, v112, v94, v94
  v_fma_f32 v113, v113, v94, v94
  s_waitcnt lgkmcnt(4)
  v_mfma_f32_32x32x16_bf16 v[160:175], a[160:163], a[128:131], v[160:175]
  ds_read_b128 a[192:195], v2 offset:8192
  buffer_load_dwordx4 v1, s[4:7], s32 offen offset:1024 lds
  v_fma_f32 v114, v114, v94, v94
  v_fma_f32 v115, v115, v94, v94
  v_fma_f32 v116, v116, v94, v94
  v_fma_f32 v117, v117, v94, v94
  v_mfma_f32_32x32x16_bf16 v[176:191], a[164:167], a[128:131], v[176:191]
  ds_read_b128 a[196:199], v2 offset:12288
  v_fma_f32 v118, v118, v94, v94
  v_fma_f32 v119, v119, v94, v94
  v_rcp_f32 v112, v112
  v_mfma_f32_32x32x16_bf16 v[160:175], a[168:171], a[132:135], v[160:175]
  ds_read_b128 a[200:203], v2 offset:9216
  v_rcp_f32 v113, v113
  v_rcp_f32 v114, v114
  v_mfma_f32_32x32x16_bf16 v[176:191], a[172:175], a[132:135], v[176:191]
  ds_read_b128 a[204:207], v2 offset:13312
  v_rcp_f32 v115, v115
  v_rcp_f32 v116, v116
  s_waitcnt lgkmcnt(4)
  v_mfma_f32_32x32x16_bf16 v[160:175], a[176:179], a[136:139], v[160:175]
  ds_read_b128 a[160:163], v2 offset:10240
  buffer_load_dwordx4 v1, s[4:7], s32 offen offset:2048 lds
  v_rcp_f32 v117, v117
  v_rcp_f32 v118, v118
  v_mfma_f32_32x32x16_bf16 v[176:191], a[180:183], a[136:139], v[176:191]
  ds_read_b128 a[164:167], v2 offset:14336
  v_rcp_f32 v119, v119
  v_mul_f32 v128, v128, v112
  v_mul_f32 v129, v129, v113
  v_mul_f32 v130, v130, v114
  v_mfma_f32_32x32x16_bf16 v[160:175], a[184:187], a[140:143], v[160:175]
  ds_read_b128 a[168:171], v2 offset:11264
  v_mul_f32 v131, v131, v115
  v_mul_f32 v132, v132, v116
  v_mul_f32 v133, v133, v117
  v_mul_f32 v134, v134, v118
  v_mul_f32 v135, v135, v119
  v_mfma_f32_32x32x16_bf16 v[176:191], a[188:191], a[140:143], v[176:191]
  ds_read_b128 a[172:175], v2 offset:15360
  v_cvt_pk_bf16_f32 v240, v128, v129
  v_cvt_pk_bf16_f32 v241, v130, v131
  v_cvt_pk_bf16_f32 v242, v132, v133
  v_cvt_pk_bf16_f32 v243, v134, v135
  s_waitcnt lgkmcnt(4)
  v_mfma_f32_32x32x16_bf16 v[160:175], a[192:195], a[144:147], v[160:175]
  s_waitcnt vmcnt(11)
  s_waitcnt vmcnt(7)
  s_barrier
  ds_read_b128 a[176:179], v2 offset:16384
  buffer_load_dwordx4 v1, s[4:7], s32 offen offset:3072 lds
  buffer_store_dwordx4 v[240:243], v1, s[4:7], s46 offen sc1
  v_mfma_f32_32x32x16_bf16 v[176:191], a[196:199], a[144:147], v[176:191]
  ds_read_b128 a[180:183], v2 offset:17408
  v_mul_f32 v120, v144, v144
  v_mul_f32 v121, v145, v145
  v_mul_f32 v122, v146, v146
  v_mul_f32 v123, v147, v147
  v_mul_f32 v124, v148, v148
  v_mfma_f32_32x32x16_bf16 v[160:175], a[200:203], a[148:151], v[160:175]
  ds_read_b128 a[184:187], v2 offset:18432
  s_add_u32 s33, s25, 28672
  buffer_load_dwordx4 v[128:131], v1, s[4:7], s33 offen
  v_mul_f32 v125, v149, v149
  v_mul_f32 v126, v150, v150
  v_mul_f32 v127, v151, v151
  v_mfma_f32_32x32x16_bf16 v[176:191], a[204:207], a[148:151], v[176:191]
  ds_read_b128 a[188:191], v2 offset:19456
  v_fma_f32 v120, v120, v92, v90
  v_fma_f32 v121, v121, v92, v90
  v_fma_f32 v122, v122, v92, v90
  v_fma_f32 v123, v123, v92, v90
  s_waitcnt lgkmcnt(4)
  v_mfma_f32_32x32x16_bf16 v[160:175], a[160:163], a[152:155], v[160:175]
  ds_read_b128 a[192:195], v2 offset:20480
  s_add_u32 m0, s26, 0
  s_add_u32 s32, s31, 65536
  buffer_load_dwordx4 v1, s[4:7], s32 offen offset:0 lds
  v_fma_f32 v124, v124, v92, v90
  v_fma_f32 v125, v125, v92, v90
  v_mfma_f32_32x32x16_bf16 v[176:191], a[164:167], a[152:155], v[176:191]
  ds_read_b128 a[196:199], v2 offset:21504
  v_fma_f32 v126, v126, v92, v90
  v_fma_f32 v127, v127, v92, v90
  v_mul_f32 v120, v120, v144
  v_mul_f32 v121, v121, v145
  v_mul_f32 v122, v122, v146
  v_mfma_f32_32x32x16_bf16 v[160:175], a[168:171], a[156:159], v[160:175]
  ds_read_b128 a[200:203], v2 offset:22528
  buffer_load_dwordx4 v[132:135], v1, s[4:7], s33 offen offset:1024
  v_mul_f32 v123, v123, v147
  v_mul_f32 v124, v124, v148
  v_mul_f32 v125, v125, v149
  v_mul_f32 v126, v126, v150
  v_mfma_f32_32x32x8_bf16 v[160:175], v[102:103], v[96:97], v[160:175]
  v_mfma_f32_32x32x16_bf16 v[176:191], a[172:175], a[156:159], v[176:191]
  ds_read_b128 a[204:207], v2 offset:23552
  v_mul_f32 v127, v127, v151
  v_exp_f32 v120, v120
  v_mfma_f32_32x32x8_bf16 v[176:191], v[104:105], v[96:97], v[176:191]
  s_waitcnt lgkmcnt(4)
  v_mfma_f32_32x32x16_bf16 v[192:207], a[176:179], a[0:3], 0
  ds_read_b128 a[160:163], v2 offset:24576
  buffer_load_dwordx4 v1, s[4:7], s32 offen offset:1024 lds
  v_exp_f32 v121, v121
  v_exp_f32 v122, v122
  v_mfma_f32_32x32x16_bf16 v[192:207], a[180:183], a[4:7], v[192:207]
  ds_read_b128 a[164:167], v2 offset:25600
  v_exp_f32 v123, v123
  v_exp_f32 v124, v124
  v_mfma_f32_32x32x16_bf16 v[192:207], a[184:187], a[8:11], v[192:207]
  ds_read_b128 a[168:171], v2 offset:26624
  buffer_load_dwordx4 v[136:139], v1, s[4:7], s33 offen offset:2048
  v_exp_f32 v125, v125
  v_exp_f32 v126, v126
  v_mfma_f32_32x32x16_bf16 v[192:207], a[188:191], a[12:15], v[192:207]
  ds_read_b128 a[172:175], v2 offset:27648
  v_exp_f32 v127, v127
  v_mul_f32 v144, v144, v152
  v_mul_f32 v145, v145, v153
  s_waitcnt lgkmcnt(4)
  v_mfma_f32_32x32x16_bf16 v[192:207], a[192:195], a[16:19], v[192:207]
  ds_read_b128 a[176:179], v2 offset:28672
  buffer_load_dwordx4 v1, s[4:7], s32 offen offset:2048 lds
  v_mul_f32 v146, v146, v154
  v_mul_f32 v147, v147, v155
  v_mul_f32 v148, v148, v156
  v_mul_f32 v149, v149, v157
  v_mfma_f32_32x32x16_bf16 v[192:207], a[196:199], a[20:23], v[192:207]
  ds_read_b128 a[180:183], v2 offset:29696
  v_mul_f32 v150, v150, v158
  v_mul_f32 v151, v151, v159
  v_fma_f32 v120, v120, v94, v94
  v_fma_f32 v121, v121, v94, v94
  v_fma_f32 v122, v122, v94, v94
  v_mfma_f32_32x32x16_bf16 v[192:207], a[200:203], a[24:27], v[192:207]
  ds_read_b128 a[184:187], v2 offset:30720
  buffer_load_dwordx4 v[140:143], v1, s[4:7], s33 offen offset:3072
  v_fma_f32 v123, v123, v94, v94
  v_fma_f32 v124, v124, v94, v94
  v_fma_f32 v125, v125, v94, v94
  v_fma_f32 v126, v126, v94, v94
  v_mfma_f32_32x32x16_bf16 v[192:207], a[204:207], a[28:31], v[192:207]
  ds_read_b128 a[188:191], v2 offset:31744
  v_fma_f32 v127, v127, v94, v94
  v_rcp_f32 v120, v120
  s_waitcnt lgkmcnt(4)
  v_mfma_f32_32x32x16_bf16 v[192:207], a[160:163], a[32:35], v[192:207]
  ds_read_b128 a[192:195], v2 offset:32768
  buffer_load_dwordx4 v1, s[4:7], s32 offen offset:3072 lds
  v_rcp_f32 v121, v121
  v_rcp_f32 v122, v122
  v_mfma_f32_32x32x16_bf16 v[192:207], a[164:167], a[36:39], v[192:207]
  ds_read_b128 a[196:199], v2 offset:33792
  v_rcp_f32 v123, v123
  v_rcp_f32 v124, v124
  v_mfma_f32_32x32x16_bf16 v[192:207], a[168:171], a[40:43], v[192:207]
  ds_read_b128 a[200:203], v2 offset:34816
  v_rcp_f32 v125, v125
  v_rcp_f32 v126, v126
  v_mfma_f32_32x32x16_bf16 v[192:207], a[172:175], a[44:47], v[192:207]
  ds_read_b128 a[204:207], v2 offset:35840
  v_rcp_f32 v127, v127
  v_mul_f32 v144, v144, v120
  v_mul_f32 v145, v145, v121
  s_waitcnt lgkmcnt(4)
  v_mfma_f32_32x32x16_bf16 v[192:207], a[176:179], a[48:51], v[192:207]
  ds_read_b128 a[160:163], v2 offset:36864
  s_add_u32 m0, s26, 16384
  s_add_u32 s32, s31, 81920
  buffer_load_dwordx4 v1, s[4:7], s32 offen offset:0 lds
  v_mul_f32 v146, v146, v122
  v_mul_f32 v147, v147, v123
  v_mfma_f32_32x32x16_bf16 v[192:207], a[180:183], a[52:55], v[192:207]
  ds_read_b128 a[164:167], v2 offset:37888
  v_mul_f32 v148, v148, v124
  v_mul_f32 v149, v149, v125
  v_mul_f32 v150, v150, v126
  v_mul_f32 v151, v151, v127
  v_cvt_pk_bf16_f32 v244, v144, v145
  v_mfma_f32_32x32x16_bf16 v[192:207], a[184:187], a[56:59], v[192:207]
  ds_read_b128 a[168:171], v2 offset:38912
  v_cvt_pk_bf16_f32 v245, v146, v147
  v_cvt_pk_bf16_f32 v246, v148, v149
  v_cvt_pk_bf16_f32 v247, v150, v151
  v_mfma_f32_32x32x16_bf16 v[192:207], a[188:191], a[60:63], v[192:207]
  ds_read_b128 a[172:175], v2 offset:39936
  buffer_store_dwordx4 v[244:247], v1, s[4:7], s46 offen offset:1024 sc1
  s_waitcnt lgkmcnt(4)
  v_mfma_f32_32x32x16_bf16 v[192:207], a[192:195], a[64:67], v[192:207]
  ds_read_b128 a[176:179], v2 offset:40960
  buffer_load_dwordx4 v1, s[4:7], s32 offen offset:1024 lds
  v_mul_f32 v112, v160, v160
  v_mul_f32 v113, v161, v161
  v_mul_f32 v114, v162, v162
  v_mul_f32 v115, v163, v163
  v_mfma_f32_32x32x16_bf16 v[192:207], a[196:199], a[68:71], v[192:207]
  ds_read_b128 a[180:183], v2 offset:41984
  v_mul_f32 v116, v164, v164
  v_mul_f32 v117, v165, v165
  v_mul_f32 v118, v166, v166
  v_mul_f32 v119, v167, v167
  v_fma_f32 v112, v112, v92, v90
  v_mfma_f32_32x32x16_bf16 v[192:207], a[200:203], a[72:75], v[192:207]
  ds_read_b128 a[184:187], v2 offset:43008
  s_add_u32 s33, s25, 32768
  buffer_load_dwordx4 v[144:147], v1, s[4:7], s33 offen
  v_fma_f32 v113, v113, v92, v90
  v_fma_f32 v114, v114, v92, v90
  v_fma_f32 v115, v115, v92, v90
  v_mfma_f32_32x32x16_bf16 v[192:207], a[204:207], a[76:79], v[192:207]
  ds_read_b128 a[188:191], v2 offset:44032
  v_fma_f32 v116, v116, v92, v90
  v_fma_f32 v117, v117, v92, v90
  v_fma_f32 v118, v118, v92, v90
  v_fma_f32 v119, v119, v92, v90
  s_waitcnt lgkmcnt(4)
  v_mfma_f32_32x32x16_bf16 v[192:207], a[160:163], a[80:83], v[192:207]
  ds_read_b128 a[192:195], v2 offset:45056
  buffer_load_dwordx4 v1, s[4:7], s32 offen offset:2048 lds
  v_mul_f32 v112, v112, v160
  v_mul_f32 v113, v113, v161
  v_mul_f32 v114, v114, v162
  v_mul_f32 v115, v115, v163
  v_mfma_f32_32x32x16_bf16 v[192:207], a[164:167], a[84:87], v[192:207]
  ds_read_b128 a[196:199], v2 offset:46080
  v_mul_f32 v116, v116, v164
  v_mul_f32 v117, v117, v165
  v_mul_f32 v118, v118, v166
  v_mul_f32 v119, v119, v167
  v_mfma_f32_32x32x16_bf16 v[192:207], a[168:171], a[88:91], v[192:207]
  ds_read_b128 a[200:203], v2 offset:47104
  buffer_load_dwordx4 v[148:151], v1, s[4:7], s33 offen offset:1024
  v_exp_f32 v112, v112
  v_exp_f32 v113, v113
  v_mfma_f32_32x32x16_bf16 v[192:207], a[172:175], a[92:95], v[192:207]
  ds_read_b128 a[204:207], v2 offset:48128
  v_exp_f32 v114, v114
  v_exp_f32 v115, v115
  s_waitcnt lgkmcnt(4)
  v_mfma_f32_32x32x16_bf16 v[192:207], a[176:179], a[96:99], v[192:207]
  s_waitcnt vmcnt(19)
  s_waitcnt vmcnt(15)
  s_barrier
  ds_read_b128 a[160:163], v2 offset:49152
  buffer_load_dwordx4 v1, s[4:7], s32 offen offset:3072 lds
  v_exp_f32 v116, v116
  v_exp_f32 v117, v117
  v_mfma_f32_32x32x16_bf16 v[192:207], a[180:183], a[100:103], v[192:207]
  ds_read_b128 a[164:167], v2 offset:50176
  v_exp_f32 v118, v118
  v_exp_f32 v119, v119
  v_mul_f32 v160, v160, v168
  v_mfma_f32_32x32x16_bf16 v[192:207], a[184:187], a[104:107], v[192:207]
  ds_read_b128 a[168:171], v2 offset:51200
  buffer_load_dwordx4 v[152:155], v1, s[4:7], s33 offen offset:2048
  v_mul_f32 v161, v161, v169
  v_mul_f32 v162, v162, v170
  v_mul_f32 v163, v163, v171
  v_mul_f32 v164, v164, v172
  v_mfma_f32_32x32x16_bf16 v[192:207], a[188:191], a[108:111], v[192:207]
  ds_read_b128 a[172:175], v2 offset:52224
  v_mul_f32 v165, v165, v173
  v_mul_f32 v166, v166, v174
  v_mul_f32 v167, v167, v175
  v_fma_f32 v112, v112, v94, v94
  s_waitcnt lgkmcnt(4)
  v_mfma_f32_32x32x16_bf16 v[192:207], a[192:195], a[112:115], v[192:207]
  ds_read_b128 a[176:179], v2 offset:53248
  s_add_u32 m0, s26, 32768
  s_add_u32 s32, s31, 98304
  buffer_load_dwordx4 v1, s[4:7], s32 offen offset:0 lds
  v_fma_f32 v113, v113, v94, v94
  v_fma_f32 v114, v114, v94, v94
  v_mfma_f32_32x32x16_bf16 v[192:207], a[196:199], a[116:119], v[192:207]
  ds_read_b128 a[180:183], v2 offset:54272
  buffer_load_dwordx4 v1, s[4:7], s32 offen offset:1024 lds
  v_fma_f32 v115, v115, v94, v94
  v_fma_f32 v116, v116, v94, v94
  v_fma_f32 v117, v117, v94, v94
  v_fma_f32 v118, v118, v94, v94
  v_mfma_f32_32x32x16_bf16 v[192:207], a[200:203], a[120:123], v[192:207]
  ds_read_b128 a[184:187], v2 offset:55296
  buffer_load_dwordx4 v[156:159], v1, s[4:7], s33 offen offset:3072
  v_fma_f32 v119, v119, v94, v94
  v_rcp_f32 v112, v112
  v_mfma_f32_32x32x16_bf16 v[192:207], a[204:207], a[124:127], v[192:207]
  ds_read_b128 a[188:191], v2 offset:56320
  v_rcp_f32 v113, v113
  v_rcp_f32 v114, v114
  s_waitcnt lgkmcnt(4)
  v_mfma_f32_32x32x16_bf16 v[192:207], a[160:163], a[128:131], v[192:207]
  ds_read_b128 a[192:195], v2 offset:57344
  buffer_load_dwordx4 v1, s[4:7], s32 offen offset:2048 lds
  v_rcp_f32 v115, v115
  v_rcp_f32 v116, v116
  v_mfma_f32_32x32x16_bf16 v[192:207], a[164:167], a[132:135], v[192:207]
  ds_read_b128 a[196:199], v2 offset:58368
  v_rcp_f32 v117, v117
  v_rcp_f32 v118, v118
  v_mfma_f32_32x32x16_bf16 v[192:207], a[168:171], a[136:139], v[192:207]
  ds_read_b128 a[200:203], v2 offset:59392
  v_rcp_f32 v119, v119
  v_mul_f32 v160, v160, v112
  v_mul_f32 v161, v161, v113
  v_mul_f32 v162, v162, v114
  v_mfma_f32_32x32x16_bf16 v[192:207], a[172:175], a[140:143], v[192:207]
  ds_read_b128 a[204:207], v2 offset:60416
  v_mul_f32 v163, v163, v115
  v_mul_f32 v164, v164, v116
  v_mul_f32 v165, v165, v117
  v_mul_f32 v166, v166, v118
  s_waitcnt lgkmcnt(4)
  v_mfma_f32_32x32x16_bf16 v[192:207], a[176:179], a[144:147], v[192:207]
  ds_read_b128 a[160:163], v2 offset:61440
  buffer_load_dwordx4 v1, s[4:7], s32 offen offset:3072 lds
  v_mul_f32 v167, v167, v119
  v_cvt_pk_bf16_f32 v240, v160, v161
  v_cvt_pk_bf16_f32 v241, v162, v163
  v_cvt_pk_bf16_f32 v242, v164, v165
  v_mfma_f32_32x32x16_bf16 v[192:207], a[180:183], a[148:151], v[192:207]
  ds_read_b128 a[164:167], v2 offset:62464
  s_add_u32 m0, s26, 65536
  s_add_u32 s32, s25, 45056
  buffer_load_dwordx4 v1, s[4:7], s32 offen offset:0 lds
  v_cvt_pk_bf16_f32 v243, v166, v167
  v_mfma_f32_32x32x16_bf16 v[192:207], a[184:187], a[152:155], v[192:207]
  ds_read_b128 a[168:171], v2 offset:63488
  buffer_store_dwordx4 v[240:243], v1, s[4:7], s46 offen offset:2048 sc1
  v_mfma_f32_32x32x16_bf16 v[192:207], a[188:191], a[156:159], v[192:207]
  ds_read_b128 a[172:175], v2 offset:64512
  v_mul_f32 v120, v176, v176
  v_mul_f32 v121, v177, v177
  v_mul_f32 v122, v178, v178
  v_mul_f32 v123, v179, v179
  v_mfma_f32_32x32x8_bf16 v[192:207], v[106:107], v[96:97], v[192:207]
  s_waitcnt lgkmcnt(4)
  v_mfma_f32_32x32x16_bf16 v[208:223], a[192:195], a[0:3], 0
  ds_read_b128 a[176:179], v3
  buffer_load_dwordx4 v1, s[4:7], s32 offen offset:1024 lds
  v_mul_f32 v124, v180, v180
  v_mul_f32 v125, v181, v181
  v_mul_f32 v126, v182, v182
  v_mul_f32 v127, v183, v183
  v_mfma_f32_32x32x16_bf16 v[208:223], a[196:199], a[4:7], v[208:223]
  ds_read_b128 a[180:183], v3 offset:1024
  s_add_u32 s69, s63, s65
  buffer_load_dwordx4 v[80:83], v9, s[4:7], s69 offen sc1
  buffer_load_dwordx4 v[84:87], v9, s[4:7], s69 offen offset:2048 sc1
  buffer_load_dwordx2 v[88:89], v10, s[4:7], s69 offen sc1
  v_fma_f32 v120, v120, v92, v90
  v_mfma_f32_32x32x16_bf16 v[208:223], a[200:203], a[8:11], v[208:223]
  ds_read_b128 a[184:187], v3 offset:2048
  s_add_u32 s33, s25, 36864
  buffer_load_dwordx4 v[160:163], v1, s[4:7], s33 offen
  v_fma_f32 v121, v121, v92, v90
  v_fma_f32 v122, v122, v92, v90
  v_fma_f32 v123, v123, v92, v90
  v_mfma_f32_32x32x16_bf16 v[208:223], a[204:207], a[12:15], v[208:223]
  ds_read_b128 a[188:191], v3 offset:3072
  v_fma_f32 v124, v124, v92, v90
  v_fma_f32 v125, v125, v92, v90
  v_fma_f32 v126, v126, v92, v90
  v_fma_f32 v127, v127, v92, v90
  s_waitcnt lgkmcnt(4)
  v_mfma_f32_32x32x16_bf16 v[208:223], a[160:163], a[16:19], v[208:223]
  ds_read_b128 a[192:195], v3 offset:4096
  buffer_load_dwordx4 v1, s[4:7], s32 offen offset:2048 lds
  v_mul_f32 v120, v120, v176
  v_mul_f32 v121, v121, v177
  v_mul_f32 v122, v122, v178
  v_mul_f32 v123, v123, v179
  v_mfma_f32_32x32x16_bf16 v[208:223], a[164:167], a[20:23], v[208:223]
  ds_read_b128 a[196:199], v3 offset:5120
  buffer_load_dwordx4 v1, s[4:7], s32 offen offset:3072 lds
  v_mul_f32 v124, v124, v180
  v_mul_f32 v125, v125, v181
  v_mul_f32 v126, v126, v182
  v_mul_f32 v127, v127, v183
  v_mfma_f32_32x32x16_bf16 v[208:223], a[168:171], a[24:27], v[208:223]
  ds_read_b128 a[200:203], v3 offset:6144
  buffer_load_dwordx4 v[164:167], v1, s[4:7], s33 offen offset:1024
  v_exp_f32 v120, v120
  v_exp_f32 v121, v121
  v_mfma_f32_32x32x16_bf16 v[208:223], a[172:175], a[28:31], v[208:223]
  ds_read_b128 a[204:207], v3 offset:7168
  v_exp_f32 v122, v122
  v_exp_f32 v123, v123
  s_waitcnt lgkmcnt(4)
  v_mfma_f32_32x32x16_bf16 v[208:223], a[176:179], a[32:35], v[208:223]
  ds_read_b128 a[160:163], v3 offset:8192
  s_add_u32 m0, s26, 49152
  s_add_u32 s32, s31, 114688
  buffer_load_dwordx4 v1, s[4:7], s32 offen offset:0 lds
  v_exp_f32 v124, v124
  v_mfma_f32_32x32x16_bf16 v[208:223], a[180:183], a[36:39], v[208:223]
  ds_read_b128 a[164:167], v3 offset:9216
  v_exp_f32 v125, v125
  v_exp_f32 v126, v126
  v_mfma_f32_32x32x16_bf16 v[208:223], a[184:187], a[40:43], v[208:223]
  ds_read_b128 a[168:171], v3 offset:10240
  buffer_load_dwordx4 v[168:171], v1, s[4:7], s33 offen offset:2048
  v_exp_f32 v127, v127
  v_mul_f32 v176, v176, v184
  v_mul_f32 v177, v177, v185
  v_mfma_f32_32x32x16_bf16 v[208:223], a[188:191], a[44:47], v[208:223]
  ds_read_b128 a[172:175], v3 offset:11264
  v_mul_f32 v178, v178, v186
  v_mul_f32 v179, v179, v187
  v_mul_f32 v180, v180, v188
  v_mul_f32 v181, v181, v189
  s_waitcnt lgkmcnt(4)
  v_mfma_f32_32x32x16_bf16 v[208:223], a[192:195], a[48:51], v[208:223]
  ds_read_b128 a[176:179], v3 offset:12288
  buffer_load_dwordx4 v1, s[4:7], s32 offen offset:1024 lds
  v_mul_f32 v182, v182, v190
  v_mul_f32 v183, v183, v191
  v_fma_f32 v120, v120, v94, v94
  v_fma_f32 v121, v121, v94, v94
  v_mfma_f32_32x32x16_bf16 v[208:223], a[196:199], a[52:55], v[208:223]
  ds_read_b128 a[180:183], v3 offset:13312
  buffer_load_dwordx4 v1, s[4:7], s32 offen offset:2048 lds
  v_fma_f32 v122, v122, v94, v94
  v_fma_f32 v123, v123, v94, v94
  v_fma_f32 v124, v124, v94, v94
  v_fma_f32 v125, v125, v94, v94
  v_mfma_f32_32x32x16_bf16 v[208:223], a[200:203], a[56:59], v[208:223]
  ds_read_b128 a[184:187], v3 offset:14336
  buffer_load_dwordx4 v[172:175], v1, s[4:7], s33 offen offset:3072
  v_fma_f32 v126, v126, v94, v94
  v_fma_f32 v127, v127, v94, v94
  v_rcp_f32 v120, v120
  v_mfma_f32_32x32x16_bf16 v[208:223], a[204:207], a[60:63], v[208:223]
  ds_read_b128 a[188:191], v3 offset:15360
  v_rcp_f32 v121, v121
  v_rcp_f32 v122, v122
  s_waitcnt lgkmcnt(4)
  v_mfma_f32_32x32x16_bf16 v[208:223], a[160:163], a[64:67], v[208:223]
  s_waitcnt vmcnt(28)
  s_waitcnt vmcnt(21)
  s_barrier
  ds_read_b128 a[192:195], v1
  buffer_load_dwordx4 v1, s[4:7], s32 offen offset:3072 lds
  v_rcp_f32 v123, v123
  v_rcp_f32 v124, v124
  v_mfma_f32_32x32x16_bf16 v[208:223], a[164:167], a[68:71], v[208:223]
  ds_read_b128 a[196:199], v1 offset:1024
  v_rcp_f32 v125, v125
  v_rcp_f32 v126, v126
  v_mfma_f32_32x32x16_bf16 v[208:223], a[168:171], a[72:75], v[208:223]
  ds_read_b128 a[200:203], v1 offset:2048
  v_rcp_f32 v127, v127
  v_mul_f32 v176, v176, v120
  v_mul_f32 v177, v177, v121
  v_mul_f32 v178, v178, v122
  v_mfma_f32_32x32x16_bf16 v[208:223], a[172:175], a[76:79], v[208:223]
  ds_read_b128 a[204:207], v1 offset:3072
  v_mul_f32 v179, v179, v123
  v_mul_f32 v180, v180, v124
  v_mul_f32 v181, v181, v125
  v_mul_f32 v182, v182, v126
  s_waitcnt lgkmcnt(4)
  v_mfma_f32_32x32x16_bf16 v[208:223], a[176:179], a[80:83], v[208:223]
  ds_read_b128 a[160:163], v1 offset:4096
  s_add_u32 m0, s26, 81920
  s_add_u32 s32, s25, 49152
  buffer_load_dwordx4 v1, s[4:7], s32 offen offset:0 lds
  v_mul_f32 v183, v183, v127
  v_cvt_pk_bf16_f32 v244, v176, v177
  v_mfma_f32_32x32x16_bf16 v[208:223], a[180:183], a[84:87], v[208:223]
  ds_read_b128 a[164:167], v1 offset:5120
  buffer_load_dwordx4 v1, s[4:7], s32 offen offset:1024 lds
  v_cvt_pk_bf16_f32 v245, v178, v179
  v_cvt_pk_bf16_f32 v246, v180, v181
  v_cvt_pk_bf16_f32 v247, v182, v183
  v_mfma_f32_32x32x16_bf16 v[208:223], a[184:187], a[88:91], v[208:223]
  ds_read_b128 a[168:171], v1 offset:6144
  buffer_store_dwordx4 v[244:247], v1, s[4:7], s46 offen offset:3072 sc1
  v_mfma_f32_32x32x16_bf16 v[208:223], a[188:191], a[92:95], v[208:223]
  ds_read_b128 a[172:175], v1 offset:7168
  v_mul_f32 v112, v192, v192
  v_mul_f32 v113, v193, v193
  v_mul_f32 v114, v194, v194
  v_mul_f32 v115, v195, v195
  s_waitcnt lgkmcnt(4)
  v_mfma_f32_32x32x16_bf16 v[208:223], a[192:195], a[96:99], v[208:223]
  ds_read_b128 a[176:179], v1 offset:8192
  buffer_load_dwordx4 v1, s[4:7], s32 offen offset:2048 lds
  v_mul_f32 v116, v196, v196
  v_mul_f32 v117, v197, v197
  v_mul_f32 v118, v198, v198
  v_mul_f32 v119, v199, v199
  v_mfma_f32_32x32x16_bf16 v[208:223], a[196:199], a[100:103], v[208:223]
  ds_read_b128 a[180:183], v1 offset:9216
  v_fma_f32 v112, v112, v92, v90
  v_fma_f32 v113, v113, v92, v90
  v_fma_f32 v114, v114, v92, v90
  v_fma_f32 v115, v115, v92, v90
  v_fma_f32 v116, v116, v92, v90
  v_mfma_f32_32x32x16_bf16 v[208:223], a[200:203], a[104:107], v[208:223]
  ds_read_b128 a[184:187], v1 offset:10240
  s_add_u32 s33, s25, 40960
  buffer_load_dwordx4 v[176:179], v1, s[4:7], s33 offen
  v_fma_f32 v117, v117, v92, v90
  v_fma_f32 v118, v118, v92, v90
  v_fma_f32 v119, v119, v92, v90
  v_mfma_f32_32x32x16_bf16 v[208:223], a[204:207], a[108:111], v[208:223]
  ds_read_b128 a[188:191], v1 offset:11264
  v_mul_f32 v112, v112, v192
  v_mul_f32 v113, v113, v193
  v_mul_f32 v114, v114, v194
  v_mul_f32 v115, v115, v195
  s_waitcnt lgkmcnt(4)
  v_mfma_f32_32x32x16_bf16 v[208:223], a[160:163], a[112:115], v[208:223]
  ds_read_b128 a[192:195], v1 offset:12288
  buffer_load_dwordx4 v1, s[4:7], s32 offen offset:3072 lds
  v_mul_f32 v116, v116, v196
  v_mul_f32 v117, v117, v197
  v_mul_f32 v118, v118, v198
  v_mul_f32 v119, v119, v199
  v_mfma_f32_32x32x16_bf16 v[208:223], a[164:167], a[116:119], v[208:223]
  ds_read_b128 a[196:199], v1 offset:13312
  v_exp_f32 v112, v112
  v_exp_f32 v113, v113
  v_mfma_f32_32x32x16_bf16 v[208:223], a[168:171], a[120:123], v[208:223]
  ds_read_b128 a[200:203], v1 offset:14336
  buffer_load_dwordx4 v[180:183], v1, s[4:7], s33 offen offset:1024
  v_exp_f32 v114, v114
  v_exp_f32 v115, v115
  v_mfma_f32_32x32x16_bf16 v[208:223], a[172:175], a[124:127], v[208:223]
  ds_read_b128 a[204:207], v1 offset:15360
  v_exp_f32 v116, v116
  v_exp_f32 v117, v117
  s_waitcnt lgkmcnt(4)
  v_mfma_f32_32x32x16_bf16 v[208:223], a[176:179], a[128:131], v[208:223]
  ds_read_b128 a[160:163], v1 offset:16384
  s_add_u32 m0, s26, 98304
  s_add_u32 s32, s25, 53248
  buffer_load_dwordx4 v1, s[4:7], s32 offen offset:0 lds
  v_exp_f32 v118, v118
  v_mfma_f32_32x32x16_bf16 v[208:223], a[180:183], a[132:135], v[208:223]
  ds_read_b128 a[164:167], v1 offset:17408
  buffer_load_dwordx4 v1, s[4:7], s32 offen offset:1024 lds
  v_exp_f32 v119, v119
  v_mul_f32 v192, v192, v200
  v_mul_f32 v193, v193, v201
  v_mfma_f32_32x32x16_bf16 v[208:223], a[184:187], a[136:139], v[208:223]
  ds_read_b128 a[168:171], v1 offset:18432
  buffer_load_dwordx4 v[184:187], v1, s[4:7], s33 offen offset:2048
  v_mul_f32 v194, v194, v202
  v_mul_f32 v195, v195, v203
  v_mul_f32 v196, v196, v204
  v_mul_f32 v197, v197, v205
  v_mfma_f32_32x32x16_bf16 v[208:223], a[188:191], a[140:143], v[208:223]
  ds_read_b128 a[172:175], v1 offset:19456
  v_mul_f32 v198, v198, v206
  v_mul_f32 v199, v199, v207
  v_fma_f32 v112, v112, v94, v94
  v_fma_f32 v113, v113, v94, v94
  s_waitcnt lgkmcnt(4)
  v_mfma_f32_32x32x16_bf16 v[208:223], a[192:195], a[144:147], v[208:223]
  ds_read_b128 a[176:179], v1 offset:20480
  buffer_load_dwordx4 v1, s[4:7], s32 offen offset:2048 lds
  v_fma_f32 v114, v114, v94, v94
  v_fma_f32 v115, v115, v94, v94
  v_fma_f32 v116, v116, v94, v94
  v_fma_f32 v117, v117, v94, v94
  v_mfma_f32_32x32x16_bf16 v[208:223], a[196:199], a[148:151], v[208:223]
  ds_read_b128 a[180:183], v1 offset:21504
  buffer_load_dwordx4 v1, s[4:7], s32 offen offset:3072 lds
  v_fma_f32 v118, v118, v94, v94
  v_fma_f32 v119, v119, v94, v94
  v_rcp_f32 v112, v112
  v_mfma_f32_32x32x16_bf16 v[208:223], a[200:203], a[152:155], v[208:223]
  ds_read_b128 a[184:187], v1 offset:22528
  buffer_load_dwordx4 v[188:191], v1, s[4:7], s33 offen offset:3072
  v_rcp_f32 v113, v113
  v_rcp_f32 v114, v114
  v_mfma_f32_32x32x16_bf16 v[208:223], a[204:207], a[156:159], v[208:223]
  ds_read_b128 a[188:191], v1 offset:23552
  v_rcp_f32 v115, v115
  v_rcp_f32 v116, v116
  v_mfma_f32_32x32x8_bf16 v[208:223], v[108:109], v[96:97], v[208:223]
  s_waitcnt lgkmcnt(4)
  v_mfma_f32_32x32x16_bf16 v[224:239], a[160:163], a[0:3], 0
  s_waitcnt vmcnt(10)
  s_mov_b64 exec, 1
  buffer_store_byte v14, v15, s[4:7], s58 offen
  s_mov_b64 exec, -1
  s_sub_u32 s58, s58, 3072
  ds_read_b128 a[192:195], v1 offset:24576
  s_add_u32 m0, s26, 114688
  s_add_u32 s32, s25, 57344
  buffer_load_dwordx4 v1, s[4:7], s32 offen offset:0 lds
  v_rcp_f32 v117, v117
  v_mfma_f32_32x32x16_bf16 v[224:239], a[164:167], a[4:7], v[224:239]
  ds_read_b128 a[196:199], v1 offset:25600
  v_rcp_f32 v118, v118
  v_rcp_f32 v119, v119
  v_mul_f32 v192, v192, v112
  v_mfma_f32_32x32x16_bf16 v[224:239], a[168:171], a[8:11], v[224:239]
  ds_read_b128 a[200:203], v1 offset:26624
  v_mul_f32 v193, v193, v113
  v_mul_f32 v194, v194, v114
  v_mul_f32 v195, v195, v115
  v_mul_f32 v196, v196, v116
  v_mul_f32 v197, v197, v117
  v_mfma_f32_32x32x16_bf16 v[224:239], a[172:175], a[12:15], v[224:239]
  ds_read_b128 a[204:207], v1 offset:27648
  v_mul_f32 v198, v198, v118
  v_mul_f32 v199, v199, v119
  v_cvt_pk_bf16_f32 v240, v192, v193
  v_cvt_pk_bf16_f32 v241, v194, v195
  s_waitcnt lgkmcnt(4)
  v_mfma_f32_32x32x16_bf16 v[224:239], a[176:179], a[16:19], v[224:239]
  ds_read_b128 a[160:163], v1 offset:28672
  buffer_load_dwordx4 v1, s[4:7], s32 offen offset:1024 lds
  v_cvt_pk_bf16_f32 v242, v196, v197
  v_cvt_pk_bf16_f32 v243, v198, v199
  v_mfma_f32_32x32x16_bf16 v[224:239], a[180:183], a[20:23], v[224:239]
  ds_read_b128 a[164:167], v1 offset:29696
  buffer_load_dwordx4 v1, s[4:7], s32 offen offset:2048 lds
  buffer_store_dwordx4 v[240:243], v1, s[4:7], s50 offen sc1
  v_mul_f32 v120, v208, v208
  v_mul_f32 v121, v209, v209
  v_mul_f32 v122, v210, v210
  v_mfma_f32_32x32x16_bf16 v[224:239], a[184:187], a[24:27], v[224:239]
  ds_read_b128 a[168:171], v1 offset:30720
  v_mul_f32 v123, v211, v211
  v_mul_f32 v124, v212, v212
  v_mul_f32 v125, v213, v213
  v_mul_f32 v126, v214, v214
  v_mul_f32 v127, v215, v215
  v_mfma_f32_32x32x16_bf16 v[224:239], a[188:191], a[28:31], v[224:239]
  ds_read_b128 a[172:175], v1 offset:31744
  v_fma_f32 v120, v120, v92, v90
  v_fma_f32 v121, v121, v92, v90
  v_fma_f32 v122, v122, v92, v90
  v_fma_f32 v123, v123, v92, v90
  s_waitcnt lgkmcnt(4)
  v_mfma_f32_32x32x16_bf16 v[224:239], a[192:195], a[32:35], v[224:239]
  s_barrier
  ds_read_b128 a[176:179], v1 offset:32768
  buffer_load_dwordx4 v1, s[4:7], s32 offen offset:3072 lds
  v_fma_f32 v124, v124, v92, v90
  v_fma_f32 v125, v125, v92, v90
  v_fma_f32 v126, v126, v92, v90
  v_fma_f32 v127, v127, v92, v90
  v_mfma_f32_32x32x16_bf16 v[224:239], a[196:199], a[36:39], v[224:239]
  ds_read_b128 a[180:183], v1 offset:33792
  v_mul_f32 v120, v120, v208
  v_mul_f32 v121, v121, v209
  v_mul_f32 v122, v122, v210
  v_mul_f32 v123, v123, v211
  v_mul_f32 v124, v124, v212
  v_mfma_f32_32x32x16_bf16 v[224:239], a[200:203], a[40:43], v[224:239]
  ds_read_b128 a[184:187], v1 offset:34816
  v_mul_f32 v125, v125, v213
  v_mul_f32 v126, v126, v214
  v_mul_f32 v127, v127, v215
  v_exp_f32 v120, v120
  v_mfma_f32_32x32x16_bf16 v[224:239], a[204:207], a[44:47], v[224:239]
  ds_read_b128 a[188:191], v1 offset:35840
  v_exp_f32 v121, v121
  v_exp_f32 v122, v122
  s_waitcnt lgkmcnt(4)
  v_mfma_f32_32x32x16_bf16 v[224:239], a[160:163], a[48:51], v[224:239]
  buffer_load_dwordx4 v[252:255], v15, s[4:7], s95 offen sc1
  ds_read_b128 a[192:195], v1 offset:36864
  s_add_u32 m0, s26, 131072
  s_add_u32 s32, s25, 61440
  buffer_load_dwordx4 v1, s[4:7], s32 offen offset:0 lds
  v_exp_f32 v123, v123
  v_mfma_f32_32x32x16_bf16 v[224:239], a[164:167], a[52:55], v[224:239]
  ds_read_b128 a[196:199], v1 offset:37888
  buffer_load_dwordx4 v1, s[4:7], s32 offen offset:1024 lds
  v_exp_f32 v124, v124
  v_exp_f32 v125, v125
  v_mfma_f32_32x32x16_bf16 v[224:239], a[168:171], a[56:59], v[224:239]
  ds_read_b128 a[200:203], v1 offset:38912
  v_exp_f32 v126, v126
  v_exp_f32 v127, v127
  v_mul_f32 v208, v208, v216
  v_mfma_f32_32x32x16_bf16 v[224:239], a[172:175], a[60:63], v[224:239]
  ds_read_b128 a[204:207], v1 offset:39936
  v_mul_f32 v209, v209, v217
  v_mul_f32 v210, v210, v218
  v_mul_f32 v211, v211, v219
  v_mul_f32 v212, v212, v220
  s_waitcnt lgkmcnt(4)
  v_mfma_f32_32x32x16_bf16 v[224:239], a[176:179], a[64:67], v[224:239]
  ds_read_b128 a[160:163], v1 offset:40960
  buffer_load_dwordx4 v1, s[4:7], s32 offen offset:2048 lds
  v_mul_f32 v213, v213, v221
  v_mul_f32 v214, v214, v222
  v_mul_f32 v215, v215, v223
  v_fma_f32 v120, v120, v94, v94
  v_mfma_f32_32x32x16_bf16 v[224:239], a[180:183], a[68:71], v[224:239]
  ds_read_b128 a[164:167], v1 offset:41984
  v_fma_f32 v121, v121, v94, v94
  v_fma_f32 v122, v122, v94, v94
  v_fma_f32 v123, v123, v94, v94
  v_fma_f32 v124, v124, v94, v94
  v_fma_f32 v125, v125, v94, v94
  v_mfma_f32_32x32x16_bf16 v[224:239], a[184:187], a[72:75], v[224:239]
  ds_read_b128 a[168:171], v1 offset:43008
  v_fma_f32 v126, v126, v94, v94
  v_fma_f32 v127, v127, v94, v94
  v_rcp_f32 v120, v120
  v_mfma_f32_32x32x16_bf16 v[224:239], a[188:191], a[76:79], v[224:239]
  ds_read_b128 a[172:175], v1 offset:44032
  v_rcp_f32 v121, v121
  v_rcp_f32 v122, v122
  s_waitcnt lgkmcnt(4)
  v_mfma_f32_32x32x16_bf16 v[224:239], a[192:195], a[80:83], v[224:239]
  ds_read_b128 a[176:179], v1 offset:45056
  buffer_load_dwordx4 v1, s[4:7], s32 offen offset:3072 lds
  v_rcp_f32 v123, v123
  v_rcp_f32 v124, v124
  v_mfma_f32_32x32x16_bf16 v[224:239], a[196:199], a[84:87], v[224:239]
  ds_read_b128 a[180:183], v1 offset:46080
  v_rcp_f32 v125, v125
  v_rcp_f32 v126, v126
  v_mfma_f32_32x32x16_bf16 v[224:239], a[200:203], a[88:91], v[224:239]
  ds_read_b128 a[184:187], v1 offset:47104
  v_rcp_f32 v127, v127
  v_mul_f32 v208, v208, v120
  v_mul_f32 v209, v209, v121
  v_mul_f32 v210, v210, v122
  v_mfma_f32_32x32x16_bf16 v[224:239], a[204:207], a[92:95], v[224:239]
  ds_read_b128 a[188:191], v1 offset:48128
  v_mul_f32 v211, v211, v123
  v_mul_f32 v212, v212, v124
  v_mul_f32 v213, v213, v125
  v_mul_f32 v214, v214, v126
  s_waitcnt lgkmcnt(4)
  v_mfma_f32_32x32x16_bf16 v[224:239], a[160:163], a[96:99], v[224:239]
  s_mov_b32 s59, 0
  s_waitcnt vmcnt(4)
RP_22:
  v_and_b32 v252, v252, v253
  v_and_b32 v254, v254, v255
  v_and_b32 v252, v252, v254
  v_and_b32 v252, s51, v252
  v_cmp_ne_u32 vcc, s51, v252
  s_add_u32 s59, s59, 1
  s_nop 1
  s_cbranch_vccz RPD_23
  buffer_load_dwordx4 v[252:255], v15, s[4:7], s95 offen sc1
  s_waitcnt vmcnt(0)
  s_cmp_lt_u32 s59, 60000
  s_cbranch_scc1 RP_22
RPD_23:
  ds_read_b128 a[192:195], v1 offset:49152
  buffer_load_dwordx4 a[0:3], v9, s[4:7], s87 offen sc1
  v_mul_f32 v215, v215, v127
  v_cvt_pk_bf16_f32 v244, v208, v209
  v_cvt_pk_bf16_f32 v245, v210, v211
  v_cvt_pk_bf16_f32 v246, v212, v213
  v_mfma_f32_32x32x16_bf16 v[224:239], a[164:167], a[100:103], v[224:239]
  ds_read_b128 a[196:199], v1 offset:50176
  buffer_load_dwordx4 a[4:7], v9, s[4:7], s88 offen sc1
  v_cvt_pk_bf16_f32 v247, v214, v215
  v_mfma_f32_32x32x16_bf16 v[224:239], a[168:171], a[104:107], v[224:239]
  ds_read_b128 a[200:203], v1 offset:51200
  buffer_load_dwordx4 a[8:11], v9, s[4:7], s89 offen sc1
  buffer_store_dwordx4 v[244:247], v1, s[4:7], s50 offen offset:1024 sc1
  v_mfma_f32_32x32x16_bf16 v[224:239], a[172:175], a[108:111], v[224:239]
  ds_read_b128 a[204:207], v1 offset:52224
  s_waitcnt lgkmcnt(4)
  v_mfma_f32_32x32x16_bf16 v[224:239], a[176:179], a[112:115], v[224:239]
  ds_read_b128 a[160:163], v1 offset:53248
  buffer_load_dwordx4 a[12:15], v9, s[4:7], s86 offen sc1
  v_mfma_f32_32x32x16_bf16 v[224:239], a[180:183], a[116:119], v[224:239]
  ds_read_b128 a[164:167], v1 offset:54272
  buffer_load_dwordx4 a[16:19], v9, s[4:7], s87 offen offset:2048 sc1
  v_mfma_f32_32x32x16_bf16 v[224:239], a[184:187], a[120:123], v[224:239]
  ds_read_b128 a[168:171], v1 offset:55296
  v_mfma_f32_32x32x16_bf16 v[224:239], a[188:191], a[124:127], v[224:239]
  ds_read_b128 a[172:175], v1 offset:56320
  s_waitcnt lgkmcnt(4)
  v_mfma_f32_32x32x16_bf16 v[224:239], a[192:195], a[128:131], v[224:239]
  buffer_load_dwordx4 a[20:23], v9, s[4:7], s88 offen offset:2048 sc1
  v_mfma_f32_32x32x16_bf16 v[224:239], a[196:199], a[132:135], v[224:239]
  buffer_load_dwordx4 a[24:27], v9, s[4:7], s89 offen offset:2048 sc1
  v_mfma_f32_32x32x16_bf16 v[224:239], a[200:203], a[136:139], v[224:239]
  buffer_load_dwordx4 a[28:31], v9, s[4:7], s86 offen offset:2048 sc1
  v_mfma_f32_32x32x16_bf16 v[224:239], a[204:207], a[140:143], v[224:239]
  s_waitcnt lgkmcnt(0)
  v_mfma_f32_32x32x16_bf16 v[224:239], a[160:163], a[144:147], v[224:239]
  s_add_u32 s91, s87, 4096
  buffer_load_dwordx4 a[32:35], v9, s[4:7], s91 offen sc1
  v_mfma_f32_32x32x16_bf16 v[224:239], a[164:167], a[148:151], v[224:239]
  s_add_u32 s92, s88, 4096
  buffer_load_dwordx4 a[36:39], v9, s[4:7], s92 offen sc1
  v_mfma_f32_32x32x16_bf16 v[224:239], a[168:171], a[152:155], v[224:239]
  v_mfma_f32_32x32x16_bf16 v[224:239], a[172:175], a[156:159], v[224:239]
  v_mfma_f32_32x32x8_bf16 v[224:239], v[110:111], v[96:97], v[224:239]
  s_nop 11
  v_pk_mul_f32 v[112:113], v[224:225], v[224:225]
  v_pk_mul_f32 v[114:115], v[226:227], v[226:227]
  v_pk_mul_f32 v[116:117], v[228:229], v[228:229]
  v_pk_mul_f32 v[118:119], v[230:231], v[230:231]
  v_pk_fma_f32 v[112:113], v[112:113], v[92:93], v[90:91]
  v_pk_fma_f32 v[114:115], v[114:115], v[92:93], v[90:91]
  v_pk_fma_f32 v[116:117], v[116:117], v[92:93], v[90:91]
  v_pk_fma_f32 v[118:119], v[118:119], v[92:93], v[90:91]
  v_pk_mul_f32 v[112:113], v[112:113], v[224:225]
  v_pk_mul_f32 v[114:115], v[114:115], v[226:227]
  v_pk_mul_f32 v[116:117], v[116:117], v[228:229]
  v_pk_mul_f32 v[118:119], v[118:119], v[230:231]
  v_exp_f32 v112, v112
  v_exp_f32 v113, v113
  v_exp_f32 v114, v114
  v_exp_f32 v115, v115
  v_exp_f32 v116, v116
  v_exp_f32 v117, v117
  v_exp_f32 v118, v118
  v_exp_f32 v119, v119
  v_pk_mul_f32 v[224:225], v[224:225], v[232:233]
  v_pk_mul_f32 v[226:227], v[226:227], v[234:235]
  v_pk_mul_f32 v[228:229], v[228:229], v[236:237]
  v_pk_mul_f32 v[230:231], v[230:231], v[238:239]
  v_pk_fma_f32 v[112:113], v[112:113], v[94:95], v[94:95]
  v_pk_fma_f32 v[114:115], v[114:115], v[94:95], v[94:95]
  v_pk_fma_f32 v[116:117], v[116:117], v[94:95], v[94:95]
  v_pk_fma_f32 v[118:119], v[118:119], v[94:95], v[94:95]
  v_rcp_f32 v112, v112
  v_rcp_f32 v113, v113
  v_rcp_f32 v114, v114
  v_rcp_f32 v115, v115
  v_rcp_f32 v116, v116
  v_rcp_f32 v117, v117
  v_rcp_f32 v118, v118
  v_rcp_f32 v119, v119
  v_pk_mul_f32 v[224:225], v[224:225], v[112:113]
  v_pk_mul_f32 v[226:227], v[226:227], v[114:115]
  v_pk_mul_f32 v[228:229], v[228:229], v[116:117]
  v_pk_mul_f32 v[230:231], v[230:231], v[118:119]
  v_cvt_pk_bf16_f32 v240, v224, v225
  v_cvt_pk_bf16_f32 v241, v226, v227
  v_cvt_pk_bf16_f32 v242, v228, v229
  v_cvt_pk_bf16_f32 v243, v230, v231
  buffer_store_dwordx4 v[240:243], v1, s[4:7], s50 offen offset:2048 sc1
  s_cmp_ge_u32 s18, 2
  s_cselect_b64 vcc, -1, 0
  v_cndmask_b32 v234, v9, v8, vcc
  v_cndmask_b32 v235, v1, v8, vcc
  v_add_u32 v248, s26, v2
  v_add_u32 v249, s26, v3
  v_lshlrev_b32 v192, 16, v80
  v_and_b32 v193, 0xffff0000, v80
  v_lshlrev_b32 v194, 16, v81
  v_and_b32 v195, 0xffff0000, v81
  v_lshlrev_b32 v196, 16, v82
  v_and_b32 v197, 0xffff0000, v82
  v_lshlrev_b32 v198, 16, v83
  v_and_b32 v199, 0xffff0000, v83
  v_lshlrev_b32 v200, 16, v84
  v_and_b32 v201, 0xffff0000, v84
  v_lshlrev_b32 v202, 16, v85
  v_and_b32 v203, 0xffff0000, v85
  v_lshlrev_b32 v204, 16, v86
  v_and_b32 v205, 0xffff0000, v86
  v_lshlrev_b32 v206, 16, v87
  v_and_b32 v207, 0xffff0000, v87
  v_lshlrev_b32 v208, 16, v88
  v_and_b32 v209, 0xffff0000, v88
  v_lshlrev_b32 v210, 16, v89
  v_and_b32 v211, 0xffff0000, v89
  s_waitcnt vmcnt(11)
  v_mfma_f32_16x16x32_bf16 v[80:83], a[208:211], a[0:3], 0
  s_add_u32 s93, s89, 4096
  buffer_load_dwordx4 a[40:43], v9, s[4:7], s93 offen sc1
  s_add_u32 s36, s18, 1
  s_and_b32 s36, s36, 3
  s_mul_i32 s36, s36, 15360
  s_add_u32 s36, s36, 0
  v_add_u32 v237, s36, v1
  v_mfma_f32_16x16x32_bf16 v[84:87], a[212:215], a[0:3], 0
  s_add_u32 s36, s18, 2
  s_and_b32 s36, s36, 3
  s_mul_i32 s36, s36, 15360
  s_add_u32 s36, s36, 5120
  v_add_u32 v238, s36, v1
  s_add_u32 s36, s18, 3
  s_and_b32 s36, s36, 3
  s_mul_i32 s36, s36, 15360
  s_add_u32 s36, s36, 10240
  v_add_u32 v239, s36, v1
  v_mfma_f32_16x16x32_bf16 v[88:91], a[216:219], a[0:3], 0
  s_mul_i32 s36, s18, 15360
  v_add_u32 v236, s36, v1
  s_add_u32 s48, s63, s65
  v_mfma_f32_16x16x32_bf16 v[92:95], a[220:223], a[0:3], 0
  v_mov_b32 v240, v9
  v_add_u32 v241, 2048, v9
  v_mfma_f32_16x16x32_bf16 v[96:99], a[224:227], a[0:3], 0
  v_mov_b32 v242, v10
  v_mul_u32_u24 v244, 1280, v6
  s_waitcnt vmcnt(11)
  v_mfma_f32_16x16x32_bf16 v[100:103], a[208:211], a[4:7], 0
  s_add_u32 s90, s86, 4096
  buffer_load_dwordx4 a[44:47], v9, s[4:7], s90 offen sc1
  v_lshl_add_u32 v245, v7, 3, v244
  v_mfma_f32_16x16x32_bf16 v[104:107], a[212:215], a[4:7], 0
  v_lshl_add_u32 v244, v7, 4, v244
  v_add_u32 v246, 64, v244
  v_mfma_f32_16x16x32_bf16 v[108:111], a[216:219], a[4:7], 0
  v_add_u32 v245, 128, v245
  s_cmp_eq_u32 s20, 1
  s_cselect_b64 s[56:57], -1, 0
  s_cselect_b32 s48, s68, s48
  s_cselect_b32 s8, s14, s12
  s_cselect_b32 s9, s15, s13
  s_cselect_b32 s10, 2621440, s6
  v_mfma_f32_16x16x32_bf16 v[112:115], a[220:223], a[4:7], 0
  v_cndmask_b32 v250, v1, v8, s[56:57]
  v_cndmask_b32 v240, v240, v244, s[56:57]
  v_mfma_f32_16x16x32_bf16 v[116:119], a[224:227], a[4:7], 0
  v_cndmask_b32 v241, v241, v246, s[56:57]
  v_cndmask_b32 v242, v242, v245, s[56:57]
  s_waitcnt vmcnt(11)
  v_mfma_f32_16x16x32_bf16 v[120:123], a[208:211], a[8:11], 0
  buffer_load_dwordx4 a[48:51], v9, s[4:7], s91 offen offset:2048 sc1
  v_lshlrev_b32 v243, 3, v6
  v_mfma_f32_16x16x32_bf16 v[124:127], a[212:215], a[8:11], 0
  v_cmp_gt_u32 s[54:55], 16, v0
  s_nop 0
  v_mfma_f32_16x16x32_bf16 v[212:215], a[216:219], a[8:11], 0
  v_cndmask_b32 v243, v8, v243, s[54:55]
  v_mfma_f32_16x16x32_bf16 v[216:219], a[220:223], a[8:11], 0
  v_mfma_f32_16x16x32_bf16 v[220:223], a[224:227], a[8:11], 0
  s_waitcnt vmcnt(10)
  v_mfma_f32_16x16x32_bf16 v[192:195], a[208:211], a[12:15], v[192:195]
  buffer_load_dwordx4 a[52:55], v9, s[4:7], s92 offen offset:2048 sc1
  v_mfma_f32_16x16x32_bf16 v[196:199], a[212:215], a[12:15], v[196:199]
  v_mfma_f32_16x16x32_bf16 v[200:203], a[216:219], a[12:15], v[200:203]
  v_mfma_f32_16x16x32_bf16 v[204:207], a[220:223], a[12:15], v[204:207]
  v_mfma_f32_16x16x32_bf16 v[208:211], a[224:227], a[12:15], v[208:211]
  s_barrier
  s_waitcnt vmcnt(10)
  v_mfma_f32_16x16x32_bf16 v[80:83], a[228:231], a[16:19], v[80:83]
  ds_read_b128 a[208:211], v248
  v_mfma_f32_16x16x32_bf16 v[84:87], a[232:235], a[16:19], v[84:87]
  ds_read_b128 a[212:215], v248 offset:1024
  v_mfma_f32_16x16x32_bf16 v[88:91], a[236:239], a[16:19], v[88:91]
  ds_read_b128 a[216:219], v248 offset:2048
  v_mfma_f32_16x16x32_bf16 v[92:95], a[240:243], a[16:19], v[92:95]
  buffer_load_dwordx4 a[56:59], v9, s[4:7], s93 offen offset:2048 sc1
  v_mfma_f32_16x16x32_bf16 v[96:99], a[244:247], a[16:19], v[96:99]
  s_waitcnt vmcnt(10)
  v_mfma_f32_16x16x32_bf16 v[100:103], a[228:231], a[20:23], v[100:103]
  ds_read_b128 a[220:223], v248 offset:3072
  v_mfma_f32_16x16x32_bf16 v[104:107], a[232:235], a[20:23], v[104:107]
  ds_read_b128 a[224:227], v248 offset:16384
  v_mfma_f32_16x16x32_bf16 v[108:111], a[236:239], a[20:23], v[108:111]
  buffer_load_dwordx4 a[60:63], v9, s[4:7], s90 offen offset:2048 sc1
  v_mfma_f32_16x16x32_bf16 v[112:115], a[240:243], a[20:23], v[112:115]
  s_add_u32 s91, s87, 8192
  buffer_load_dwordx4 a[64:67], v9, s[4:7], s91 offen sc1
  v_mfma_f32_16x16x32_bf16 v[116:119], a[244:247], a[20:23], v[116:119]
  s_waitcnt vmcnt(11)
  v_mfma_f32_16x16x32_bf16 v[120:123], a[228:231], a[24:27], v[120:123]
  s_add_u32 s92, s88, 8192
  buffer_load_dwordx4 a[68:71], v9, s[4:7], s92 offen sc1
  v_mfma_f32_16x16x32_bf16 v[124:127], a[232:235], a[24:27], v[124:127]
  v_mfma_f32_16x16x32_bf16 v[212:215], a[236:239], a[24:27], v[212:215]
  v_mfma_f32_16x16x32_bf16 v[216:219], a[240:243], a[24:27], v[216:219]
  v_mfma_f32_16x16x32_bf16 v[220:223], a[244:247], a[24:27], v[220:223]
  s_waitcnt vmcnt(11)
  v_mfma_f32_16x16x32_bf16 v[192:195], a[228:231], a[28:31], v[192:195]
  s_add_u32 s93, s89, 8192
  buffer_load_dwordx4 a[72:75], v9, s[4:7], s93 offen sc1
  v_mfma_f32_16x16x32_bf16 v[196:199], a[232:235], a[28:31], v[196:199]
  v_mfma_f32_16x16x32_bf16 v[200:203], a[236:239], a[28:31], v[200:203]
  v_mfma_f32_16x16x32_bf16 v[204:207], a[240:243], a[28:31], v[204:207]
  v_mfma_f32_16x16x32_bf16 v[208:211], a[244:247], a[28:31], v[208:211]
  s_waitcnt vmcnt(11)
  v_mfma_f32_16x16x32_bf16 v[80:83], a[248:251], a[32:35], v[80:83]
  ds_read_b128 a[228:231], v248 offset:17408
  v_mfma_f32_16x16x32_bf16 v[84:87], a[252:255], a[32:35], v[84:87]
  ds_read_b128 a[232:235], v248 offset:18432
  v_mfma_f32_16x16x32_bf16 v[88:91], v[16:19], a[32:35], v[88:91]
  ds_read_b128 a[236:239], v248 offset:19456
  v_mfma_f32_16x16x32_bf16 v[92:95], v[20:23], a[32:35], v[92:95]
  s_add_u32 s90, s86, 8192
  buffer_load_dwordx4 a[76:79], v9, s[4:7], s90 offen sc1
  v_mfma_f32_16x16x32_bf16 v[96:99], v[24:27], a[32:35], v[96:99]
  s_waitcnt vmcnt(11)
  v_mfma_f32_16x16x32_bf16 v[100:103], a[248:251], a[36:39], v[100:103]
  ds_read_b128 a[240:243], v248 offset:32768
  v_mfma_f32_16x16x32_bf16 v[104:107], a[252:255], a[36:39], v[104:107]
  ds_read_b128 a[244:247], v248 offset:33792
  v_mfma_f32_16x16x32_bf16 v[108:111], v[16:19], a[36:39], v[108:111]
  buffer_load_dwordx4 a[80:83], v9, s[4:7], s91 offen offset:2048 sc1
  v_mfma_f32_16x16x32_bf16 v[112:115], v[20:23], a[36:39], v[112:115]
  v_mfma_f32_16x16x32_bf16 v[116:119], v[24:27], a[36:39], v[116:119]
  s_waitcnt vmcnt(10)
  v_mfma_f32_16x16x32_bf16 v[120:123], a[248:251], a[40:43], v[120:123]
  buffer_load_dwordx4 a[84:87], v9, s[4:7], s92 offen offset:2048 sc1
  v_mfma_f32_16x16x32_bf16 v[124:127], a[252:255], a[40:43], v[124:127]
  buffer_load_dwordx4 a[88:91], v9, s[4:7], s93 offen offset:2048 sc1
  v_mfma_f32_16x16x32_bf16 v[212:215], v[16:19], a[40:43], v[212:215]
  v_mfma_f32_16x16x32_bf16 v[216:219], v[20:23], a[40:43], v[216:219]
  v_mfma_f32_16x16x32_bf16 v[220:223], v[24:27], a[40:43], v[220:223]
  s_waitcnt vmcnt(11)
  v_mfma_f32_16x16x32_bf16 v[192:195], a[248:251], a[44:47], v[192:195]
  buffer_load_dwordx4 a[92:95], v9, s[4:7], s90 offen offset:2048 sc1
  v_mfma_f32_16x16x32_bf16 v[196:199], a[252:255], a[44:47], v[196:199]
  v_mfma_f32_16x16x32_bf16 v[200:203], v[16:19], a[44:47], v[200:203]
  v_mfma_f32_16x16x32_bf16 v[204:207], v[20:23], a[44:47], v[204:207]
  v_mfma_f32_16x16x32_bf16 v[208:211], v[24:27], a[44:47], v[208:211]
  s_mov_b64 exec, 1
  buffer_store_byte v14, v15, s[4:7], s58 offen
  s_mov_b64 exec, -1
  s_waitcnt vmcnt(12)
  v_mfma_f32_16x16x32_bf16 v[80:83], v[28:31], a[48:51], v[80:83]
  ds_read_b128 a[248:251], v248 offset:34816
  v_mfma_f32_16x16x32_bf16 v[84:87], v[32:35], a[48:51], v[84:87]
  ds_read_b128 a[252:255], v248 offset:35840
  v_mfma_f32_16x16x32_bf16 v[88:91], v[36:39], a[48:51], v[88:91]
  ds_read_b128 v[16:19], v248 offset:49152
  v_mfma_f32_16x16x32_bf16 v[92:95], v[40:43], a[48:51], v[92:95]
  s_add_u32 s91, s87, 12288
  buffer_load_dwordx4 a[96:99], v9, s[4:7], s91 offen sc1
  v_mfma_f32_16x16x32_bf16 v[96:99], v[44:47], a[48:51], v[96:99]
  s_waitcnt vmcnt(12)
  v_mfma_f32_16x16x32_bf16 v[100:103], v[28:31], a[52:55], v[100:103]
  ds_read_b128 v[20:23], v248 offset:50176
  v_mfma_f32_16x16x32_bf16 v[104:107], v[32:35], a[52:55], v[104:107]
  ds_read_b128 v[24:27], v248 offset:51200
  v_mfma_f32_16x16x32_bf16 v[108:111], v[36:39], a[52:55], v[108:111]
  s_add_u32 s92, s88, 12288
  buffer_load_dwordx4 a[100:103], v9, s[4:7], s92 offen sc1
  v_mfma_f32_16x16x32_bf16 v[112:115], v[40:43], a[52:55], v[112:115]
  v_mfma_f32_16x16x32_bf16 v[116:119], v[44:47], a[52:55], v[116:119]
  s_waitcnt vmcnt(12)
  v_mfma_f32_16x16x32_bf16 v[120:123], v[28:31], a[56:59], v[120:123]
  s_add_u32 s93, s89, 12288
  buffer_load_dwordx4 a[104:107], v9, s[4:7], s93 offen sc1
  v_mfma_f32_16x16x32_bf16 v[124:127], v[32:35], a[56:59], v[124:127]
  v_mfma_f32_16x16x32_bf16 v[212:215], v[36:39], a[56:59], v[212:215]
  v_mfma_f32_16x16x32_bf16 v[216:219], v[40:43], a[56:59], v[216:219]
  v_mfma_f32_16x16x32_bf16 v[220:223], v[44:47], a[56:59], v[220:223]
  s_waitcnt vmcnt(12)
  v_mfma_f32_16x16x32_bf16 v[192:195], v[28:31], a[60:63], v[192:195]
  s_add_u32 s90, s86, 12288
  buffer_load_dwordx4 a[108:111], v9, s[4:7], s90 offen sc1
  v_mfma_f32_16x16x32_bf16 v[196:199], v[32:35], a[60:63], v[196:199]
  buffer_load_dwordx4 a[112:115], v9, s[4:7], s91 offen offset:2048 sc1
  v_mfma_f32_16x16x32_bf16 v[200:203], v[36:39], a[60:63], v[200:203]
  v_mfma_f32_16x16x32_bf16 v[204:207], v[40:43], a[60:63], v[204:207]
  v_mfma_f32_16x16x32_bf16 v[208:211], v[44:47], a[60:63], v[208:211]
  s_waitcnt vmcnt(13)
  v_mfma_f32_16x16x32_bf16 v[80:83], v[48:51], a[64:67], v[80:83]
  ds_read_b128 v[28:31], v248 offset:52224
  v_mfma_f32_16x16x32_bf16 v[84:87], v[52:55], a[64:67], v[84:87]
  ds_read_b128 v[32:35], v249
  v_mfma_f32_16x16x32_bf16 v[88:91], v[56:59], a[64:67], v[88:91]
  ds_read_b128 v[36:39], v249 offset:1024
  v_mfma_f32_16x16x32_bf16 v[92:95], v[60:63], a[64:67], v[92:95]
  buffer_load_dwordx4 a[116:119], v9, s[4:7], s92 offen offset:2048 sc1
  v_mfma_f32_16x16x32_bf16 v[96:99], v[64:67], a[64:67], v[96:99]
  buffer_load_dwordx4 v[252:255], v15, s[4:7], s94 offen sc1
  s_waitcnt vmcnt(14)
  v_mfma_f32_16x16x32_bf16 v[100:103], v[48:51], a[68:71], v[100:103]
  ds_read_b128 v[40:43], v249 offset:2048
  v_mfma_f32_16x16x32_bf16 v[104:107], v[52:55], a[68:71], v[104:107]
  ds_read_b128 v[44:47], v249 offset:3072
  v_mfma_f32_16x16x32_bf16 v[108:111], v[56:59], a[68:71], v[108:111]
  buffer_load_dwordx4 a[120:123], v9, s[4:7], s93 offen offset:2048 sc1
  v_mfma_f32_16x16x32_bf16 v[112:115], v[60:63], a[68:71], v[112:115]
  v_mfma_f32_16x16x32_bf16 v[116:119], v[64:67], a[68:71], v[116:119]
  s_waitcnt vmcnt(14)
  v_mfma_f32_16x16x32_bf16 v[120:123], v[48:51], a[72:75], v[120:123]
  buffer_load_dwordx4 a[124:127], v9, s[4:7], s90 offen offset:2048 sc1
  v_mfma_f32_16x16x32_bf16 v[124:127], v[52:55], a[72:75], v[124:127]
  v_mfma_f32_16x16x32_bf16 v[212:215], v[56:59], a[72:75], v[212:215]
  v_mfma_f32_16x16x32_bf16 v[216:219], v[60:63], a[72:75], v[216:219]
  v_mfma_f32_16x16x32_bf16 v[220:223], v[64:67], a[72:75], v[220:223]
  s_waitcnt vmcnt(14)
  v_mfma_f32_16x16x32_bf16 v[192:195], v[48:51], a[76:79], v[192:195]
  v_mfma_f32_16x16x32_bf16 v[196:199], v[52:55], a[76:79], v[196:199]
  v_mfma_f32_16x16x32_bf16 v[200:203], v[56:59], a[76:79], v[200:203]
  v_mfma_f32_16x16x32_bf16 v[204:207], v[60:63], a[76:79], v[204:207]
  v_mfma_f32_16x16x32_bf16 v[208:211], v[64:67], a[76:79], v[208:211]
  s_waitcnt vmcnt(13)
  v_mfma_f32_16x16x32_bf16 v[80:83], v[68:71], a[80:83], v[80:83]
  s_add_u32 s33, s25, 65536
  buffer_load_dwordx4 v[48:51], v1, s[4:7], s33 offen
  v_mfma_f32_16x16x32_bf16 v[84:87], v[72:75], a[80:83], v[84:87]
  buffer_load_dwordx4 v[52:55], v235, s[4:7], s33 offen offset:1024
  v_mfma_f32_16x16x32_bf16 v[88:91], v[76:79], a[80:83], v[88:91]
  buffer_load_dwordx4 v[56:59], v235, s[4:7], s33 offen offset:2048
  v_mfma_f32_16x16x32_bf16 v[92:95], v[128:131], a[80:83], v[92:95]
  v_mfma_f32_16x16x32_bf16 v[96:99], v[132:135], a[80:83], v[96:99]
  s_waitcnt vmcnt(15)
  v_mfma_f32_16x16x32_bf16 v[100:103], v[68:71], a[84:87], v[100:103]
  buffer_load_dwordx4 v[60:63], v235, s[4:7], s33 offen offset:3072
  v_mfma_f32_16x16x32_bf16 v[104:107], v[72:75], a[84:87], v[104:107]
  v_mfma_f32_16x16x32_bf16 v[108:111], v[76:79], a[84:87], v[108:111]
  v_mfma_f32_16x16x32_bf16 v[112:115], v[128:131], a[84:87], v[112:115]
  v_mfma_f32_16x16x32_bf16 v[116:119], v[132:135], a[84:87], v[116:119]
  s_waitcnt vmcnt(15)
  v_mfma_f32_16x16x32_bf16 v[120:123], v[68:71], a[88:91], v[120:123]
  s_add_u32 s33, s25, 69632
  buffer_load_dwordx4 v[64:67], v235, s[4:7], s33 offen
  v_mfma_f32_16x16x32_bf16 v[124:127], v[72:75], a[88:91], v[124:127]
  v_mfma_f32_16x16x32_bf16 v[212:215], v[76:79], a[88:91], v[212:215]
  v_mfma_f32_16x16x32_bf16 v[216:219], v[128:131], a[88:91], v[216:219]
  v_mfma_f32_16x16x32_bf16 v[220:223], v[132:135], a[88:91], v[220:223]
  s_waitcnt vmcnt(15)
  v_mfma_f32_16x16x32_bf16 v[192:195], v[68:71], a[92:95], v[192:195]
  v_mfma_f32_16x16x32_bf16 v[196:199], v[72:75], a[92:95], v[196:199]
  v_mfma_f32_16x16x32_bf16 v[200:203], v[76:79], a[92:95], v[200:203]
  v_mfma_f32_16x16x32_bf16 v[204:207], v[128:131], a[92:95], v[204:207]
  v_mfma_f32_16x16x32_bf16 v[208:211], v[132:135], a[92:95], v[208:211]
  s_mov_b32 s59, 0
  s_waitcnt vmcnt(7)
RP_24:
  v_and_b32 v252, v252, v253
  v_and_b32 v254, v254, v255
  v_and_b32 v252, v252, v254
  v_and_b32 v252, s51, v252
  v_cmp_ne_u32 vcc, s51, v252
  s_add_u32 s59, s59, 1
  s_nop 1
  s_cbranch_vccz RPD_25
  buffer_load_dwordx4 v[252:255], v15, s[4:7], s94 offen sc1
  s_waitcnt vmcnt(0)
  s_cmp_lt_u32 s59, 60000
  s_cbranch_scc1 RP_24
RPD_25:
  v_mfma_f32_16x16x32_bf16 v[80:83], v[136:139], a[96:99], v[80:83]
  buffer_load_dwordx4 v[68:71], v235, s[4:7], s33 offen offset:1024
  v_mfma_f32_16x16x32_bf16 v[84:87], v[140:143], a[96:99], v[84:87]
  v_mfma_f32_16x16x32_bf16 v[88:91], v[144:147], a[96:99], v[88:91]
  v_mfma_f32_16x16x32_bf16 v[92:95], v[148:151], a[96:99], v[92:95]
  v_mfma_f32_16x16x32_bf16 v[96:99], v[152:155], a[96:99], v[96:99]
  v_mfma_f32_16x16x32_bf16 v[100:103], v[136:139], a[100:103], v[100:103]
  s_add_u32 s91, s87, 16384
  buffer_load_dwordx4 a[128:131], v9, s[4:7], s91 offen sc1
  v_mfma_f32_16x16x32_bf16 v[104:107], v[140:143], a[100:103], v[104:107]
  buffer_load_dwordx4 a[132:135], v9, s[4:7], s91 offen offset:2048 sc1
  v_mfma_f32_16x16x32_bf16 v[108:111], v[144:147], a[100:103], v[108:111]
  s_add_u32 s91, s87, 20480
  buffer_load_dwordx4 a[136:139], v9, s[4:7], s91 offen sc1
  v_mfma_f32_16x16x32_bf16 v[112:115], v[148:151], a[100:103], v[112:115]
  v_mfma_f32_16x16x32_bf16 v[116:119], v[152:155], a[100:103], v[116:119]
  v_mfma_f32_16x16x32_bf16 v[120:123], v[136:139], a[104:107], v[120:123]
  buffer_load_dwordx4 a[140:143], v9, s[4:7], s91 offen offset:2048 sc1
  v_mfma_f32_16x16x32_bf16 v[124:127], v[140:143], a[104:107], v[124:127]
  v_mfma_f32_16x16x32_bf16 v[212:215], v[144:147], a[104:107], v[212:215]
  v_mfma_f32_16x16x32_bf16 v[216:219], v[148:151], a[104:107], v[216:219]
  v_mfma_f32_16x16x32_bf16 v[220:223], v[152:155], a[104:107], v[220:223]
  v_mfma_f32_16x16x32_bf16 v[192:195], v[136:139], a[108:111], v[192:195]
  s_add_u32 s91, s87, 24576
  buffer_load_dwordx4 a[144:147], v9, s[4:7], s91 offen sc1
  v_mfma_f32_16x16x32_bf16 v[196:199], v[140:143], a[108:111], v[196:199]
  v_mfma_f32_16x16x32_bf16 v[200:203], v[144:147], a[108:111], v[200:203]
  v_mfma_f32_16x16x32_bf16 v[204:207], v[148:151], a[108:111], v[204:207]
  v_mfma_f32_16x16x32_bf16 v[208:211], v[152:155], a[108:111], v[208:211]
  v_mfma_f32_16x16x32_bf16 v[80:83], v[156:159], a[112:115], v[80:83]
  buffer_load_dwordx4 a[148:151], v234, s[4:7], s91 offen offset:2048 sc1
  v_mfma_f32_16x16x32_bf16 v[84:87], v[160:163], a[112:115], v[84:87]
  v_mfma_f32_16x16x32_bf16 v[88:91], v[164:167], a[112:115], v[88:91]
  v_mfma_f32_16x16x32_bf16 v[92:95], v[168:171], a[112:115], v[92:95]
  v_mfma_f32_16x16x32_bf16 v[96:99], v[172:175], a[112:115], v[96:99]
  v_mfma_f32_16x16x32_bf16 v[100:103], v[156:159], a[116:119], v[100:103]
  s_add_u32 s92, s88, 16384
  buffer_load_dwordx4 a[152:155], v9, s[4:7], s92 offen sc1
  v_mfma_f32_16x16x32_bf16 v[104:107], v[160:163], a[116:119], v[104:107]
  v_mfma_f32_16x16x32_bf16 v[108:111], v[164:167], a[116:119], v[108:111]
  v_mfma_f32_16x16x32_bf16 v[112:115], v[168:171], a[116:119], v[112:115]
  v_mfma_f32_16x16x32_bf16 v[116:119], v[172:175], a[116:119], v[116:119]
  s_waitcnt vmcnt(14)
  v_mfma_f32_16x16x32_bf16 v[120:123], v[156:159], a[120:123], v[120:123]
  buffer_load_dwordx4 a[156:159], v9, s[4:7], s92 offen offset:2048 sc1
  v_mfma_f32_16x16x32_bf16 v[124:127], v[160:163], a[120:123], v[124:127]
  s_add_u32 s92, s88, 20480
  buffer_load_dwordx4 a[160:163], v9, s[4:7], s92 offen sc1
  v_mfma_f32_16x16x32_bf16 v[212:215], v[164:167], a[120:123], v[212:215]
  v_mfma_f32_16x16x32_bf16 v[216:219], v[168:171], a[120:123], v[216:219]
  v_mfma_f32_16x16x32_bf16 v[220:223], v[172:175], a[120:123], v[220:223]
  s_waitcnt vmcnt(15)
  v_mfma_f32_16x16x32_bf16 v[192:195], v[156:159], a[124:127], v[192:195]
  buffer_load_dwordx4 a[164:167], v9, s[4:7], s92 offen offset:2048 sc1
  v_mfma_f32_16x16x32_bf16 v[196:199], v[160:163], a[124:127], v[196:199]
  v_mfma_f32_16x16x32_bf16 v[200:203], v[164:167], a[124:127], v[200:203]
  v_mfma_f32_16x16x32_bf16 v[204:207], v[168:171], a[124:127], v[204:207]
  v_mfma_f32_16x16x32_bf16 v[208:211], v[172:175], a[124:127], v[208:211]
  s_waitcnt vmcnt(9)
  v_mfma_f32_16x16x32_bf16 v[80:83], v[176:179], a[128:131], v[80:83]
  s_add_u32 s92, s88, 24576
  buffer_load_dwordx4 a[168:171], v9, s[4:7], s92 offen sc1
  v_mfma_f32_16x16x32_bf16 v[84:87], v[180:183], a[128:131], v[84:87]
  v_mfma_f32_16x16x32_bf16 v[88:91], v[184:187], a[128:131], v[88:91]
  v_mfma_f32_16x16x32_bf16 v[92:95], v[188:191], a[128:131], v[92:95]
  v_mfma_f32_16x16x32_bf16 v[96:99], a[208:211], a[128:131], v[96:99]
  s_waitcnt vmcnt(9)
  v_mfma_f32_16x16x32_bf16 v[80:83], a[212:215], a[132:135], v[80:83]
  buffer_load_dwordx4 a[172:175], v234, s[4:7], s92 offen offset:2048 sc1
  v_mfma_f32_16x16x32_bf16 v[84:87], a[216:219], a[132:135], v[84:87]
  v_mfma_f32_16x16x32_bf16 v[88:91], a[220:223], a[132:135], v[88:91]
  s_waitcnt lgkmcnt(15)
  v_mfma_f32_16x16x32_bf16 v[92:95], a[224:227], a[132:135], v[92:95]
  s_waitcnt lgkmcnt(14)
  v_mfma_f32_16x16x32_bf16 v[96:99], a[228:231], a[132:135], v[96:99]
  s_waitcnt vmcnt(9)
  s_waitcnt lgkmcnt(13)
  v_mfma_f32_16x16x32_bf16 v[80:83], a[232:235], a[136:139], v[80:83]
  s_add_u32 s93, s89, 16384
  buffer_load_dwordx4 a[176:179], v9, s[4:7], s93 offen sc1
  s_add_u32 s58, s21, 5120
  s_waitcnt lgkmcnt(12)
  v_mfma_f32_16x16x32_bf16 v[84:87], a[236:239], a[136:139], v[84:87]
  s_lshl_b32 s59, s17, 2
  s_add_u32 s58, s58, s59
  s_waitcnt lgkmcnt(11)
  v_mfma_f32_16x16x32_bf16 v[88:91], a[240:243], a[136:139], v[88:91]
  s_add_u32 s58, s58, s18
  v_mov_b32 v14, 1
  s_waitcnt lgkmcnt(10)
  v_mfma_f32_16x16x32_bf16 v[92:95], a[244:247], a[136:139], v[92:95]
  v_mov_b32 v15, 0
  s_mov_b32 s37, 0x3f803f80
  s_waitcnt lgkmcnt(9)
  v_mfma_f32_16x16x32_bf16 v[96:99], a[248:251], a[136:139], v[96:99]
  v_mov_b32 v244, 0
  v_mov_b32 v245, 0
  s_waitcnt vmcnt(9)
  s_waitcnt lgkmcnt(8)
  v_mfma_f32_16x16x32_bf16 v[80:83], a[252:255], a[140:143], v[80:83]
  buffer_load_dwordx4 a[180:183], v9, s[4:7], s93 offen offset:2048 sc1
  v_mov_b32 v246, 0
  s_waitcnt lgkmcnt(7)
  v_mfma_f32_16x16x32_bf16 v[84:87], v[16:19], a[140:143], v[84:87]
  s_add_u32 s93, s89, 20480
  buffer_load_dwordx4 a[184:187], v9, s[4:7], s93 offen sc1
  v_mov_b32 v247, 0
  s_waitcnt lgkmcnt(6)
  v_mfma_f32_16x16x32_bf16 v[88:91], v[20:23], a[140:143], v[88:91]
  s_waitcnt lgkmcnt(5)
  v_mfma_f32_16x16x32_bf16 v[92:95], v[24:27], a[140:143], v[92:95]
  s_waitcnt lgkmcnt(4)
  v_mfma_f32_16x16x32_bf16 v[96:99], v[28:31], a[140:143], v[96:99]
  s_waitcnt vmcnt(10)
  s_waitcnt lgkmcnt(3)
  v_mfma_f32_16x16x32_bf16 v[80:83], v[32:35], a[144:147], v[80:83]
  buffer_load_dwordx4 a[188:191], v9, s[4:7], s93 offen offset:2048 sc1
  s_waitcnt lgkmcnt(2)
  v_mfma_f32_16x16x32_bf16 v[84:87], v[36:39], a[144:147], v[84:87]
  s_waitcnt lgkmcnt(1)
  v_mfma_f32_16x16x32_bf16 v[88:91], v[40:43], a[144:147], v[88:91]
  s_waitcnt lgkmcnt(0)
  v_mfma_f32_16x16x32_bf16 v[92:95], v[44:47], a[144:147], v[92:95]
  v_mfma_f32_16x16x32_bf16 v[96:99], v[48:51], a[144:147], v[96:99]
  s_waitcnt vmcnt(10)
  v_mfma_f32_16x16x32_bf16 v[80:83], v[52:55], a[148:151], v[80:83]
  s_add_u32 s93, s89, 24576
  buffer_load_dwordx4 a[192:195], v9, s[4:7], s93 offen sc1
  v_mfma_f32_16x16x32_bf16 v[84:87], v[56:59], a[148:151], v[84:87]
  v_mfma_f32_16x16x32_bf16 v[88:91], v[60:63], a[148:151], v[88:91]
  v_mfma_f32_16x16x32_bf16 v[92:95], v[64:67], a[148:151], v[92:95]
  v_mfma_f32_16x16x32_bf16 v[96:99], v[68:71], a[148:151], v[96:99]
  s_waitcnt vmcnt(10)
  v_mfma_f32_16x16x32_bf16 v[100:103], v[176:179], a[152:155], v[100:103]
  buffer_load_dwordx4 a[196:199], v234, s[4:7], s93 offen offset:2048 sc1
  ds_write_b128 v237, v[80:83]
  v_mfma_f32_16x16x32_bf16 v[104:107], v[180:183], a[152:155], v[104:107]
  v_mfma_f32_16x16x32_bf16 v[108:111], v[184:187], a[152:155], v[108:111]
  v_mfma_f32_16x16x32_bf16 v[112:115], v[188:191], a[152:155], v[112:115]
  ds_write_b128 v237, v[84:87] offset:1024
  v_mfma_f32_16x16x32_bf16 v[116:119], a[208:211], a[152:155], v[116:119]
  s_waitcnt vmcnt(10)
  v_mfma_f32_16x16x32_bf16 v[100:103], a[212:215], a[156:159], v[100:103]
  s_add_u32 s90, s86, 16384
  buffer_load_dwordx4 a[200:203], v9, s[4:7], s90 offen sc1
  v_mfma_f32_16x16x32_bf16 v[104:107], a[216:219], a[156:159], v[104:107]
  ds_write_b128 v237, v[88:91] offset:2048
  v_mfma_f32_16x16x32_bf16 v[108:111], a[220:223], a[156:159], v[108:111]
  v_mfma_f32_16x16x32_bf16 v[112:115], a[224:227], a[156:159], v[112:115]
  v_mfma_f32_16x16x32_bf16 v[116:119], a[228:231], a[156:159], v[116:119]
  ds_write_b128 v237, v[92:95] offset:3072
  s_waitcnt vmcnt(10)
  v_mfma_f32_16x16x32_bf16 v[100:103], a[232:235], a[160:163], v[100:103]
  buffer_load_dwordx4 a[204:207], v9, s[4:7], s90 offen offset:2048 sc1
  v_mfma_f32_16x16x32_bf16 v[104:107], a[236:239], a[160:163], v[104:107]
  s_add_u32 s90, s86, 20480
  buffer_load_dwordx4 a[0:3], v9, s[4:7], s90 offen sc1
  v_mfma_f32_16x16x32_bf16 v[108:111], a[240:243], a[160:163], v[108:111]
  ds_write_b128 v237, v[96:99] offset:4096
  v_mfma_f32_16x16x32_bf16 v[112:115], a[244:247], a[160:163], v[112:115]
  v_mfma_f32_16x16x32_bf16 v[116:119], a[248:251], a[160:163], v[116:119]
  s_waitcnt vmcnt(11)
  v_mfma_f32_16x16x32_bf16 v[100:103], a[252:255], a[164:167], v[100:103]
  buffer_load_dwordx4 a[4:7], v9, s[4:7], s90 offen offset:2048 sc1
  v_mfma_f32_16x16x32_bf16 v[104:107], v[16:19], a[164:167], v[104:107]
  v_mfma_f32_16x16x32_bf16 v[108:111], v[20:23], a[164:167], v[108:111]
  v_mfma_f32_16x16x32_bf16 v[112:115], v[24:27], a[164:167], v[112:115]
  v_mfma_f32_16x16x32_bf16 v[116:119], v[28:31], a[164:167], v[116:119]
  s_waitcnt vmcnt(11)
  v_mfma_f32_16x16x32_bf16 v[100:103], v[32:35], a[168:171], v[100:103]
  s_add_u32 s90, s86, 24576
  buffer_load_dwordx4 a[8:11], v9, s[4:7], s90 offen sc1
  v_mfma_f32_16x16x32_bf16 v[104:107], v[36:39], a[168:171], v[104:107]
  v_mfma_f32_16x16x32_bf16 v[108:111], v[40:43], a[168:171], v[108:111]
  v_mfma_f32_16x16x32_bf16 v[112:115], v[44:47], a[168:171], v[112:115]
  v_mfma_f32_16x16x32_bf16 v[116:119], v[48:51], a[168:171], v[116:119]
  s_waitcnt vmcnt(11)
  v_mfma_f32_16x16x32_bf16 v[100:103], v[52:55], a[172:175], v[100:103]
  buffer_load_dwordx4 a[12:15], v234, s[4:7], s90 offen offset:2048 sc1
  v_mfma_f32_16x16x32_bf16 v[104:107], v[56:59], a[172:175], v[104:107]
  v_mfma_f32_16x16x32_bf16 v[108:111], v[60:63], a[172:175], v[108:111]
  v_mfma_f32_16x16x32_bf16 v[112:115], v[64:67], a[172:175], v[112:115]
  v_mfma_f32_16x16x32_bf16 v[116:119], v[68:71], a[172:175], v[116:119]
  s_waitcnt vmcnt(11)
  v_mfma_f32_16x16x32_bf16 v[120:123], v[176:179], a[176:179], v[120:123]
  s_nop 0
  ds_write_b128 v238, v[100:103]
  v_mfma_f32_16x16x32_bf16 v[124:127], v[180:183], a[176:179], v[124:127]
  v_mfma_f32_16x16x32_bf16 v[212:215], v[184:187], a[176:179], v[212:215]
  v_mfma_f32_16x16x32_bf16 v[216:219], v[188:191], a[176:179], v[216:219]
  ds_write_b128 v238, v[104:107] offset:1024
  v_mfma_f32_16x16x32_bf16 v[220:223], a[208:211], a[176:179], v[220:223]
  s_waitcnt vmcnt(10)
  v_mfma_f32_16x16x32_bf16 v[120:123], a[212:215], a[180:183], v[120:123]
  v_mfma_f32_16x16x32_bf16 v[124:127], a[216:219], a[180:183], v[124:127]
  ds_write_b128 v238, v[108:111] offset:2048
  v_mfma_f32_16x16x32_bf16 v[212:215], a[220:223], a[180:183], v[212:215]
  v_mfma_f32_16x16x32_bf16 v[216:219], a[224:227], a[180:183], v[216:219]
  v_mfma_f32_16x16x32_bf16 v[220:223], a[228:231], a[180:183], v[220:223]
  ds_write_b128 v238, v[112:115] offset:3072
  s_waitcnt vmcnt(9)
  v_mfma_f32_16x16x32_bf16 v[120:123], a[232:235], a[184:187], v[120:123]
  v_mfma_f32_16x16x32_bf16 v[124:127], a[236:239], a[184:187], v[124:127]
  v_mfma_f32_16x16x32_bf16 v[212:215], a[240:243], a[184:187], v[212:215]
  ds_write_b128 v238, v[116:119] offset:4096
  s_waitcnt lgkmcnt(0)
  s_barrier
  v_mfma_f32_16x16x32_bf16 v[216:219], a[244:247], a[184:187], v[216:219]
  ds_read_b128 v[80:83], v236
  ds_read_b128 v[84:87], v236 offset:1024
  v_mfma_f32_16x16x32_bf16 v[220:223], a[248:251], a[184:187], v[220:223]
  ds_read_b128 v[88:91], v236 offset:2048
  ds_read_b128 v[92:95], v236 offset:3072
  s_waitcnt vmcnt(8)
  v_mfma_f32_16x16x32_bf16 v[120:123], a[252:255], a[188:191], v[120:123]
  s_add_u32 m0, s26, 65536
  s_add_u32 s32, s22, 0
  buffer_load_dwordx4 v250, s[4:7], s32 offen offset:0 lds
  ds_read_b128 v[96:99], v236 offset:4096
  v_mfma_f32_16x16x32_bf16 v[124:127], v[16:19], a[188:191], v[124:127]
  ds_read_b128 v[100:103], v236 offset:5120
  ds_read_b128 v[104:107], v236 offset:6144
  v_mfma_f32_16x16x32_bf16 v[212:215], v[20:23], a[188:191], v[212:215]
  ds_read_b128 v[108:111], v236 offset:7168
  ds_read_b128 v[112:115], v236 offset:8192
  v_mfma_f32_16x16x32_bf16 v[216:219], v[24:27], a[188:191], v[216:219]
  ds_read_b128 v[116:119], v236 offset:9216
  v_mfma_f32_16x16x32_bf16 v[220:223], v[28:31], a[188:191], v[220:223]
  s_waitcnt vmcnt(8)
  v_mfma_f32_16x16x32_bf16 v[120:123], v[32:35], a[192:195], v[120:123]
  buffer_load_dwordx4 v250, s[4:7], s32 offen offset:1024 lds
  v_mfma_f32_16x16x32_bf16 v[124:127], v[36:39], a[192:195], v[124:127]
  v_mfma_f32_16x16x32_bf16 v[212:215], v[40:43], a[192:195], v[212:215]
  v_mfma_f32_16x16x32_bf16 v[216:219], v[44:47], a[192:195], v[216:219]
  v_mfma_f32_16x16x32_bf16 v[220:223], v[48:51], a[192:195], v[220:223]
  s_waitcnt vmcnt(8)
  v_mfma_f32_16x16x32_bf16 v[120:123], v[52:55], a[196:199], v[120:123]
  buffer_load_dwordx4 v250, s[4:7], s32 offen offset:2048 lds
  v_mfma_f32_16x16x32_bf16 v[124:127], v[56:59], a[196:199], v[124:127]
  v_mfma_f32_16x16x32_bf16 v[212:215], v[60:63], a[196:199], v[212:215]
  v_mfma_f32_16x16x32_bf16 v[216:219], v[64:67], a[196:199], v[216:219]
  v_mfma_f32_16x16x32_bf16 v[220:223], v[68:71], a[196:199], v[220:223]
  s_waitcnt vmcnt(8)
  v_mfma_f32_16x16x32_bf16 v[192:195], v[176:179], a[200:203], v[192:195]
  buffer_load_dwordx4 v250, s[4:7], s32 offen offset:3072 lds
  ds_write_b128 v239, v[120:123]
  v_mfma_f32_16x16x32_bf16 v[196:199], v[180:183], a[200:203], v[196:199]
  s_add_u32 m0, s26, 81920
  s_add_u32 s32, s22, 4096
  buffer_load_dwordx4 v250, s[4:7], s32 offen offset:0 lds
  v_mfma_f32_16x16x32_bf16 v[200:203], v[184:187], a[200:203], v[200:203]
  v_mfma_f32_16x16x32_bf16 v[204:207], v[188:191], a[200:203], v[204:207]
  ds_write_b128 v239, v[124:127] offset:1024
  v_mfma_f32_16x16x32_bf16 v[208:211], a[208:211], a[200:203], v[208:211]
  s_waitcnt vmcnt(9)
  v_mfma_f32_16x16x32_bf16 v[192:195], a[212:215], a[204:207], v[192:195]
  buffer_load_dwordx4 v250, s[4:7], s32 offen offset:1024 lds
  v_mfma_f32_16x16x32_bf16 v[196:199], a[216:219], a[204:207], v[196:199]
  ds_write_b128 v239, v[212:215] offset:2048
  v_mfma_f32_16x16x32_bf16 v[200:203], a[220:223], a[204:207], v[200:203]
  v_mfma_f32_16x16x32_bf16 v[204:207], a[224:227], a[204:207], v[204:207]
  v_mfma_f32_16x16x32_bf16 v[208:211], a[228:231], a[204:207], v[208:211]
  ds_write_b128 v239, v[216:219] offset:3072
  s_waitcnt vmcnt(9)
  v_mfma_f32_16x16x32_bf16 v[192:195], a[232:235], a[0:3], v[192:195]
  buffer_load_dwordx4 v250, s[4:7], s32 offen offset:2048 lds
  v_mfma_f32_16x16x32_bf16 v[196:199], a[236:239], a[0:3], v[196:199]
  v_mfma_f32_16x16x32_bf16 v[200:203], a[240:243], a[0:3], v[200:203]
  ds_write_b128 v239, v[220:223] offset:4096
  s_waitcnt lgkmcnt(9)
  v_add_f32 v80, v80, v100
  v_mfma_f32_16x16x32_bf16 v[204:207], a[244:247], a[0:3], v[204:207]
  v_add_f32 v81, v81, v101
  v_add_f32 v82, v82, v102
  v_mfma_f32_16x16x32_bf16 v[208:211], a[248:251], a[0:3], v[208:211]
  v_add_f32 v83, v83, v103
  s_waitcnt lgkmcnt(8)
  v_add_f32 v84, v84, v104
  s_waitcnt vmcnt(9)
  v_mfma_f32_16x16x32_bf16 v[192:195], a[252:255], a[4:7], v[192:195]
  buffer_load_dwordx4 v250, s[4:7], s32 offen offset:3072 lds
  v_add_f32 v85, v85, v105
  v_mfma_f32_16x16x32_bf16 v[196:199], v[16:19], a[4:7], v[196:199]
  v_add_f32 v86, v86, v106
  v_add_f32 v87, v87, v107
  v_mfma_f32_16x16x32_bf16 v[200:203], v[20:23], a[4:7], v[200:203]
  s_waitcnt lgkmcnt(7)
  v_add_f32 v88, v88, v108
  v_add_f32 v89, v89, v109
  v_mfma_f32_16x16x32_bf16 v[204:207], v[24:27], a[4:7], v[204:207]
  s_waitcnt lgkmcnt(0)
  s_barrier
  ds_read_b128 v[120:123], v236 offset:10240
  v_mfma_f32_16x16x32_bf16 v[208:211], v[28:31], a[4:7], v[208:211]
  ds_read_b128 v[124:127], v236 offset:11264
  ds_read_b128 v[212:215], v236 offset:12288
  s_waitcnt vmcnt(9)
  v_mfma_f32_16x16x32_bf16 v[192:195], v[32:35], a[8:11], v[192:195]
  s_add_u32 m0, s26, 98304
  s_add_u32 s32, s22, 8192
  buffer_load_dwordx4 v250, s[4:7], s32 offen offset:0 lds
  ds_read_b128 v[216:219], v236 offset:13312
  v_mfma_f32_16x16x32_bf16 v[196:199], v[36:39], a[8:11], v[196:199]
  ds_read_b128 v[220:223], v236 offset:14336
  v_add_f32 v90, v90, v110
  v_mfma_f32_16x16x32_bf16 v[200:203], v[40:43], a[8:11], v[200:203]
  v_add_f32 v91, v91, v111
  v_add_f32 v92, v92, v112
  v_mfma_f32_16x16x32_bf16 v[204:207], v[44:47], a[8:11], v[204:207]
  v_add_f32 v93, v93, v113
  v_add_f32 v94, v94, v114
  v_mfma_f32_16x16x32_bf16 v[208:211], v[48:51], a[8:11], v[208:211]
  v_add_f32 v95, v95, v115
  v_add_f32 v96, v96, v116
  s_waitcnt vmcnt(9)
  v_mfma_f32_16x16x32_bf16 v[192:195], v[52:55], a[12:15], v[192:195]
  buffer_load_dwordx4 v250, s[4:7], s32 offen offset:1024 lds
  v_add_f32 v97, v97, v117
  v_mfma_f32_16x16x32_bf16 v[196:199], v[56:59], a[12:15], v[196:199]
  buffer_load_dwordx4 v250, s[4:7], s32 offen offset:2048 lds
  v_add_f32 v98, v98, v118
  v_mfma_f32_16x16x32_bf16 v[200:203], v[60:63], a[12:15], v[200:203]
  v_add_f32 v99, v99, v119
  v_mfma_f32_16x16x32_bf16 v[204:207], v[64:67], a[12:15], v[204:207]
  v_mfma_f32_16x16x32_bf16 v[208:211], v[68:71], a[12:15], v[208:211]
  s_waitcnt lgkmcnt(4)
  v_pk_add_f32 v[80:81], v[80:81], v[120:121]
  v_pk_add_f32 v[82:83], v[82:83], v[122:123]
  s_waitcnt lgkmcnt(3)
  v_pk_add_f32 v[84:85], v[84:85], v[124:125]
  v_pk_add_f32 v[86:87], v[86:87], v[126:127]
  s_waitcnt lgkmcnt(2)
  v_pk_add_f32 v[88:89], v[88:89], v[212:213]
  v_pk_add_f32 v[90:91], v[90:91], v[214:215]
  s_waitcnt lgkmcnt(1)
  v_pk_add_f32 v[92:93], v[92:93], v[216:217]
  v_pk_add_f32 v[94:95], v[94:95], v[218:219]
  s_waitcnt lgkmcnt(0)
  v_pk_add_f32 v[96:97], v[96:97], v[220:221]
  v_pk_add_f32 v[98:99], v[98:99], v[222:223]
  v_pk_add_f32 v[192:193], v[192:193], v[80:81]
  v_pk_add_f32 v[194:195], v[194:195], v[82:83]
  v_pk_add_f32 v[196:197], v[196:197], v[84:85]
  v_pk_add_f32 v[198:199], v[198:199], v[86:87]
  v_pk_add_f32 v[200:201], v[200:201], v[88:89]
  v_pk_add_f32 v[202:203], v[202:203], v[90:91]
  v_pk_add_f32 v[204:205], v[204:205], v[92:93]
  v_pk_add_f32 v[206:207], v[206:207], v[94:95]
  v_pk_add_f32 v[208:209], v[208:209], v[96:97]
  v_pk_add_f32 v[210:211], v[210:211], v[98:99]
  v_cvt_pk_bf16_f32 v224, v192, v193
  v_cvt_pk_bf16_f32 v225, v194, v195
  v_cvt_pk_bf16_f32 v226, v196, v197
  v_cvt_pk_bf16_f32 v227, v198, v199
  buffer_store_dwordx4 v[224:227], v240, s[8:11], s48 offen
  v_cvt_pk_bf16_f32 v228, v200, v201
  v_cvt_pk_bf16_f32 v229, v202, v203
  v_cvt_pk_bf16_f32 v230, v204, v205
  v_cvt_pk_bf16_f32 v231, v206, v207
  buffer_store_dwordx4 v[228:231], v241, s[8:11], s48 offen
  v_cvt_pk_bf16_f32 v232, v208, v209
  v_cvt_pk_bf16_f32 v233, v210, v211
  buffer_store_dwordx2 v[232:233], v242, s[8:11], s48 offen
  s_cmp_eq_u32 s20, 1
  s_cbranch_scc1 MAIN_END
  v_dot2_f32_bf16 v244, v224, s37, v244
  v_dot2_f32_bf16 v245, v224, v224, v245
  v_dot2_f32_bf16 v246, v225, s37, v246
  v_dot2_f32_bf16 v247, v225, v225, v247
  v_dot2_f32_bf16 v244, v226, s37, v244
  v_dot2_f32_bf16 v245, v226, v226, v245
  v_dot2_f32_bf16 v246, v227, s37, v246
  v_dot2_f32_bf16 v247, v227, v227, v247
  v_dot2_f32_bf16 v244, v228, s37, v244
  v_dot2_f32_bf16 v245, v228, v228, v245
  v_dot2_f32_bf16 v246, v229, s37, v246
  v_dot2_f32_bf16 v247, v229, v229, v247
  v_dot2_f32_bf16 v244, v230, s37, v244
  v_dot2_f32_bf16 v245, v230, v230, v245
  v_dot2_f32_bf16 v246, v231, s37, v246
  v_dot2_f32_bf16 v247, v231, v231, v247
  v_dot2_f32_bf16 v244, v232, s37, v244
  v_dot2_f32_bf16 v245, v232, v232, v245
  v_dot2_f32_bf16 v246, v233, s37, v246
  v_dot2_f32_bf16 v247, v233, v233, v247
  s_nop 2
  v_pk_add_f32 v[244:245], v[244:245], v[246:247]
  v_mov_b32 v246, v244
  v_mov_b32 v247, v245
  s_nop 0
  v_permlane16_swap_b32 v244, v246
  v_permlane16_swap_b32 v245, v247
  v_pk_add_f32 v[244:245], v[244:245], v[246:247]
  v_mov_b32 v246, v244
  v_mov_b32 v247, v245
  s_nop 0
  v_permlane32_swap_b32 v244, v246
  v_permlane32_swap_b32 v245, v247
  v_pk_add_f32 v[244:245], v[244:245], v[246:247]
  buffer_store_dwordx2 v[244:245], v243, s[4:7], s67 offen
  buffer_load_dwordx4 v250, s[4:7], s32 offen offset:3072 lds
  s_add_u32 m0, s26, 114688
  s_add_u32 s32, s22, 12288
  buffer_load_dwordx4 v250, s[4:7], s32 offen offset:0 lds
  buffer_load_dwordx4 v250, s[4:7], s32 offen offset:1024 lds
  buffer_load_dwordx4 v250, s[4:7], s32 offen offset:2048 lds
  buffer_load_dwordx4 v250, s[4:7], s32 offen offset:3072 lds
  s_add_u32 m0, s26, 131072
  s_add_u32 s32, s22, 16384
  buffer_load_dwordx4 v250, s[4:7], s32 offen offset:0 lds
  buffer_load_dwordx4 v250, s[4:7], s32 offen offset:1024 lds
  buffer_load_dwordx4 v250, s[4:7], s32 offen offset:2048 lds
  buffer_load_dwordx4 v250, s[4:7], s32 offen offset:3072 lds
  s_waitcnt vmcnt(9)
  s_mov_b64 exec, 1
  buffer_store_byte v14, v15, s[4:7], s58 offen
  s_mov_b64 exec, -1
  s_barrier
  s_add_u32 s20, s20, 1
  s_add_u32 s19, s19, 14942208
  s_add_u32 s21, s21, 5120
  s_cmp_lt_u32 s20, 2
  s_cbranch_scc1 LAYER_LOOP
MAIN_END:

  s_endpgm
.section .rodata,"a"
.p2align 6
.amdhsa_kernel prep_kernel
  .amdhsa_next_free_vgpr 512
  .amdhsa_next_free_sgpr 102
  .amdhsa_accum_offset 256
  .amdhsa_group_segment_fixed_size 0
  .amdhsa_kernarg_size 80
  .amdhsa_user_sgpr_count 2
  .amdhsa_user_sgpr_kernarg_segment_ptr 1
  .amdhsa_system_sgpr_workgroup_id_x 1
  .amdhsa_float_denorm_mode_32 3
  .amdhsa_float_denorm_mode_16_64 3
.end_amdhsa_kernel
.p2align 6
.amdhsa_kernel main_kernel
  .amdhsa_next_free_vgpr 512
  .amdhsa_next_free_sgpr 100
  .amdhsa_accum_offset 256
  .amdhsa_group_segment_fixed_size 0
  .amdhsa_kernarg_size 80
  .amdhsa_user_sgpr_count 2
  .amdhsa_user_sgpr_kernarg_segment_ptr 1
  .amdhsa_system_sgpr_workgroup_id_x 1
  .amdhsa_float_denorm_mode_32 3
  .amdhsa_float_denorm_mode_16_64 3
.end_amdhsa_kernel
```
